```python
import torch

def _softmax(x, axis=-1):
    return torch.softmax(x, dim=axis)
def _gelu(x):
    return torch.nn.functional.gelu(x, approximate="tanh")
def _silu(x):
    return torch.nn.functional.silu(x)
def _sigmoid(x):
    return torch.sigmoid(x)
def _layernorm(x, axis=-1, eps=1e-5):
    m = x.mean(dim=axis, keepdim=True)
    v = x.var(dim=axis, keepdim=True, unbiased=False)
    return (x - m) / torch.sqrt(v + eps)
def _scatter_add(tgt, idx, src, axis=0):
    return tgt.clone().index_add_(axis, idx, src)
def _segment_sum(src, seg, n):
    out = torch.zeros((n,) + src.shape[1:], dtype=src.dtype)
    return out.index_add_(0, seg, src)
def _pad(x, pw):
    flat = tuple(v for pair in reversed(pw) for v in pair)
    return torch.nn.functional.pad(x, flat)

kernel_name = 'interleave_layers__grouped_kv_mqa__glu_gated_geglu__prompt'

def setup_inputs():

    _w = (lambda a: (lambda t: t.to(torch.bfloat16) if t.is_floating_point() else t)(torch.as_tensor(a)))
    def _A_setup():
        B, S, D, H = 1, 2048, 512, 32
        Dh = D // H
        return {
            "x": _w((lambda *s: torch.randn(*s, dtype=torch.bfloat16) * 0.05)(B, S, D)),
            "wq": _w((lambda *s: torch.randn(*s, dtype=torch.bfloat16) * 0.05)(D, H * Dh)),
            "wk": _w((lambda *s: torch.randn(*s, dtype=torch.bfloat16) * 0.05)(D, Dh)),
            "wv": _w((lambda *s: torch.randn(*s, dtype=torch.bfloat16) * 0.05)(D, Dh)),
            "wo": _w((lambda *s: torch.randn(*s, dtype=torch.bfloat16) * 0.05)(H * Dh, D)),
        }
    _A_in = _A_setup()

    def _B_setup():
        B, S, Dm, Df = 1, 2048, 512, 1376
        return {
            "x": _w((lambda *s: torch.randn(*s, dtype=torch.bfloat16) * 0.05)(B, S, Dm)),
            "w_gate": _w((lambda *s: torch.randn(*s, dtype=torch.bfloat16) * 0.8)(Dm, Df) * (Dm ** -0.5)),
            "w_up": _w((lambda *s: torch.randn(*s, dtype=torch.bfloat16) * 0.8)(Dm, Df) * (Dm ** -0.5)),
            "w_down": _w((lambda *s: torch.randn(*s, dtype=torch.bfloat16) * 0.8)(Df, Dm) * (Df ** -0.5)),
        }
    _B_in = _B_setup()

    return {
        "A_x": _A_in["x"],
        "A_wq": _A_in["wq"],
        "A_wk": _A_in["wk"],
        "A_wv": _A_in["wv"],
        "A_wo": _A_in["wo"],
        "B_x": _B_in["x"],
        "B_w_gate": _B_in["w_gate"],
        "B_w_up": _B_in["w_up"],
        "B_w_down": _B_in["w_down"],
    }

def reference(A_x, A_wq, A_wk, A_wv, A_wo, B_x, B_w_gate, B_w_up, B_w_down):
    def _A_ref(x, wq, wk, wv, wo):
        B, S, D = x.shape
        H = 32
        Dh = D // H
        q = (lambda x, *d: x.permute(*d))((x @ wq).reshape(B, S, H, Dh), 0, 2, 1, 3)
        k = x @ wk
        v = x @ wv
        scores = torch.einsum("bhqd,bkd->bhqk", q, k) * (Dh ** -0.5)
        p = _softmax(scores, axis=-1)
        o = torch.einsum("bhqk,bkd->bhqd", p, v)
        return (lambda x, *d: x.permute(*d))(o, 0, 2, 1, 3).reshape(B, S, H * Dh) @ wo

    def _B_ref(x, w_gate, w_up, w_down):
        g = torch.einsum("bsd,df->bsf", x, w_gate)
        u = torch.einsum("bsd,df->bsf", x, w_up)
        h = _gelu(g) * u
        return torch.einsum("bsf,fd->bsd", h, w_down)

    x = A_x
    x = x + _A_ref(_layernorm(x, axis=-1), A_wq, A_wk, A_wv, A_wo)
    x = x + _B_ref(_layernorm(x, axis=-1), B_w_gate, B_w_up, B_w_down)
    x = x + _A_ref(_layernorm(x, axis=-1), A_wq, A_wk, A_wv, A_wo)
    x = x + _B_ref(_layernorm(x, axis=-1), B_w_gate, B_w_up, B_w_down)
    return x
```

```asm
; @launch kernel=front_kernel grid=(256,1,1) block=(512,1,1) lds=163840
; @launch kernel=main_kernel grid=(256,1,1) block=(256,1,1) lds=163840
.amdgcn_target "amdgcn-amd-amdhsa--gfx950"
.text
.globl front_kernel
.p2align 8
.type front_kernel,@function
front_kernel:
    s_cmp_ge_u32 s2, 256
    s_cbranch_scc1 L_front_kernel_end_1
    s_load_dwordx2 s[4:5], s[0:1], 88
    s_load_dwordx16 s[24:39], s[0:1], 0
    s_load_dwordx2 s[40:41], s[0:1], 64
    v_and_b32 v1, 63, v0
    v_lshrrev_b32 v2, 6, v0
    s_mov_b32 s6, 37666816
    v_readfirstlane_b32 s3, v2
    s_mov_b32 s7, 0x20000
    v_lshlrev_b32 v2, 4, v1
    v_mov_b32 v80, 0x3f803f80
    v_mov_b32 v81, 0x3f803f80
    v_mov_b32 v82, 0x3f803f80
    v_mov_b32 v83, 0x3f803f80
    v_mov_b32 v15, 155648
    v_lshl_add_u32 v16, v1, 2, v15
    v_mov_b32 v17, 0
    ds_write_b32 v16, v17
    v_mov_b32 v143, 1
    s_waitcnt lgkmcnt(0)
    s_barrier
    s_cmp_ge_u32 s3, 4
    s_cbranch_scc1 L_front_kernel_B_7
    s_and_b32 s20, s2, 7
    s_lshl_b32 s20, s20, 2
    s_lshr_b32 s21, s2, 6
    s_add_u32 s20, s20, s21
    s_lshr_b32 s21, s2, 3
    s_and_b32 s21, s21, 7
    v_lshrrev_b32 v16, 3, v1
    v_and_b32 v17, 7, v1
    v_lshrrev_b32 v18, 2, v1
    v_and_b32 v18, 4, v18
    v_xor_b32 v18, v17, v18
    v_lshlrev_b32 v18, 4, v18
    v_lshl_add_u32 v3, v16, 10, v18
    v_add_u32 v129, 8192, v3
    v_lshrrev_b32 v18, 4, v1
    v_xor_b32 v18, v17, v18
    v_lshlrev_b32 v18, 4, v18
    v_lshl_add_u32 v4, v16, 10, v18
    v_xor_b32 v128, 64, v4
    v_add_u32 v128, 8192, v128
    s_lshl_b32 s22, s21, 7
    s_lshl_b32 s23, s20, 16
    s_lshl_b32 s68, s3, 14
    s_add_u32 s22, s22, s68
    s_add_u32 s23, s23, s68
    s_lshl_b32 s69, s3, 11
    s_and_b32 s101, s20, 3
    s_lshl_b32 s101, s101, 1
    s_add_u32 s101, s101, s21
    s_mov_b32 s10, 2097152
    s_mov_b32 s11, 0x20000
    s_mov_b32 s14, 524288
    s_mov_b32 s15, 0x20000
    s_mov_b32 s18, 16384
    s_mov_b32 s19, 0x20000
    s_waitcnt lgkmcnt(0)
    s_mov_b32 s8, s24
    s_mov_b32 s9, s25
    s_mov_b32 s12, s26
    s_mov_b32 s13, s27
    s_bitcmp1_b32 s21, 0
    s_cselect_b32 s16, s30, s28
    s_cselect_b32 s17, s31, s29
    s_add_u32 s100, s101, 0
    s_and_b32 s100, s100, 7
    s_lshl_b32 s70, s100, 7
    s_add_u32 m0, s69, 65536
    s_add_u32 s70, s70, s23
    buffer_load_dwordx4 v4, s[8:11], s70 offen lds
    s_lshl_b32 s70, s100, 16
    s_add_u32 m0, s69, 0
    s_add_u32 s70, s70, s22
    buffer_load_dwordx4 v3, s[12:15], s70 offen lds
    s_lshl_b32 s70, s100, 7
    s_add_u32 m0, s69, 66560
    s_add_u32 s70, s70, s23
    buffer_load_dwordx4 v128, s[8:11], s70 offen lds
    s_lshl_b32 s70, s100, 16
    s_add_u32 m0, s69, 1024
    s_add_u32 s70, s70, s22
    buffer_load_dwordx4 v129, s[12:15], s70 offen lds
    s_add_u32 s100, s101, 1
    s_and_b32 s100, s100, 7
    s_lshl_b32 s70, s100, 7
    s_add_u32 m0, s69, 73728
    s_add_u32 s70, s70, s23
    buffer_load_dwordx4 v4, s[8:11], s70 offen lds
    s_lshl_b32 s70, s100, 16
    s_add_u32 m0, s69, 8192
    s_add_u32 s70, s70, s22
    buffer_load_dwordx4 v3, s[12:15], s70 offen lds
    s_lshl_b32 s70, s100, 7
    s_add_u32 m0, s69, 74752
    s_add_u32 s70, s70, s23
    buffer_load_dwordx4 v128, s[8:11], s70 offen lds
    s_lshl_b32 s70, s100, 16
    s_add_u32 m0, s69, 9216
    s_add_u32 s70, s70, s22
    buffer_load_dwordx4 v129, s[12:15], s70 offen lds
    s_lshl_b32 s99, s3, 12
    s_lshl_b32 s64, s3, 1
    s_add_u32 s64, s64, s101
    s_add_u32 s64, s64, 0
    s_and_b32 s64, s64, 7
    s_lshl_b32 s97, s64, 11
    s_add_u32 m0, s99, 131072
    s_nop 0
    buffer_load_dwordx4 v2, s[16:19], s97 offen offset:0 lds
    buffer_load_dwordx4 v2, s[16:19], s97 offen offset:1024 lds
    s_lshl_b32 s64, s3, 1
    s_add_u32 s64, s64, s101
    s_add_u32 s64, s64, 1
    s_and_b32 s64, s64, 7
    s_lshl_b32 s98, s64, 11
    s_add_u32 m0, s99, 133120
    s_nop 0
    buffer_load_dwordx4 v2, s[16:19], s98 offen offset:0 lds
    buffer_load_dwordx4 v2, s[16:19], s98 offen offset:1024 lds
    v_and_b32 v16, 1, v1
    v_lshlrev_b32 v16, 4, v16
    v_and_b32 v17, 2, v1
    v_lshl_add_u32 v16, v17, 2, v16
    v_and_b32 v17, 16, v1
    v_lshl_add_u32 v16, v17, 1, v16
    v_bfe_u32 v17, v1, 2, 2
    v_lshrrev_b32 v22, 5, v1
    v_lshl_add_u32 v23, v22, 3, v17
    v_lshl_add_u32 v9, v23, 7, v16
    v_lshrrev_b32 v17, 1, v17
    s_and_b32 s64, s3, 1
    v_xor_b32 v17, s64, v17
    v_lshl_add_u32 v9, v17, 6, v9
    v_and_b32 v16, 31, v1
    s_lshr_b32 s64, s3, 1
    s_lshl_b32 s64, s64, 12
    s_add_u32 s64, s64, 65536
    v_lshlrev_b32 v17, 7, v16
    v_add_u32 v17, s64, v17
    v_bfe_u32 v16, v1, 1, 3
    v_xor_b32 v16, v16, v22
    v_xor_b32 v23, 0, v16
    v_lshl_add_u32 v5, v23, 4, v17
    v_xor_b32 v23, 2, v16
    v_lshl_add_u32 v6, v23, 4, v17
    v_xor_b32 v23, 4, v16
    v_lshl_add_u32 v7, v23, 4, v17
    v_xor_b32 v23, 6, v16
    v_lshl_add_u32 v8, v23, 4, v17
    s_and_b32 s64, s3, 1
    s_lshl_b32 s64, s64, 1
    v_xor_b32 v23, s64, v16
    v_lshl_add_u32 v130, v23, 4, v17
    v_xor_b32 v23, 4, v23
    v_lshl_add_u32 v131, v23, 4, v17
    v_lshrrev_b32 v16, 4, v1
    v_bfe_u32 v17, v1, 2, 2
    v_lshl_add_u32 v17, v16, 3, v17
    v_lshlrev_b32 v17, 5, v17
    v_and_b32 v22, 3, v1
    v_lshl_add_u32 v17, v22, 3, v17
    s_add_u32 s64, s99, 131072
    v_add_u32 v10, s64, v17
    v_add_u32 v140, s64, v2
    s_lshr_b32 s64, s21, 1
    s_lshl_b32 s65, s64, 4
    v_and_b32 v17, 15, v1
    v_add_u32 v22, s65, v17
    v_lshlrev_b32 v23, 7, v22
    s_add_u32 s66, s68, 65536
    v_add_u32 v23, s66, v23
    v_lshrrev_b32 v24, 1, v17
    v_xor_b32 v24, v24, v16
    v_lshl_add_u32 v11, v24, 4, v23
    v_xor_b32 v24, 4, v24
    v_lshl_add_u32 v12, v24, 4, v23
    v_and_b32 v13, 31, v22
    v_and_b32 v24, 1, v16
    v_lshrrev_b32 v25, 1, v16
    v_lshl_add_u32 v26, v25, 5, v13
    v_lshlrev_b32 v26, 4, v26
    v_lshl_add_u32 v26, v24, 3, v26
    v_lshrrev_b32 v27, 3, v17
    v_lshlrev_b32 v27, 4, v27
    v_lshl_add_u32 v27, v24, 3, v27
    v_lshl_add_u32 v27, v25, 2, v27
    v_lshlrev_b32 v27, 4, v27
    v_and_b32 v28, 7, v17
    v_lshl_add_u32 v27, v28, 1, v27
    s_and_b32 s65, s64, 1
    s_lshl_b32 s65, s65, 9
    s_add_u32 s65, s65, 1024
    v_add_u32 v27, s65, v27
    s_bitcmp1_b32 s21, 0
    s_cselect_b64 vcc, -1, 0
    s_cselect_b32 s71, 16, 2
    v_cndmask_b32 v14, v26, v27, vcc
    v_lshlrev_b32 v13, 2, v13
    v_mov_b32 v84, 0
    v_mov_b32 v85, 0
    v_mov_b32 v86, 0
    v_mov_b32 v87, 0
    s_waitcnt vmcnt(8)
    s_add_u32 s100, s101, 2
    s_and_b32 s100, s100, 7
    s_lshl_b32 s70, s100, 7
    s_add_u32 m0, s69, 81920
    s_add_u32 s70, s70, s23
    buffer_load_dwordx4 v4, s[8:11], s70 offen lds
    s_lshl_b32 s70, s100, 16
    s_add_u32 m0, s69, 16384
    s_add_u32 s70, s70, s22
    buffer_load_dwordx4 v3, s[12:15], s70 offen lds
    s_lshl_b32 s70, s100, 7
    s_add_u32 m0, s69, 82944
    s_add_u32 s70, s70, s23
    buffer_load_dwordx4 v128, s[8:11], s70 offen lds
    s_lshl_b32 s70, s100, 16
    s_add_u32 m0, s69, 17408
    s_add_u32 s70, s70, s22
    buffer_load_dwordx4 v129, s[12:15], s70 offen lds
    s_add_u32 s100, s101, 3
    s_and_b32 s100, s100, 7
    s_lshl_b32 s70, s100, 7
    s_add_u32 m0, s69, 90112
    s_add_u32 s70, s70, s23
    buffer_load_dwordx4 v4, s[8:11], s70 offen lds
    s_lshl_b32 s70, s100, 16
    s_add_u32 m0, s69, 24576
    s_add_u32 s70, s70, s22
    buffer_load_dwordx4 v3, s[12:15], s70 offen lds
    s_lshl_b32 s70, s100, 7
    s_add_u32 m0, s69, 91136
    s_add_u32 s70, s70, s23
    buffer_load_dwordx4 v128, s[8:11], s70 offen lds
    s_lshl_b32 s70, s100, 16
    s_add_u32 m0, s69, 25600
    s_add_u32 s70, s70, s22
    buffer_load_dwordx4 v129, s[12:15], s70 offen lds
    s_waitcnt vmcnt(12)
    s_mov_b64 exec, 1
    ds_add_u32 v15, v143 offset:0
    s_mov_b64 exec, -1
L_front_kernel_ls_8:
    ds_read_b32 v0, v15 offset:0
    s_waitcnt lgkmcnt(0)
    v_cmp_ne_u32 vcc, 4, v0
    s_cbranch_vccnz L_front_kernel_ls_8
    ds_read_b128 v[48:51], v5 offset:0
    ds_read_b64_tr_b16 v[52:53], v9 offset:0
    ds_read_b64_tr_b16 v[54:55], v9 offset:512
    ds_read_b128 v[132:135], v130 offset:0
    ds_read_b128 v[56:59], v6 offset:0
    ds_read_b64_tr_b16 v[60:61], v9 offset:2048
    ds_read_b64_tr_b16 v[62:63], v9 offset:2560
    s_waitcnt lgkmcnt(3)
    v_mfma_f32_32x32x16_bf16 v[16:31], v[52:55], v[48:51], 0
    ds_read_b128 v[64:67], v7 offset:0
    ds_read_b64_tr_b16 v[68:69], v9 offset:4096
    ds_read_b64_tr_b16 v[70:71], v9 offset:4608
    ds_read_b128 v[136:139], v131 offset:0
    v_lshlrev_b32 v141, 16, v132
    v_and_b32 v142, 0xffff0000, v132
    v_fmac_f32 v86, v141, v141
    v_add_f32 v84, v84, v141
    v_fmac_f32 v87, v142, v142
    v_mfma_f32_32x32x16_bf16 v[32:47], v[52:55], v[80:83], 0
    s_add_u32 s100, s101, 4
    s_and_b32 s100, s100, 7
    s_lshl_b32 s70, s100, 7
    s_add_u32 m0, s69, 98304
    s_add_u32 s70, s70, s23
    buffer_load_dwordx4 v4, s[8:11], s70 offen lds
    s_lshl_b32 s70, s100, 16
    s_add_u32 m0, s69, 32768
    s_add_u32 s70, s70, s22
    buffer_load_dwordx4 v3, s[12:15], s70 offen lds
    v_add_f32 v85, v85, v142
    v_lshlrev_b32 v141, 16, v133
    v_and_b32 v142, 0xffff0000, v133
    v_fmac_f32 v86, v141, v141
    v_add_f32 v84, v84, v141
    v_fmac_f32 v87, v142, v142
    v_add_f32 v85, v85, v142
    s_waitcnt lgkmcnt(4)
    v_mfma_f32_32x32x16_bf16 v[16:31], v[60:63], v[56:59], v[16:31]
    ds_read_b128 v[72:75], v8 offset:0
    ds_read_b64_tr_b16 v[76:77], v9 offset:6144
    ds_read_b64_tr_b16 v[78:79], v9 offset:6656
    v_lshlrev_b32 v141, 16, v134
    v_and_b32 v142, 0xffff0000, v134
    v_fmac_f32 v86, v141, v141
    v_add_f32 v84, v84, v141
    v_fmac_f32 v87, v142, v142
    v_mfma_f32_32x32x16_bf16 v[32:47], v[60:63], v[80:83], v[32:47]
    s_lshl_b32 s70, s100, 7
    s_add_u32 m0, s69, 99328
    s_add_u32 s70, s70, s23
    buffer_load_dwordx4 v128, s[8:11], s70 offen lds
    s_lshl_b32 s70, s100, 16
    s_add_u32 m0, s69, 33792
    s_add_u32 s70, s70, s22
    buffer_load_dwordx4 v129, s[12:15], s70 offen lds
    v_add_f32 v85, v85, v142
    v_lshlrev_b32 v141, 16, v135
    v_and_b32 v142, 0xffff0000, v135
    v_fmac_f32 v86, v141, v141
    v_add_f32 v84, v84, v141
    v_fmac_f32 v87, v142, v142
    v_add_f32 v85, v85, v142
    s_waitcnt lgkmcnt(3)
    v_mfma_f32_32x32x16_bf16 v[16:31], v[68:71], v[64:67], v[16:31]
    ds_read_b128 v[48:51], v5 offset:8192
    ds_read_b64_tr_b16 v[52:53], v9 offset:8192
    ds_read_b64_tr_b16 v[54:55], v9 offset:8704
    ds_read_b128 v[132:135], v130 offset:8192
    v_lshlrev_b32 v141, 16, v136
    v_and_b32 v142, 0xffff0000, v136
    v_fmac_f32 v86, v141, v141
    v_add_f32 v84, v84, v141
    v_fmac_f32 v87, v142, v142
    v_mfma_f32_32x32x16_bf16 v[32:47], v[68:71], v[80:83], v[32:47]
    s_add_u32 s100, s101, 5
    s_and_b32 s100, s100, 7
    s_lshl_b32 s70, s100, 7
    s_add_u32 m0, s69, 106496
    s_add_u32 s70, s70, s23
    buffer_load_dwordx4 v4, s[8:11], s70 offen lds
    s_lshl_b32 s70, s100, 16
    s_add_u32 m0, s69, 40960
    s_add_u32 s70, s70, s22
    buffer_load_dwordx4 v3, s[12:15], s70 offen lds
    v_add_f32 v85, v85, v142
    v_lshlrev_b32 v141, 16, v137
    v_and_b32 v142, 0xffff0000, v137
    v_fmac_f32 v86, v141, v141
    v_add_f32 v84, v84, v141
    v_fmac_f32 v87, v142, v142
    v_add_f32 v85, v85, v142
    s_waitcnt lgkmcnt(4)
    v_mfma_f32_32x32x16_bf16 v[16:31], v[76:79], v[72:75], v[16:31]
    ds_read_b128 v[56:59], v6 offset:8192
    ds_read_b64_tr_b16 v[60:61], v9 offset:10240
    ds_read_b64_tr_b16 v[62:63], v9 offset:10752
    v_lshlrev_b32 v141, 16, v138
    v_and_b32 v142, 0xffff0000, v138
    v_fmac_f32 v86, v141, v141
    v_add_f32 v84, v84, v141
    v_fmac_f32 v87, v142, v142
    v_mfma_f32_32x32x16_bf16 v[32:47], v[76:79], v[80:83], v[32:47]
    s_lshl_b32 s70, s100, 7
    s_add_u32 m0, s69, 107520
    s_add_u32 s70, s70, s23
    buffer_load_dwordx4 v128, s[8:11], s70 offen lds
    s_lshl_b32 s70, s100, 16
    s_add_u32 m0, s69, 41984
    s_add_u32 s70, s70, s22
    buffer_load_dwordx4 v129, s[12:15], s70 offen lds
    v_add_f32 v85, v85, v142
    v_lshlrev_b32 v141, 16, v139
    v_and_b32 v142, 0xffff0000, v139
    v_fmac_f32 v86, v141, v141
    v_add_f32 v84, v84, v141
    v_fmac_f32 v87, v142, v142
    v_add_f32 v85, v85, v142
    s_waitcnt lgkmcnt(3)
    v_mfma_f32_32x32x16_bf16 v[16:31], v[52:55], v[48:51], v[16:31]
    ds_read_b128 v[64:67], v7 offset:8192
    ds_read_b64_tr_b16 v[68:69], v9 offset:12288
    ds_read_b64_tr_b16 v[70:71], v9 offset:12800
    ds_read_b128 v[136:139], v131 offset:8192
    v_lshlrev_b32 v141, 16, v132
    v_and_b32 v142, 0xffff0000, v132
    v_fmac_f32 v86, v141, v141
    v_add_f32 v84, v84, v141
    v_fmac_f32 v87, v142, v142
    v_mfma_f32_32x32x16_bf16 v[32:47], v[52:55], v[80:83], v[32:47]
    s_add_u32 s100, s101, 6
    s_and_b32 s100, s100, 7
    s_lshl_b32 s70, s100, 7
    s_add_u32 m0, s69, 114688
    s_add_u32 s70, s70, s23
    buffer_load_dwordx4 v4, s[8:11], s70 offen lds
    s_lshl_b32 s70, s100, 16
    s_add_u32 m0, s69, 49152
    s_add_u32 s70, s70, s22
    buffer_load_dwordx4 v3, s[12:15], s70 offen lds
    v_add_f32 v85, v85, v142
    v_lshlrev_b32 v141, 16, v133
    v_and_b32 v142, 0xffff0000, v133
    v_fmac_f32 v86, v141, v141
    v_add_f32 v84, v84, v141
    v_fmac_f32 v87, v142, v142
    v_add_f32 v85, v85, v142
    s_waitcnt lgkmcnt(4)
    v_mfma_f32_32x32x16_bf16 v[16:31], v[60:63], v[56:59], v[16:31]
    ds_read_b128 v[72:75], v8 offset:8192
    ds_read_b64_tr_b16 v[76:77], v9 offset:14336
    ds_read_b64_tr_b16 v[78:79], v9 offset:14848
    v_lshlrev_b32 v141, 16, v134
    v_and_b32 v142, 0xffff0000, v134
    v_fmac_f32 v86, v141, v141
    v_add_f32 v84, v84, v141
    v_fmac_f32 v87, v142, v142
    v_mfma_f32_32x32x16_bf16 v[32:47], v[60:63], v[80:83], v[32:47]
    s_lshl_b32 s70, s100, 7
    s_add_u32 m0, s69, 115712
    s_add_u32 s70, s70, s23
    buffer_load_dwordx4 v128, s[8:11], s70 offen lds
    s_lshl_b32 s70, s100, 16
    s_add_u32 m0, s69, 50176
    s_add_u32 s70, s70, s22
    buffer_load_dwordx4 v129, s[12:15], s70 offen lds
    v_add_f32 v85, v85, v142
    v_lshlrev_b32 v141, 16, v135
    v_and_b32 v142, 0xffff0000, v135
    v_fmac_f32 v86, v141, v141
    v_add_f32 v84, v84, v141
    v_fmac_f32 v87, v142, v142
    v_add_f32 v85, v85, v142
    s_waitcnt lgkmcnt(3)
    v_mfma_f32_32x32x16_bf16 v[16:31], v[68:71], v[64:67], v[16:31]
    s_waitcnt vmcnt(12)
    s_mov_b64 exec, 1
    ds_add_u32 v15, v143 offset:4
    s_mov_b64 exec, -1
L_front_kernel_ls_9:
    ds_read_b32 v0, v15 offset:4
    s_waitcnt lgkmcnt(0)
    v_cmp_ne_u32 vcc, 4, v0
    s_cbranch_vccnz L_front_kernel_ls_9
    ds_read_b128 v[48:51], v5 offset:16384
    ds_read_b64_tr_b16 v[52:53], v9 offset:16384
    ds_read_b64_tr_b16 v[54:55], v9 offset:16896
    ds_read_b128 v[132:135], v130 offset:16384
    v_lshlrev_b32 v141, 16, v136
    v_and_b32 v142, 0xffff0000, v136
    v_fmac_f32 v86, v141, v141
    v_add_f32 v84, v84, v141
    v_fmac_f32 v87, v142, v142
    v_mfma_f32_32x32x16_bf16 v[32:47], v[68:71], v[80:83], v[32:47]
    s_add_u32 s100, s101, 7
    s_and_b32 s100, s100, 7
    s_lshl_b32 s70, s100, 7
    s_add_u32 m0, s69, 122880
    s_add_u32 s70, s70, s23
    buffer_load_dwordx4 v4, s[8:11], s70 offen lds
    s_lshl_b32 s70, s100, 16
    s_add_u32 m0, s69, 57344
    s_add_u32 s70, s70, s22
    buffer_load_dwordx4 v3, s[12:15], s70 offen lds
    v_add_f32 v85, v85, v142
    v_lshlrev_b32 v141, 16, v137
    v_and_b32 v142, 0xffff0000, v137
    v_fmac_f32 v86, v141, v141
    v_add_f32 v84, v84, v141
    v_fmac_f32 v87, v142, v142
    v_add_f32 v85, v85, v142
    s_waitcnt lgkmcnt(4)
    v_mfma_f32_32x32x16_bf16 v[16:31], v[76:79], v[72:75], v[16:31]
    ds_read_b128 v[56:59], v6 offset:16384
    ds_read_b64_tr_b16 v[60:61], v9 offset:18432
    ds_read_b64_tr_b16 v[62:63], v9 offset:18944
    v_lshlrev_b32 v141, 16, v138
    v_and_b32 v142, 0xffff0000, v138
    v_fmac_f32 v86, v141, v141
    v_add_f32 v84, v84, v141
    v_fmac_f32 v87, v142, v142
    v_mfma_f32_32x32x16_bf16 v[32:47], v[76:79], v[80:83], v[32:47]
    s_lshl_b32 s70, s100, 7
    s_add_u32 m0, s69, 123904
    s_add_u32 s70, s70, s23
    buffer_load_dwordx4 v128, s[8:11], s70 offen lds
    s_lshl_b32 s70, s100, 16
    s_add_u32 m0, s69, 58368
    s_add_u32 s70, s70, s22
    buffer_load_dwordx4 v129, s[12:15], s70 offen lds
    v_add_f32 v85, v85, v142
    v_lshlrev_b32 v141, 16, v139
    v_and_b32 v142, 0xffff0000, v139
    v_fmac_f32 v86, v141, v141
    v_add_f32 v84, v84, v141
    v_fmac_f32 v87, v142, v142
    v_add_f32 v85, v85, v142
    s_waitcnt lgkmcnt(3)
    v_mfma_f32_32x32x16_bf16 v[16:31], v[52:55], v[48:51], v[16:31]
    ds_read_b128 v[64:67], v7 offset:16384
    ds_read_b64_tr_b16 v[68:69], v9 offset:20480
    ds_read_b64_tr_b16 v[70:71], v9 offset:20992
    ds_read_b128 v[136:139], v131 offset:16384
    v_lshlrev_b32 v141, 16, v132
    v_and_b32 v142, 0xffff0000, v132
    v_fmac_f32 v86, v141, v141
    v_add_f32 v84, v84, v141
    v_fmac_f32 v87, v142, v142
    v_mfma_f32_32x32x16_bf16 v[32:47], v[52:55], v[80:83], v[32:47]
    v_add_f32 v85, v85, v142
    v_lshlrev_b32 v141, 16, v133
    v_and_b32 v142, 0xffff0000, v133
    v_fmac_f32 v86, v141, v141
    v_add_f32 v84, v84, v141
    v_fmac_f32 v87, v142, v142
    v_add_f32 v85, v85, v142
    s_waitcnt lgkmcnt(4)
    v_mfma_f32_32x32x16_bf16 v[16:31], v[60:63], v[56:59], v[16:31]
    ds_read_b128 v[72:75], v8 offset:16384
    ds_read_b64_tr_b16 v[76:77], v9 offset:22528
    ds_read_b64_tr_b16 v[78:79], v9 offset:23040
    v_lshlrev_b32 v141, 16, v134
    v_and_b32 v142, 0xffff0000, v134
    v_fmac_f32 v86, v141, v141
    v_add_f32 v84, v84, v141
    v_fmac_f32 v87, v142, v142
    v_mfma_f32_32x32x16_bf16 v[32:47], v[60:63], v[80:83], v[32:47]
    v_add_f32 v85, v85, v142
    v_lshlrev_b32 v141, 16, v135
    v_and_b32 v142, 0xffff0000, v135
    v_fmac_f32 v86, v141, v141
    v_add_f32 v84, v84, v141
    v_fmac_f32 v87, v142, v142
    v_add_f32 v85, v85, v142
    s_waitcnt lgkmcnt(3)
    v_mfma_f32_32x32x16_bf16 v[16:31], v[68:71], v[64:67], v[16:31]
    ds_read_b128 v[48:51], v5 offset:24576
    ds_read_b64_tr_b16 v[52:53], v9 offset:24576
    ds_read_b64_tr_b16 v[54:55], v9 offset:25088
    ds_read_b128 v[132:135], v130 offset:24576
    v_lshlrev_b32 v141, 16, v136
    v_and_b32 v142, 0xffff0000, v136
    v_fmac_f32 v86, v141, v141
    v_add_f32 v84, v84, v141
    v_fmac_f32 v87, v142, v142
    v_mfma_f32_32x32x16_bf16 v[32:47], v[68:71], v[80:83], v[32:47]
    v_add_f32 v85, v85, v142
    v_lshlrev_b32 v141, 16, v137
    v_and_b32 v142, 0xffff0000, v137
    v_fmac_f32 v86, v141, v141
    v_add_f32 v84, v84, v141
    v_fmac_f32 v87, v142, v142
    v_add_f32 v85, v85, v142
    s_waitcnt lgkmcnt(4)
    v_mfma_f32_32x32x16_bf16 v[16:31], v[76:79], v[72:75], v[16:31]
    ds_read_b128 v[56:59], v6 offset:24576
    ds_read_b64_tr_b16 v[60:61], v9 offset:26624
    ds_read_b64_tr_b16 v[62:63], v9 offset:27136
    v_lshlrev_b32 v141, 16, v138
    v_and_b32 v142, 0xffff0000, v138
    v_fmac_f32 v86, v141, v141
    v_add_f32 v84, v84, v141
    v_fmac_f32 v87, v142, v142
    v_mfma_f32_32x32x16_bf16 v[32:47], v[76:79], v[80:83], v[32:47]
    v_add_f32 v85, v85, v142
    v_lshlrev_b32 v141, 16, v139
    v_and_b32 v142, 0xffff0000, v139
    v_fmac_f32 v86, v141, v141
    v_add_f32 v84, v84, v141
    v_fmac_f32 v87, v142, v142
    v_add_f32 v85, v85, v142
    s_waitcnt lgkmcnt(3)
    v_mfma_f32_32x32x16_bf16 v[16:31], v[52:55], v[48:51], v[16:31]
    ds_read_b128 v[64:67], v7 offset:24576
    ds_read_b64_tr_b16 v[68:69], v9 offset:28672
    ds_read_b64_tr_b16 v[70:71], v9 offset:29184
    ds_read_b128 v[136:139], v131 offset:24576
    v_lshlrev_b32 v141, 16, v132
    v_and_b32 v142, 0xffff0000, v132
    v_fmac_f32 v86, v141, v141
    v_add_f32 v84, v84, v141
    v_fmac_f32 v87, v142, v142
    v_mfma_f32_32x32x16_bf16 v[32:47], v[52:55], v[80:83], v[32:47]
    v_add_f32 v85, v85, v142
    v_lshlrev_b32 v141, 16, v133
    v_and_b32 v142, 0xffff0000, v133
    v_fmac_f32 v86, v141, v141
    v_add_f32 v84, v84, v141
    v_fmac_f32 v87, v142, v142
    v_add_f32 v85, v85, v142
    s_waitcnt lgkmcnt(4)
    v_mfma_f32_32x32x16_bf16 v[16:31], v[60:63], v[56:59], v[16:31]
    ds_read_b128 v[72:75], v8 offset:24576
    ds_read_b64_tr_b16 v[76:77], v9 offset:30720
    ds_read_b64_tr_b16 v[78:79], v9 offset:31232
    v_lshlrev_b32 v141, 16, v134
    v_and_b32 v142, 0xffff0000, v134
    v_fmac_f32 v86, v141, v141
    v_add_f32 v84, v84, v141
    v_fmac_f32 v87, v142, v142
    v_mfma_f32_32x32x16_bf16 v[32:47], v[60:63], v[80:83], v[32:47]
    v_add_f32 v85, v85, v142
    v_lshlrev_b32 v141, 16, v135
    v_and_b32 v142, 0xffff0000, v135
    v_fmac_f32 v86, v141, v141
    v_add_f32 v84, v84, v141
    v_fmac_f32 v87, v142, v142
    v_add_f32 v85, v85, v142
    s_waitcnt lgkmcnt(3)
    v_mfma_f32_32x32x16_bf16 v[16:31], v[68:71], v[64:67], v[16:31]
    s_waitcnt vmcnt(8)
    s_mov_b64 exec, 1
    ds_add_u32 v15, v143 offset:8
    s_mov_b64 exec, -1
L_front_kernel_ls_10:
    ds_read_b32 v0, v15 offset:8
    s_waitcnt lgkmcnt(0)
    v_cmp_ne_u32 vcc, 4, v0
    s_cbranch_vccnz L_front_kernel_ls_10
    ds_read_b128 v[48:51], v5 offset:32768
    ds_read_b64_tr_b16 v[52:53], v9 offset:32768
    ds_read_b64_tr_b16 v[54:55], v9 offset:33280
    ds_read_b128 v[132:135], v130 offset:32768
    v_lshlrev_b32 v141, 16, v136
    v_and_b32 v142, 0xffff0000, v136
    v_fmac_f32 v86, v141, v141
    v_add_f32 v84, v84, v141
    v_fmac_f32 v87, v142, v142
    v_mfma_f32_32x32x16_bf16 v[32:47], v[68:71], v[80:83], v[32:47]
    v_add_f32 v85, v85, v142
    v_lshlrev_b32 v141, 16, v137
    v_and_b32 v142, 0xffff0000, v137
    v_fmac_f32 v86, v141, v141
    v_add_f32 v84, v84, v141
    v_fmac_f32 v87, v142, v142
    v_add_f32 v85, v85, v142
    s_waitcnt lgkmcnt(4)
    v_mfma_f32_32x32x16_bf16 v[16:31], v[76:79], v[72:75], v[16:31]
    ds_read_b128 v[56:59], v6 offset:32768
    ds_read_b64_tr_b16 v[60:61], v9 offset:34816
    ds_read_b64_tr_b16 v[62:63], v9 offset:35328
    v_lshlrev_b32 v141, 16, v138
    v_and_b32 v142, 0xffff0000, v138
    v_fmac_f32 v86, v141, v141
    v_add_f32 v84, v84, v141
    v_fmac_f32 v87, v142, v142
    v_mfma_f32_32x32x16_bf16 v[32:47], v[76:79], v[80:83], v[32:47]
    v_add_f32 v85, v85, v142
    v_lshlrev_b32 v141, 16, v139
    v_and_b32 v142, 0xffff0000, v139
    v_fmac_f32 v86, v141, v141
    v_add_f32 v84, v84, v141
    v_fmac_f32 v87, v142, v142
    v_add_f32 v85, v85, v142
    s_waitcnt lgkmcnt(3)
    v_mfma_f32_32x32x16_bf16 v[16:31], v[52:55], v[48:51], v[16:31]
    ds_read_b128 v[64:67], v7 offset:32768
    ds_read_b64_tr_b16 v[68:69], v9 offset:36864
    ds_read_b64_tr_b16 v[70:71], v9 offset:37376
    ds_read_b128 v[136:139], v131 offset:32768
    v_lshlrev_b32 v141, 16, v132
    v_and_b32 v142, 0xffff0000, v132
    v_fmac_f32 v86, v141, v141
    v_add_f32 v84, v84, v141
    v_fmac_f32 v87, v142, v142
    v_mfma_f32_32x32x16_bf16 v[32:47], v[52:55], v[80:83], v[32:47]
    v_add_f32 v85, v85, v142
    v_lshlrev_b32 v141, 16, v133
    v_and_b32 v142, 0xffff0000, v133
    v_fmac_f32 v86, v141, v141
    v_add_f32 v84, v84, v141
    v_fmac_f32 v87, v142, v142
    v_add_f32 v85, v85, v142
    s_waitcnt lgkmcnt(4)
    v_mfma_f32_32x32x16_bf16 v[16:31], v[60:63], v[56:59], v[16:31]
    ds_read_b128 v[72:75], v8 offset:32768
    ds_read_b64_tr_b16 v[76:77], v9 offset:38912
    ds_read_b64_tr_b16 v[78:79], v9 offset:39424
    v_lshlrev_b32 v141, 16, v134
    v_and_b32 v142, 0xffff0000, v134
    v_fmac_f32 v86, v141, v141
    v_add_f32 v84, v84, v141
    v_fmac_f32 v87, v142, v142
    v_mfma_f32_32x32x16_bf16 v[32:47], v[60:63], v[80:83], v[32:47]
    v_add_f32 v85, v85, v142
    v_lshlrev_b32 v141, 16, v135
    v_and_b32 v142, 0xffff0000, v135
    v_fmac_f32 v86, v141, v141
    v_add_f32 v84, v84, v141
    v_fmac_f32 v87, v142, v142
    v_add_f32 v85, v85, v142
    s_waitcnt lgkmcnt(3)
    v_mfma_f32_32x32x16_bf16 v[16:31], v[68:71], v[64:67], v[16:31]
    ds_read_b128 v[48:51], v5 offset:40960
    ds_read_b64_tr_b16 v[52:53], v9 offset:40960
    ds_read_b64_tr_b16 v[54:55], v9 offset:41472
    ds_read_b128 v[132:135], v130 offset:40960
    v_lshlrev_b32 v141, 16, v136
    v_and_b32 v142, 0xffff0000, v136
    v_fmac_f32 v86, v141, v141
    v_add_f32 v84, v84, v141
    v_fmac_f32 v87, v142, v142
    v_mfma_f32_32x32x16_bf16 v[32:47], v[68:71], v[80:83], v[32:47]
    v_add_f32 v85, v85, v142
    v_lshlrev_b32 v141, 16, v137
    v_and_b32 v142, 0xffff0000, v137
    v_fmac_f32 v86, v141, v141
    v_add_f32 v84, v84, v141
    v_fmac_f32 v87, v142, v142
    v_add_f32 v85, v85, v142
    s_waitcnt lgkmcnt(4)
    v_mfma_f32_32x32x16_bf16 v[16:31], v[76:79], v[72:75], v[16:31]
    ds_read_b128 v[56:59], v6 offset:40960
    ds_read_b64_tr_b16 v[60:61], v9 offset:43008
    ds_read_b64_tr_b16 v[62:63], v9 offset:43520
    v_lshlrev_b32 v141, 16, v138
    v_and_b32 v142, 0xffff0000, v138
    v_fmac_f32 v86, v141, v141
    v_add_f32 v84, v84, v141
    v_fmac_f32 v87, v142, v142
    v_mfma_f32_32x32x16_bf16 v[32:47], v[76:79], v[80:83], v[32:47]
    v_add_f32 v85, v85, v142
    v_lshlrev_b32 v141, 16, v139
    v_and_b32 v142, 0xffff0000, v139
    v_fmac_f32 v86, v141, v141
    v_add_f32 v84, v84, v141
    v_fmac_f32 v87, v142, v142
    v_add_f32 v85, v85, v142
    s_waitcnt lgkmcnt(3)
    v_mfma_f32_32x32x16_bf16 v[16:31], v[52:55], v[48:51], v[16:31]
    ds_read_b128 v[64:67], v7 offset:40960
    ds_read_b64_tr_b16 v[68:69], v9 offset:45056
    ds_read_b64_tr_b16 v[70:71], v9 offset:45568
    ds_read_b128 v[136:139], v131 offset:40960
    v_lshlrev_b32 v141, 16, v132
    v_and_b32 v142, 0xffff0000, v132
    v_fmac_f32 v86, v141, v141
    v_add_f32 v84, v84, v141
    v_fmac_f32 v87, v142, v142
    v_mfma_f32_32x32x16_bf16 v[32:47], v[52:55], v[80:83], v[32:47]
    v_add_f32 v85, v85, v142
    v_lshlrev_b32 v141, 16, v133
    v_and_b32 v142, 0xffff0000, v133
    v_fmac_f32 v86, v141, v141
    v_add_f32 v84, v84, v141
    v_fmac_f32 v87, v142, v142
    v_add_f32 v85, v85, v142
    s_waitcnt lgkmcnt(4)
    v_mfma_f32_32x32x16_bf16 v[16:31], v[60:63], v[56:59], v[16:31]
    ds_read_b128 v[72:75], v8 offset:40960
    ds_read_b64_tr_b16 v[76:77], v9 offset:47104
    ds_read_b64_tr_b16 v[78:79], v9 offset:47616
    v_lshlrev_b32 v141, 16, v134
    v_and_b32 v142, 0xffff0000, v134
    v_fmac_f32 v86, v141, v141
    v_add_f32 v84, v84, v141
    v_fmac_f32 v87, v142, v142
    v_mfma_f32_32x32x16_bf16 v[32:47], v[60:63], v[80:83], v[32:47]
    v_add_f32 v85, v85, v142
    v_lshlrev_b32 v141, 16, v135
    v_and_b32 v142, 0xffff0000, v135
    v_fmac_f32 v86, v141, v141
    v_add_f32 v84, v84, v141
    v_fmac_f32 v87, v142, v142
    v_add_f32 v85, v85, v142
    s_waitcnt lgkmcnt(3)
    v_mfma_f32_32x32x16_bf16 v[16:31], v[68:71], v[64:67], v[16:31]
    s_waitcnt vmcnt(0)
    s_mov_b64 exec, 1
    ds_add_u32 v15, v143 offset:12
    s_mov_b64 exec, -1
L_front_kernel_ls_11:
    ds_read_b32 v0, v15 offset:12
    s_waitcnt lgkmcnt(0)
    v_cmp_ne_u32 vcc, 4, v0
    s_cbranch_vccnz L_front_kernel_ls_11
    ds_read_b128 v[48:51], v5 offset:49152
    ds_read_b64_tr_b16 v[52:53], v9 offset:49152
    ds_read_b64_tr_b16 v[54:55], v9 offset:49664
    ds_read_b128 v[132:135], v130 offset:49152
    v_lshlrev_b32 v141, 16, v136
    v_and_b32 v142, 0xffff0000, v136
    v_fmac_f32 v86, v141, v141
    v_add_f32 v84, v84, v141
    v_fmac_f32 v87, v142, v142
    v_mfma_f32_32x32x16_bf16 v[32:47], v[68:71], v[80:83], v[32:47]
    v_add_f32 v85, v85, v142
    v_lshlrev_b32 v141, 16, v137
    v_and_b32 v142, 0xffff0000, v137
    v_fmac_f32 v86, v141, v141
    v_add_f32 v84, v84, v141
    v_fmac_f32 v87, v142, v142
    v_add_f32 v85, v85, v142
    s_waitcnt lgkmcnt(4)
    v_mfma_f32_32x32x16_bf16 v[16:31], v[76:79], v[72:75], v[16:31]
    ds_read_b128 v[56:59], v6 offset:49152
    ds_read_b64_tr_b16 v[60:61], v9 offset:51200
    ds_read_b64_tr_b16 v[62:63], v9 offset:51712
    v_lshlrev_b32 v141, 16, v138
    v_and_b32 v142, 0xffff0000, v138
    v_fmac_f32 v86, v141, v141
    v_add_f32 v84, v84, v141
    v_fmac_f32 v87, v142, v142
    v_mfma_f32_32x32x16_bf16 v[32:47], v[76:79], v[80:83], v[32:47]
    v_add_f32 v85, v85, v142
    v_lshlrev_b32 v141, 16, v139
    v_and_b32 v142, 0xffff0000, v139
    v_fmac_f32 v86, v141, v141
    v_add_f32 v84, v84, v141
    v_fmac_f32 v87, v142, v142
    v_add_f32 v85, v85, v142
    s_waitcnt lgkmcnt(3)
    v_mfma_f32_32x32x16_bf16 v[16:31], v[52:55], v[48:51], v[16:31]
    ds_read_b128 v[64:67], v7 offset:49152
    ds_read_b64_tr_b16 v[68:69], v9 offset:53248
    ds_read_b64_tr_b16 v[70:71], v9 offset:53760
    ds_read_b128 v[136:139], v131 offset:49152
    v_lshlrev_b32 v141, 16, v132
    v_and_b32 v142, 0xffff0000, v132
    v_fmac_f32 v86, v141, v141
    v_add_f32 v84, v84, v141
    v_fmac_f32 v87, v142, v142
    v_mfma_f32_32x32x16_bf16 v[32:47], v[52:55], v[80:83], v[32:47]
    v_add_f32 v85, v85, v142
    v_lshlrev_b32 v141, 16, v133
    v_and_b32 v142, 0xffff0000, v133
    v_fmac_f32 v86, v141, v141
    v_add_f32 v84, v84, v141
    v_fmac_f32 v87, v142, v142
    v_add_f32 v85, v85, v142
    s_waitcnt lgkmcnt(4)
    v_mfma_f32_32x32x16_bf16 v[16:31], v[60:63], v[56:59], v[16:31]
    ds_read_b128 v[72:75], v8 offset:49152
    ds_read_b64_tr_b16 v[76:77], v9 offset:55296
    ds_read_b64_tr_b16 v[78:79], v9 offset:55808
    v_lshlrev_b32 v141, 16, v134
    v_and_b32 v142, 0xffff0000, v134
    v_fmac_f32 v86, v141, v141
    v_add_f32 v84, v84, v141
    v_fmac_f32 v87, v142, v142
    v_mfma_f32_32x32x16_bf16 v[32:47], v[60:63], v[80:83], v[32:47]
    v_add_f32 v85, v85, v142
    v_lshlrev_b32 v141, 16, v135
    v_and_b32 v142, 0xffff0000, v135
    v_fmac_f32 v86, v141, v141
    v_add_f32 v84, v84, v141
    v_fmac_f32 v87, v142, v142
    v_add_f32 v85, v85, v142
    s_waitcnt lgkmcnt(3)
    v_mfma_f32_32x32x16_bf16 v[16:31], v[68:71], v[64:67], v[16:31]
    ds_read_b128 v[48:51], v5 offset:57344
    ds_read_b64_tr_b16 v[52:53], v9 offset:57344
    ds_read_b64_tr_b16 v[54:55], v9 offset:57856
    ds_read_b128 v[132:135], v130 offset:57344
    v_lshlrev_b32 v141, 16, v136
    v_and_b32 v142, 0xffff0000, v136
    v_fmac_f32 v86, v141, v141
    v_add_f32 v84, v84, v141
    v_fmac_f32 v87, v142, v142
    v_mfma_f32_32x32x16_bf16 v[32:47], v[68:71], v[80:83], v[32:47]
    v_add_f32 v85, v85, v142
    v_lshlrev_b32 v141, 16, v137
    v_and_b32 v142, 0xffff0000, v137
    v_fmac_f32 v86, v141, v141
    v_add_f32 v84, v84, v141
    v_fmac_f32 v87, v142, v142
    v_add_f32 v85, v85, v142
    s_waitcnt lgkmcnt(4)
    v_mfma_f32_32x32x16_bf16 v[16:31], v[76:79], v[72:75], v[16:31]
    ds_read_b128 v[56:59], v6 offset:57344
    ds_read_b64_tr_b16 v[60:61], v9 offset:59392
    ds_read_b64_tr_b16 v[62:63], v9 offset:59904
    v_lshlrev_b32 v141, 16, v138
    v_and_b32 v142, 0xffff0000, v138
    v_fmac_f32 v86, v141, v141
    v_add_f32 v84, v84, v141
    v_fmac_f32 v87, v142, v142
    v_mfma_f32_32x32x16_bf16 v[32:47], v[76:79], v[80:83], v[32:47]
    v_add_f32 v85, v85, v142
    v_lshlrev_b32 v141, 16, v139
    v_and_b32 v142, 0xffff0000, v139
    v_fmac_f32 v86, v141, v141
    v_add_f32 v84, v84, v141
    v_fmac_f32 v87, v142, v142
    v_add_f32 v85, v85, v142
    s_waitcnt lgkmcnt(3)
    v_mfma_f32_32x32x16_bf16 v[16:31], v[52:55], v[48:51], v[16:31]
    ds_read_b128 v[64:67], v7 offset:57344
    ds_read_b64_tr_b16 v[68:69], v9 offset:61440
    ds_read_b64_tr_b16 v[70:71], v9 offset:61952
    ds_read_b128 v[136:139], v131 offset:57344
    v_lshlrev_b32 v141, 16, v132
    v_and_b32 v142, 0xffff0000, v132
    v_fmac_f32 v86, v141, v141
    v_add_f32 v84, v84, v141
    v_fmac_f32 v87, v142, v142
    v_mfma_f32_32x32x16_bf16 v[32:47], v[52:55], v[80:83], v[32:47]
    v_add_f32 v85, v85, v142
    v_lshlrev_b32 v141, 16, v133
    v_and_b32 v142, 0xffff0000, v133
    v_fmac_f32 v86, v141, v141
    v_add_f32 v84, v84, v141
    v_fmac_f32 v87, v142, v142
    v_add_f32 v85, v85, v142
    s_waitcnt lgkmcnt(4)
    v_mfma_f32_32x32x16_bf16 v[16:31], v[60:63], v[56:59], v[16:31]
    ds_read_b128 v[72:75], v8 offset:57344
    ds_read_b64_tr_b16 v[76:77], v9 offset:63488
    ds_read_b64_tr_b16 v[78:79], v9 offset:64000
    v_lshlrev_b32 v141, 16, v134
    v_and_b32 v142, 0xffff0000, v134
    v_fmac_f32 v86, v141, v141
    v_add_f32 v84, v84, v141
    v_fmac_f32 v87, v142, v142
    v_mfma_f32_32x32x16_bf16 v[32:47], v[60:63], v[80:83], v[32:47]
    v_add_f32 v85, v85, v142
    v_lshlrev_b32 v141, 16, v135
    v_and_b32 v142, 0xffff0000, v135
    v_fmac_f32 v86, v141, v141
    v_add_f32 v84, v84, v141
    v_fmac_f32 v87, v142, v142
    v_add_f32 v85, v85, v142
    s_waitcnt lgkmcnt(3)
    v_mfma_f32_32x32x16_bf16 v[16:31], v[68:71], v[64:67], v[16:31]
    v_lshlrev_b32 v141, 16, v136
    v_and_b32 v142, 0xffff0000, v136
    v_fmac_f32 v86, v141, v141
    v_add_f32 v84, v84, v141
    v_fmac_f32 v87, v142, v142
    v_mfma_f32_32x32x16_bf16 v[32:47], v[68:71], v[80:83], v[32:47]
    v_add_f32 v85, v85, v142
    v_lshlrev_b32 v141, 16, v137
    v_and_b32 v142, 0xffff0000, v137
    v_fmac_f32 v86, v141, v141
    v_add_f32 v84, v84, v141
    v_fmac_f32 v87, v142, v142
    v_add_f32 v85, v85, v142
    s_waitcnt lgkmcnt(0)
    v_mfma_f32_32x32x16_bf16 v[16:31], v[76:79], v[72:75], v[16:31]
    v_lshlrev_b32 v141, 16, v138
    v_and_b32 v142, 0xffff0000, v138
    v_fmac_f32 v86, v141, v141
    v_add_f32 v84, v84, v141
    v_fmac_f32 v87, v142, v142
    v_mfma_f32_32x32x16_bf16 v[32:47], v[76:79], v[80:83], v[32:47]
    v_add_f32 v85, v85, v142
    v_lshlrev_b32 v141, 16, v139
    v_and_b32 v142, 0xffff0000, v139
    v_fmac_f32 v86, v141, v141
    v_add_f32 v84, v84, v141
    v_fmac_f32 v87, v142, v142
    v_add_f32 v85, v85, v142
    ds_read_b64_tr_b16 v[96:97], v10 offset:0
    ds_read_b64_tr_b16 v[98:99], v10 offset:128
    ds_read_b128 v[112:115], v11 offset:0
    ds_read_b64_tr_b16 v[100:101], v10 offset:1024
    ds_read_b64_tr_b16 v[102:103], v10 offset:1152
    ds_read_b128 v[116:119], v12 offset:0
    ds_read_b64_tr_b16 v[104:105], v10 offset:2048
    ds_read_b64_tr_b16 v[106:107], v10 offset:2176
    ds_read_b128 v[120:123], v11 offset:8192
    ds_read_b64_tr_b16 v[108:109], v10 offset:3072
    ds_read_b64_tr_b16 v[110:111], v10 offset:3200
    ds_read_b128 v[124:127], v12 offset:8192
    v_add_f32 v84, v84, v85
    v_add_f32 v85, v86, v87
    s_waitcnt lgkmcnt(0)
    ds_write_b64 v140, v[84:85] offset:3072
    v_mfma_f32_16x16x32_bf16 v[88:91], v[96:99], v[112:115], 0
    v_mfma_f32_16x16x32_bf16 v[92:95], v[96:99], v[80:83], 0
    v_mfma_f32_16x16x32_bf16 v[88:91], v[100:103], v[116:119], v[88:91]
    v_mfma_f32_16x16x32_bf16 v[92:95], v[100:103], v[80:83], v[92:95]
    v_mfma_f32_16x16x32_bf16 v[88:91], v[104:107], v[120:123], v[88:91]
    v_mfma_f32_16x16x32_bf16 v[92:95], v[104:107], v[80:83], v[92:95]
    v_mfma_f32_16x16x32_bf16 v[88:91], v[108:111], v[124:127], v[88:91]
    v_mfma_f32_16x16x32_bf16 v[92:95], v[108:111], v[80:83], v[92:95]
    s_lshl_b32 s65, s21, 14
    s_add_u32 s65, s65, 524288
    s_lshl_b32 s66, s20, 3
    s_add_u32 s66, s66, s21
    s_cmp_lt_u32 s66, 2
    s_cselect_b32 s65, s65, 2147418112
    s_add_u32 s97, s97, s65
    s_add_u32 s98, s98, s65
    v_xor_b32 v50, 0x1000, v140
    ds_write_b128 v140, v[88:91] offset:1024
    ds_write_b128 v140, v[92:95] offset:2048
    s_lshr_b32 s64, s3, 1
    s_lshl_b32 s65, s20, 1
    s_add_u32 s64, s64, s65
    s_lshl_b32 s64, s64, 15
    s_and_b32 s65, s3, 1
    s_lshl_b32 s67, s21, 1
    s_add_u32 s65, s65, s67
    s_lshl_b32 s65, s65, 11
    s_add_u32 s64, s64, s65
    s_add_u32 s64, s64, 7499776
    v_add_u32 v54, 131072, v2
    s_waitcnt lgkmcnt(0)
    s_mov_b64 exec, 1
    ds_add_u32 v15, v143 offset:16
    s_mov_b64 exec, -1
L_front_kernel_ls_12:
    ds_read_b32 v0, v15 offset:16
    s_waitcnt lgkmcnt(0)
    v_cmp_ne_u32 vcc, 4, v0
    s_cbranch_vccnz L_front_kernel_ls_12
    ds_read_b64 v[86:87], v50 offset:3072
    ds_read_b128 v[144:147], v54 offset:1024
    ds_read_b128 v[160:163], v54 offset:2048
    ds_read_b128 v[148:151], v54 offset:5120
    ds_read_b128 v[164:167], v54 offset:6144
    ds_read_b128 v[152:155], v54 offset:9216
    ds_read_b128 v[168:171], v54 offset:10240
    ds_read_b128 v[156:159], v54 offset:13312
    ds_read_b128 v[172:175], v54 offset:14336
    s_waitcnt lgkmcnt(8)
    v_add_f32 v84, v84, v86
    v_add_f32 v86, v85, v87
    v_mov_b32 v85, v84
    v_mov_b32 v87, v86
    s_nop 1
    v_permlane32_swap_b32 v84, v85
    v_permlane32_swap_b32 v86, v87
    s_nop 1
    v_add_f32 v84, v84, v85
    v_add_f32 v86, v86, v87
    v_mul_f32 v48, 0x3b000000, v84
    v_mul_f32 v50, 0x3b000000, v86
    v_fma_f32 v50, -v48, v48, v50
    v_max_f32 v50, 0, v50
    v_add_f32 v50, 0x3727c5ac, v50
    v_rsq_f32 v49, v50
    s_nop 0
    ds_bpermute_b32 v52, v13, v48
    ds_bpermute_b32 v53, v13, v49
    v_mul_f32 v51, 0x3eb8aa3b, v49
    v_fma_f32 v16, -v48, v32, v16
    v_mul_f32 v16, v51, v16
    v_fma_f32 v17, -v48, v33, v17
    v_mul_f32 v17, v51, v17
    v_fma_f32 v18, -v48, v34, v18
    v_mul_f32 v18, v51, v18
    v_fma_f32 v19, -v48, v35, v19
    v_mul_f32 v19, v51, v19
    v_fma_f32 v20, -v48, v36, v20
    v_mul_f32 v20, v51, v20
    v_fma_f32 v21, -v48, v37, v21
    v_mul_f32 v21, v51, v21
    v_fma_f32 v22, -v48, v38, v22
    v_mul_f32 v22, v51, v22
    v_fma_f32 v23, -v48, v39, v23
    v_mul_f32 v23, v51, v23
    v_cvt_pk_bf16_f32 v56, v16, v17
    v_cvt_pk_bf16_f32 v57, v18, v19
    v_cvt_pk_bf16_f32 v58, v20, v21
    v_cvt_pk_bf16_f32 v59, v22, v23
    buffer_store_dwordx4 v[56:59], v2, s[4:7], s64 offen offset:0
    v_fma_f32 v24, -v48, v40, v24
    v_mul_f32 v24, v51, v24
    v_fma_f32 v25, -v48, v41, v25
    v_mul_f32 v25, v51, v25
    v_fma_f32 v26, -v48, v42, v26
    v_mul_f32 v26, v51, v26
    v_fma_f32 v27, -v48, v43, v27
    v_mul_f32 v27, v51, v27
    v_fma_f32 v28, -v48, v44, v28
    v_mul_f32 v28, v51, v28
    v_fma_f32 v29, -v48, v45, v29
    v_mul_f32 v29, v51, v29
    v_fma_f32 v30, -v48, v46, v30
    v_mul_f32 v30, v51, v30
    v_fma_f32 v31, -v48, v47, v31
    v_mul_f32 v31, v51, v31
    v_cvt_pk_bf16_f32 v60, v24, v25
    v_cvt_pk_bf16_f32 v61, v26, v27
    v_cvt_pk_bf16_f32 v62, v28, v29
    v_cvt_pk_bf16_f32 v63, v30, v31
    buffer_store_dwordx4 v[60:63], v2, s[4:7], s64 offen offset:1024
    s_waitcnt lgkmcnt(0)
    v_add_f32 v144, v144, v148
    v_add_f32 v152, v152, v156
    v_add_f32 v144, v144, v152
    v_add_f32 v145, v145, v149
    v_add_f32 v153, v153, v157
    v_add_f32 v145, v145, v153
    v_add_f32 v146, v146, v150
    v_add_f32 v154, v154, v158
    v_add_f32 v146, v146, v154
    v_add_f32 v147, v147, v151
    v_add_f32 v155, v155, v159
    v_add_f32 v147, v147, v155
    v_add_f32 v160, v160, v164
    v_add_f32 v168, v168, v172
    v_add_f32 v160, v160, v168
    v_add_f32 v161, v161, v165
    v_add_f32 v169, v169, v173
    v_add_f32 v161, v161, v169
    v_add_f32 v162, v162, v166
    v_add_f32 v170, v170, v174
    v_add_f32 v162, v162, v170
    v_add_f32 v163, v163, v167
    v_add_f32 v171, v171, v175
    v_add_f32 v163, v163, v171
    v_fma_f32 v144, -v52, v160, v144
    v_mul_f32 v144, v53, v144
    v_fma_f32 v145, -v52, v161, v145
    v_mul_f32 v145, v53, v145
    v_fma_f32 v146, -v52, v162, v146
    v_mul_f32 v146, v53, v146
    v_fma_f32 v147, -v52, v163, v147
    v_mul_f32 v147, v53, v147
    v_cvt_pk_bf16_f32 v148, v144, v145
    v_cvt_pk_bf16_f32 v149, v146, v147
    s_lshr_b32 s64, s21, 2
    s_lshl_b32 s65, s20, 1
    s_add_u32 s65, s65, s64
    s_lshr_b32 s67, s65, 3
    s_mul_i32 s67, s67, 17408
    s_and_b32 s65, s65, 7
    s_mul_i32 s65, s65, 2080
    s_add_u32 s65, s65, s67
    s_add_u32 s65, s65, 14315520
    s_lshl_b32 s64, s64, 1
    s_cmp_eq_u32 s64, s3
    s_cselect_b32 s65, s65, 2147418112
    buffer_store_short v148, v14, s[4:7], s65 offen
    s_add_u32 s65, s65, s71
    buffer_store_short_d16_hi v148, v14, s[4:7], s65 offen
    s_add_u32 s65, s65, s71
    buffer_store_short v149, v14, s[4:7], s65 offen
    s_add_u32 s65, s65, s71
    buffer_store_short_d16_hi v149, v14, s[4:7], s65 offen
    s_cmp_lg_u32 s20, 0
    s_cbranch_scc1 L_front_kernel_noimg_13
    v_lshrrev_b32 v21, 4, v1
    v_lshlrev_b32 v21, 4, v21
    s_lshl_b32 s65, s21, 6
    s_add_u32 s65, s65, 5310464
    s_cmp_lt_u32 s66, 2
    s_cselect_b32 s65, s65, 2147418112
    buffer_store_dwordx4 v[160:163], v21, s[4:7], s65 offen
    v_lshrrev_b32 v18, 5, v1
    v_lshlrev_b32 v18, 6, v18
    s_lshl_b32 s64, s21, 1
    s_add_u32 s64, s64, s3
    s_lshl_b32 s64, s64, 7
    s_add_u32 s64, s64, 5308416
    s_cmp_lt_u32 s3, 2
    s_cselect_b32 s64, s64, 2147418112
    buffer_store_dwordx4 v[32:35], v18, s[4:7], s64 offen offset:0
    buffer_store_dwordx4 v[36:39], v18, s[4:7], s64 offen offset:16
    buffer_store_dwordx4 v[40:43], v18, s[4:7], s64 offen offset:32
    buffer_store_dwordx4 v[44:47], v18, s[4:7], s64 offen offset:48
    buffer_store_dwordx4 v[96:99], v2, s[4:7], s97 offen offset:0
    buffer_store_dwordx4 v[100:103], v2, s[4:7], s97 offen offset:1024
    buffer_store_dwordx4 v[104:107], v2, s[4:7], s98 offen offset:0
    buffer_store_dwordx4 v[108:111], v2, s[4:7], s98 offen offset:1024
L_front_kernel_noimg_13:
    s_endpgm
L_front_kernel_B_7:
    s_sub_u32 s3, s3, 4
    s_mov_b32 s49, 31
    s_mov_b32 s51, 0
    s_mov_b32 s53, 2147418112
    s_movk_i32 s46, 1024
    s_mov_b32 s52, 64
    s_mov_b32 s62, 32768
    s_and_b32 s65, s2, 3
    s_lshl_b32 s48, s65, 3
    s_waitcnt lgkmcnt(0)
    s_cmp_ge_u32 s2, 164
    s_cbranch_scc1 L_front_kernel_misc_6
    s_cmp_ge_u32 s2, 120
    s_cbranch_scc1 L_front_kernel_wd_4
    s_cmp_ge_u32 s2, 104
    s_cbranch_scc1 L_front_kernel_wo_3
    s_cmp_ge_u32 s2, 16
    s_cbranch_scc1 L_front_kernel_gu_2
    s_and_b32 s64, s2, 12
    s_lshl_b32 s66, s64, 6
    s_add_u32 s42, s26, s66
    s_addc_u32 s43, s27, 0
    s_add_u32 s44, s42, 32
    s_addc_u32 s45, s43, 0
    s_lshl_b32 s50, s64, 15
    s_add_u32 s50, s50, 0
    s_branch L_front_kernel_go_5
L_front_kernel_gu_2:
    s_movk_i32 s46, 2752
    s_mov_b32 s52, 32
    s_sub_u32 s64, s2, 16
    s_andn2_b32 s64, s64, 3
    s_min_u32 s64, s64, 82
    s_lshl_b32 s66, s64, 5
    s_add_u32 s42, s36, s66
    s_addc_u32 s43, s37, 0
    s_add_u32 s44, s38, s66
    s_addc_u32 s45, s39, 0
    s_lshl_b32 s50, s64, 15
    s_add_u32 s50, s50, 1081344
    s_add_u32 s53, s64, s3
    s_lshl_b32 s53, s53, 10
    s_lshr_b32 s66, s65, 1
    s_lshl_b32 s66, s66, 9
    s_add_u32 s53, s53, s66
    s_and_b32 s66, s65, 1
    s_lshl_b32 s66, s66, 3
    s_add_u32 s53, s53, s66
    s_add_u32 s53, s53, 5312512
    s_branch L_front_kernel_go_5
L_front_kernel_wo_3:
    s_sub_u32 s64, s2, 104
    s_andn2_b32 s64, s64, 3
    s_lshl_b32 s66, s64, 6
    s_add_u32 s42, s32, s66
    s_addc_u32 s43, s33, 0
    s_add_u32 s44, s42, 32
    s_addc_u32 s45, s43, 0
    s_lshl_b32 s50, s64, 15
    s_add_u32 s50, s50, 557056
    s_branch L_front_kernel_go_5
L_front_kernel_wd_4:
    s_mov_b32 s51, 1
    s_mov_b32 s62, 88064
    s_sub_u32 s64, s2, 120
    s_lshr_b32 s64, s64, 2
    s_lshl_b32 s48, s64, 3
    s_mov_b32 s49, 85
    s_lshl_b32 s66, s65, 8
    s_add_u32 s42, s40, s66
    s_addc_u32 s43, s41, 0
    s_add_u32 s44, s42, 32
    s_addc_u32 s45, s43, 0
    s_mul_i32 s50, s65, 352256
    s_add_u32 s50, s50, 3899392
L_front_kernel_go_5:
    v_lshrrev_b32 v16, 4, v1
    v_mul_lo_u32 v16, v16, s46
    v_bfe_u32 v17, v1, 1, 2
    v_mul_lo_u32 v17, v17, s52
    v_add_u32 v16, v16, v17
    v_and_b32 v17, 1, v1
    v_lshl_add_u32 v16, v17, 4, v16
    v_and_b32 v17, 8, v1
    v_cmp_ne_u32 vcc, 0, v17
    v_mov_b32 v18, s42
    v_mov_b32 v19, s43
    v_mov_b32 v20, s44
    v_mov_b32 v21, s45
    v_cndmask_b32 v18, v18, v20, vcc
    v_cndmask_b32 v19, v19, v21, vcc
    v_add_co_u32 v18, vcc, v18, v16
    s_lshl_b32 s63, s46, 4
    s_mov_b32 s67, 0
    v_addc_co_u32 v19, vcc, 0, v19, vcc
    s_lshl_b32 s68, s46, 2
    s_mov_b32 s69, 0
    s_lshl_b32 s64, s3, 1
    s_add_u32 s48, s48, s64
    s_add_u32 s64, s48, 0
    s_min_u32 s64, s64, s49
    s_and_b32 s65, s64, 15
    s_min_u32 s66, s65, 6
    s_mul_i32 s65, s65, 5
    s_add_u32 s65, s65, s66
    s_lshr_b32 s66, s64, 4
    s_add_u32 s65, s65, s66
    s_cmp_eq_u32 s51, 1
    s_cselect_b32 s65, s65, s64
    s_mul_i32 s66, s65, s63
    s_lshl_b32 s64, s64, 10
    s_add_u32 s54, s64, s50
    v_lshl_add_u64 v[20:21], v[18:19], 0, s[66:67]
    global_load_dwordx4 v[96:99], v[20:21], off
    v_lshl_add_u64 v[20:21], v[20:21], 0, s[68:69]
    global_load_dwordx4 v[100:103], v[20:21], off
    v_lshl_add_u64 v[20:21], v[20:21], 0, s[68:69]
    global_load_dwordx4 v[104:107], v[20:21], off
    v_lshl_add_u64 v[20:21], v[20:21], 0, s[68:69]
    global_load_dwordx4 v[108:111], v[20:21], off
    s_add_u32 s64, s48, 1
    s_min_u32 s64, s64, s49
    s_and_b32 s65, s64, 15
    s_min_u32 s66, s65, 6
    s_mul_i32 s65, s65, 5
    s_add_u32 s65, s65, s66
    s_lshr_b32 s66, s64, 4
    s_add_u32 s65, s65, s66
    s_cmp_eq_u32 s51, 1
    s_cselect_b32 s65, s65, s64
    s_mul_i32 s66, s65, s63
    s_lshl_b32 s64, s64, 10
    s_add_u32 s55, s64, s50
    v_lshl_add_u64 v[20:21], v[18:19], 0, s[66:67]
    global_load_dwordx4 v[112:115], v[20:21], off
    v_lshl_add_u64 v[20:21], v[20:21], 0, s[68:69]
    global_load_dwordx4 v[116:119], v[20:21], off
    v_lshl_add_u64 v[20:21], v[20:21], 0, s[68:69]
    global_load_dwordx4 v[120:123], v[20:21], off
    v_lshl_add_u64 v[20:21], v[20:21], 0, s[68:69]
    global_load_dwordx4 v[124:127], v[20:21], off
    s_lshl_b32 s64, s3, 11
    s_add_u32 s64, s64, 147456
    v_add_u32 v3, s64, v2
    v_and_b32 v16, 1, v1
    v_lshlrev_b32 v16, 4, v16
    v_and_b32 v17, 2, v1
    v_lshl_add_u32 v16, v17, 2, v16
    v_and_b32 v17, 16, v1
    v_lshl_add_u32 v16, v17, 3, v16
    v_bfe_u32 v17, v1, 2, 2
    v_lshrrev_b32 v22, 5, v1
    v_lshl_add_u32 v23, v22, 2, v17
    v_lshl_add_u32 v4, v23, 8, v16
    v_add_u32 v4, s64, v4
    v_lshlrev_b32 v5, 6, v22
    v_add_u32 v5, s64, v5
    s_waitcnt vmcnt(4)
    ds_write_b128 v3, v[96:99]
    ds_write_b128 v3, v[104:107] offset:1024
    s_waitcnt lgkmcnt(0)
    ds_read_b64_tr_b16 v[128:129], v4 offset:0
    ds_read_b64_tr_b16 v[132:133], v4 offset:32
    ds_read_b64_tr_b16 v[136:137], v4 offset:64
    ds_read_b64_tr_b16 v[140:141], v4 offset:96
    s_waitcnt lgkmcnt(0)
    ds_write_b128 v3, v[100:103]
    ds_write_b128 v3, v[108:111] offset:1024
    s_waitcnt lgkmcnt(0)
    ds_read_b64_tr_b16 v[130:131], v4 offset:0
    ds_read_b64_tr_b16 v[134:135], v4 offset:32
    ds_read_b64_tr_b16 v[138:139], v4 offset:64
    ds_read_b64_tr_b16 v[142:143], v4 offset:96
    s_waitcnt lgkmcnt(0)
    buffer_store_dwordx4 v[128:131], v2, s[4:7], s54 offen
    s_add_u32 s54, s54, s62
    buffer_store_dwordx4 v[132:135], v2, s[4:7], s54 offen
    s_add_u32 s54, s54, s62
    buffer_store_dwordx4 v[136:139], v2, s[4:7], s54 offen
    s_add_u32 s54, s54, s62
    buffer_store_dwordx4 v[140:143], v2, s[4:7], s54 offen
    s_waitcnt vmcnt(4)
    ds_write_b128 v3, v[112:115]
    ds_write_b128 v3, v[120:123] offset:1024
    s_waitcnt lgkmcnt(0)
    ds_read_b64_tr_b16 v[144:145], v4 offset:0
    ds_read_b64_tr_b16 v[148:149], v4 offset:32
    ds_read_b64_tr_b16 v[152:153], v4 offset:64
    ds_read_b64_tr_b16 v[156:157], v4 offset:96
    s_waitcnt lgkmcnt(0)
    ds_write_b128 v3, v[116:119]
    ds_write_b128 v3, v[124:127] offset:1024
    s_waitcnt lgkmcnt(0)
    ds_read_b64_tr_b16 v[146:147], v4 offset:0
    ds_read_b64_tr_b16 v[150:151], v4 offset:32
    ds_read_b64_tr_b16 v[154:155], v4 offset:64
    ds_read_b64_tr_b16 v[158:159], v4 offset:96
    s_waitcnt lgkmcnt(0)
    buffer_store_dwordx4 v[144:147], v2, s[4:7], s55 offen
    s_add_u32 s55, s55, s62
    buffer_store_dwordx4 v[148:151], v2, s[4:7], s55 offen
    s_add_u32 s55, s55, s62
    buffer_store_dwordx4 v[152:155], v2, s[4:7], s55 offen
    s_add_u32 s55, s55, s62
    buffer_store_dwordx4 v[156:159], v2, s[4:7], s55 offen
    s_cmp_lg_u32 s52, 32
    s_cbranch_scc1 L_front_kernel_end_1
    v_mfma_f32_32x32x16_bf16 v[160:175], v[128:131], v[80:83], 0
    v_mfma_f32_32x32x16_bf16 v[176:191], v[132:135], v[80:83], 0
    v_mfma_f32_32x32x16_bf16 v[192:207], v[136:139], v[80:83], 0
    v_mfma_f32_32x32x16_bf16 v[208:223], v[140:143], v[80:83], 0
    v_mfma_f32_32x32x16_bf16 v[160:175], v[144:147], v[80:83], v[160:175]
    v_mfma_f32_32x32x16_bf16 v[176:191], v[148:151], v[80:83], v[176:191]
    v_mfma_f32_32x32x16_bf16 v[192:207], v[152:155], v[80:83], v[192:207]
    v_mfma_f32_32x32x16_bf16 v[208:223], v[156:159], v[80:83], v[208:223]
    v_and_b32 v20, 3, v1
    v_and_b32 v21, 4, v1
    v_lshl_or_b32 v20, v21, 2, v20
    v_and_b32 v21, 24, v1
    v_lshrrev_b32 v21, 1, v21
    v_or_b32 v20, v20, v21
    v_lshlrev_b32 v20, 2, v20
    s_lshl_b32 s64, s3, 7
    s_add_u32 s64, s64, 147456
    v_add_u32 v20, s64, v20
    v_and_b32 v21, 0x1f0, v2
    s_nop 3
    s_mov_b32 exec_lo, 1
    s_mov_b32 exec_hi, 1
    ds_write_b128 v5, v[160:163] offset:0
    ds_write_b128 v5, v[164:167] offset:16
    ds_write_b128 v5, v[168:171] offset:32
    ds_write_b128 v5, v[172:175] offset:48
    ds_write_b128 v5, v[176:179] offset:128
    ds_write_b128 v5, v[180:183] offset:144
    ds_write_b128 v5, v[184:187] offset:160
    ds_write_b128 v5, v[188:191] offset:176
    ds_write_b128 v5, v[192:195] offset:256
    ds_write_b128 v5, v[196:199] offset:272
    ds_write_b128 v5, v[200:203] offset:288
    ds_write_b128 v5, v[204:207] offset:304
    ds_write_b128 v5, v[208:211] offset:384
    ds_write_b128 v5, v[212:215] offset:400
    ds_write_b128 v5, v[216:219] offset:416
    ds_write_b128 v5, v[220:223] offset:432
    s_mov_b64 exec, -1
    s_waitcnt lgkmcnt(0)
    v_mov_b32 v143, 1
    s_mov_b64 exec, 1
    ds_add_u32 v15, v143 offset:32
    s_mov_b64 exec, -1
L_front_kernel_ls_14:
    ds_read_b32 v0, v15 offset:32
    s_waitcnt lgkmcnt(0)
    v_cmp_ne_u32 vcc, 4, v0
    s_cbranch_vccnz L_front_kernel_ls_14
    ds_read_b32 v22, v20
    ds_read_b32 v23, v20 offset:2048
    ds_read_b32 v24, v20 offset:4096
    ds_read_b32 v25, v20 offset:6144
    s_waitcnt lgkmcnt(0)
    v_add_f32 v22, v22, v23
    v_add_f32 v24, v24, v25
    v_add_f32 v22, v22, v24
    v_cvt_pk_bf16_f32 v23, v22, v22
    v_and_b32 v24, 0xffff0000, v23
    v_sub_f32 v24, v22, v24
    v_cvt_pk_bf16_f32 v26, v22, v24
    v_and_b32 v27, 0xffff, v23
    buffer_store_dwordx2 v[26:27], v21, s[4:7], s53 offen
    s_endpgm
L_front_kernel_misc_6:
    s_sub_u32 s64, s2, 164
    s_lshl_b32 s64, s64, 8
    v_subrev_u32 v24, 256, v0
    v_add_u32 v16, s64, v24
    v_min_u32 v17, 10503, v16
    v_lshlrev_b32 v17, 7, v17
    v_mov_b32 v22, 0
    s_mov_b32 s65, 35205120
    buffer_store_dword v22, v17, s[4:7], s65 offen
    s_lshr_b32 s65, s64, 9
    s_and_b32 s66, s65, 1
    s_mul_i32 s66, s66, 139264
    s_lshr_b32 s65, s65, 1
    s_mul_i32 s65, s65, 14901248
    s_add_u32 s65, s65, s66
    s_add_u32 s65, s65, 14317568
    s_cmp_lt_u32 s64, 1536
    s_cselect_b32 s65, s65, 2147418112
    v_bfe_u32 v17, v16, 6, 3
    v_mul_u32_u24 v17, 17408, v17
    v_bfe_u32 v23, v16, 3, 3
    v_mul_u32_u24 v23, 2080, v23
    v_add_u32 v17, v17, v23
    v_and_b32 v23, 7, v16
    v_cmp_gt_u32 vcc, 4, v23
    v_lshl_add_u32 v17, v23, 2, v17
    v_mov_b32 v23, 0x3f803f80
    v_cndmask_b32 v23, v22, v23, vcc
    buffer_store_dword v23, v17, s[4:7], s65 offen
    s_getpc_b64 s[72:73]
L_front_pc:
    s_add_u32 s72, s72, main_kernel-L_front_pc
    s_addc_u32 s73, s73, 0
    s_lshr_b32 s64, s2, 3
    s_sub_u32 s64, s64, 21
    s_max_i32 s64, s64, 0
    s_lshl_b32 s64, s64, 2
    s_add_u32 s64, s64, s3
    s_lshl_b32 s64, s64, 11
    v_and_b32 v16, 15, v1
    v_lshlrev_b32 v16, 7, v16
    v_add_u32 v16, s64, v16
    v_min_u32 v16, L_main_end-main_kernel-4, v16
    global_load_dword v0, v16, s[72:73]
    s_sub_u32 s64, s2, 164
    s_lshl_b32 s64, s64, 8
    v_add_u32 v16, s64, v24
    v_mul_u32_u24 v17, 7711, v16
    v_lshrrev_b32 v17, 23, v17
    v_mul_u32_u24 v17, 1088, v17
    v_sub_u32 v17, v16, v17
    v_mul_u32_u24 v18, 1009, v17
    v_lshrrev_b32 v18, 17, v18
    v_mul_u32_u24 v18, 130, v18
    v_sub_u32 v18, v17, v18
    v_cmp_eq_u32 vcc, 128, v18
    v_mov_b32 v19, 0x3f803f80
    v_lshlrev_b32 v16, 4, v16
    v_cndmask_b32 v28, v22, v19, vcc
    s_mov_b32 s65, 29356032
    s_cmp_lt_u32 s64, 8704
    s_cselect_b32 s65, s65, 2147418112
    v_mov_b32 v29, v28
    v_mov_b32 v30, v28
    v_mov_b32 v31, v28
    buffer_store_dwordx4 v[28:31], v16, s[4:7], s65 offen
L_front_kernel_end_1:
    s_endpgm
.section .rodata,"a"
.p2align 6
.amdhsa_kernel front_kernel
  .amdhsa_next_free_vgpr 224
  .amdhsa_next_free_sgpr 102
  .amdhsa_accum_offset 224
  .amdhsa_group_segment_fixed_size 0
  .amdhsa_kernarg_size 96
  .amdhsa_user_sgpr_count 2
  .amdhsa_user_sgpr_kernarg_segment_ptr 1
  .amdhsa_system_sgpr_workgroup_id_x 1
.end_amdhsa_kernel
.text
.globl main_kernel
.p2align 8
.type main_kernel,@function
main_kernel:
    s_cmp_ge_u32 s2, 256
    s_cbranch_scc1 L_main_kernel_end_1
    s_load_dwordx2 s[4:5], s[0:1], 88
    s_load_dwordx2 s[8:9], s[0:1], 72
    s_load_dwordx2 s[44:45], s[0:1], 0
    s_mov_b32 s46, 2097152
    s_mov_b32 s47, 0x20000
    v_and_b32 v1, 63, v0
    v_lshrrev_b32 v2, 6, v0
    s_mov_b32 s6, 37666816
    v_readfirstlane_b32 s3, v2
    s_mov_b32 s7, 0x20000
    s_mov_b32 s10, 2097152
    s_mov_b32 s11, 0x20000
    v_mov_b32 v8, 0
    s_getreg_b32 s12, hwreg(HW_REG_XCC_ID)
    s_and_b32 s12, s12, 7
    s_lshl_b32 s38, s12, 7
    s_add_u32 s38, s38, 36548608
    v_mov_b32 v12, 1
    s_waitcnt lgkmcnt(0)
    s_cmp_lg_u32 s3, 0
    s_cbranch_scc1 L_main_kernel_tw_2
    s_mov_b64 exec, 1
    buffer_atomic_add v12, v8, s[4:7], s38 offen sc0
    s_mov_b64 exec, -1
L_main_kernel_tw_2:
    v_lshlrev_b32 v2, 4, v1
    v_and_b32 v3, 15, v1
    v_lshlrev_b32 v3, 7, v3
    v_lshlrev_b32 v4, 7, v1
    v_and_b32 v14, 31, v1
    v_lshrrev_b32 v13, 5, v1
    v_lshlrev_b32 v5, 8, v14
    v_lshl_add_u32 v5, v13, 7, v5
    v_and_b32 v15, 3, v1
    v_xor_b32 v15, s3, v15
    v_lshl_add_u32 v5, v15, 5, v5
    v_lshlrev_b32 v6, 3, v14
    v_lshl_add_u32 v6, v13, 17, v6
    v_lshlrev_b32 v7, 6, v13
    s_lshl_b32 s26, s3, 13
    s_lshl_b32 s27, s3, 12
    s_lshl_b32 s101, s3, 11
    s_mul_i32 s37, s12, 17408
    s_add_u32 s39, s37, s27
    s_add_u32 m0, s27, 24576
    s_add_u32 s43, s39, 14315520
    buffer_load_dwordx4 v2, s[4:7], s43 offen offset:0  lds
    buffer_load_dwordx4 v2, s[4:7], s43 offen offset:1024  lds
    buffer_load_dwordx4 v2, s[4:7], s43 offen offset:2048  lds
    buffer_load_dwordx4 v2, s[4:7], s43 offen offset:3072  lds
    s_mov_b32 m0, 40960
    s_add_u32 s43, s37, 14331904
    buffer_load_dwordx4 v2, s[4:7], s43 offen offset:0  lds
    s_lshr_b32 s42, s2, 3
    s_and_b32 s42, s42, 31
    s_lshl_b32 s42, s42, 13
    s_lshl_b32 s43, s12, 18
    s_add_u32 s42, s42, s43
    s_add_u32 s42, s42, s101
    s_add_u32 s42, s42, 7499776
    buffer_load_dword v0, v3, s[4:7], s42 offen
    v_lshrrev_b32 v121, 3, v1
    v_lshlrev_b32 v121, 9, v121
    v_and_b32 v14, 0x70, v2
    v_lshlrev_b32 v13, 1, v1
    v_and_b32 v13, 0x60, v13
    v_xor_b32 v14, v14, v13
    v_add_u32 v121, v121, v14
    v_mov_b32 v112, 0xdddddddd
    v_add_u32 v113, 24576, v2
    v_and_b32 v14, 15, v1
    v_lshlrev_b32 v14, 4, v14
    v_lshrrev_b32 v13, 5, v1
    v_lshl_add_u32 v14, v13, 8, v14
    v_add_u32 v114, 25600, v14
    v_add_u32 v115, 26112, v14
    v_and_b32 v14, 27, v1
    v_cmp_eq_u32 vcc, 16, v14
    v_mov_b32 v14, 26640
    v_mov_b32 v13, 26624
    v_cndmask_b32 v14, v14, v13, vcc
    v_and_b32 v13, 16, v1
    v_cmp_ne_u32 vcc, 0, v13
    s_nop 1
    v_cndmask_b32 v114, v114, v14, vcc
    v_cndmask_b32 v115, v115, v14, vcc
    v_mov_b32 v24, 0
    v_mov_b32 v25, 0
    v_mov_b32 v26, 0
    v_mov_b32 v27, 0
    v_mov_b32 v28, 0
    v_mov_b32 v29, 0
    v_mov_b32 v30, 0
    v_mov_b32 v31, 0
    v_mov_b32 v32, 0
    v_mov_b32 v33, 0
    v_mov_b32 v34, 0
    v_mov_b32 v35, 0
    v_mov_b32 v36, 0
    v_mov_b32 v37, 0
    v_mov_b32 v38, 0
    v_mov_b32 v39, 0
    v_mov_b32 v40, 0
    v_mov_b32 v41, 0
    v_mov_b32 v42, 0
    v_mov_b32 v43, 0
    v_mov_b32 v44, 0
    v_mov_b32 v45, 0
    v_mov_b32 v46, 0
    v_mov_b32 v47, 0
    v_mov_b32 v48, 0
    v_mov_b32 v49, 0
    v_mov_b32 v50, 0
    v_mov_b32 v51, 0
    v_mov_b32 v52, 0
    v_mov_b32 v53, 0
    v_mov_b32 v54, 0
    v_mov_b32 v55, 0
    v_min_u32 v118, 4, v1
    v_lshlrev_b32 v118, 17, v118
    v_min_u32 v119, 2176, v4
    v_and_b32 v120, 0x380, v3
    v_and_b32 v117, 0x80, v3
    v_and_b32 v122, 0xf80, v4
    v_lshlrev_b32 v123, 2, v1
    v_and_b32 v124, 0x180, v3
    s_cmp_lg_u32 s3, 0
    s_cbranch_scc1 L_main_kernel_tw2_3
    s_waitcnt vmcnt(0)
    s_mov_b64 exec, 1
    ds_write_b32 v8, v12 offset:16384
    s_mov_b64 exec, -1
    s_waitcnt lgkmcnt(0)
L_main_kernel_tw2_3:
    s_barrier
    ds_read_b32 v12, v8 offset:16384
    s_waitcnt lgkmcnt(0)
    v_readfirstlane_b32 s13, v12
    s_nop 3
    s_cmp_ge_u32 s13, 32
    s_cbranch_scc1 L_main_kernel_end_1
    s_lshl_b32 s41, s12, 3
    s_lshr_b32 s42, s13, 2
    s_add_u32 s38, s41, s42
    s_lshl_b32 s17, s38, 15
    s_and_b32 s42, s13, 3
    s_lshl_b32 s43, s42, 7
    s_add_u32 s31, s26, s43
    s_add_u32 s31, s31, s17
    s_add_u32 m0, s101, 0
    s_add_u32 s43, s31, 7499776
    buffer_load_dwordx4 v121, s[4:7], s43 offen lds
    s_add_u32 m0, s101, 1024
    s_add_u32 s43, s31, 7503872
    buffer_load_dwordx4 v121, s[4:7], s43 offen lds
    s_lshl_b32 s33, s38, 8
    s_lshl_b32 s43, s42, 2
    s_add_u32 s14, s43, s3
    s_lshl_b32 s23, s14, 15
    s_and_b32 s42, s13, 1
    s_lshl_b32 s42, s42, 14
    s_add_u32 s100, s42, s27
    s_lshr_b32 s42, s13, 4
    s_lshl_b32 s42, s42, 2
    s_add_u32 s39, s41, s42
    s_add_u32 s39, s39, s3
    s_and_b32 s15, s13, 15
    s_min_u32 s41, s15, 6
    s_mul_i32 s40, s15, 5
    s_add_u32 s40, s40, s41
    s_lshl_b32 s41, s14, 11
    s_add_u32 s16, s17, s41
    s_lshl_b32 s19, s38, 11
    s_lshl_b32 s41, s14, 7
    s_add_u32 s18, s19, s41
    s_lshl_b32 s20, s39, 11
    s_lshl_b32 s41, s15, 7
    s_add_u32 s21, s20, s41
    s_lshl_b32 s22, s39, 15
    s_mul_i32 s24, s14, 88064
    s_lshl_b32 s25, s40, 15
    s_add_u32 s25, s25, s26
    s_mul_i32 s28, s39, 88064
    s_lshl_b32 s41, s15, 10
    s_add_u32 s28, s28, s41
    s_mul_i32 s29, s38, 88064
    s_add_u32 s29, s29, s27
    s_lshl_b32 s41, s14, 14
    s_add_u32 s30, s41, s33
    s_mul_i32 s32, s12, 17408
    s_and_b32 s41, s38, 7
    s_mul_i32 s41, s41, 2080
    s_add_u32 s32, s32, s41
    s_lshl_b32 s34, s39, 8
    s_lshl_b32 s35, s40, 10
    s_lshr_b32 s36, s13, 2
    s_lshl_b32 s36, s36, 12
    s_getpc_b64 s[92:93]
L_main_pc:
    s_sub_u32 s92, s92, L_main_pc-main_kernel
    s_subb_u32 s93, s93, 0
    s_lshl_b32 s41, s13, 2
    s_add_u32 s41, s41, s3
    s_lshl_b32 s41, s41, 9
    s_min_u32 s41, s41, L_main_end-main_kernel-512
    s_add_u32 s92, s92, s41
    s_addc_u32 s93, s93, 0
    s_add_u32 s41, s19, 131072
    s_lshl_b32 s42, s12, 14
    s_add_u32 s42, s42, 131072
    v_add_u32 v12, s41, v3
    v_and_b32 v13, 31, v1
    v_lshlrev_b32 v13, 9, v13
    v_add_u32 v13, s42, v13
    v_cmp_gt_u32 vcc, 16, v1
    s_nop 1
    v_cndmask_b32 v9, v13, v12, vcc
    s_waitcnt vmcnt(0)
    s_barrier
    ds_read_b128 v[16:19], v5
    ds_read_b128 v[20:23], v5 offset:16
    ds_read_b128 v[56:59], v113 offset:0
    ds_read_b128 v[64:67], v114 offset:0
    ds_read_b128 v[68:71], v115 offset:0
    s_waitcnt lgkmcnt(2)
    v_mfma_f32_32x32x16_bf16 v[80:95], v[56:59], v[16:19], 0
    s_nop 11
    s_waitcnt lgkmcnt(0)
    v_exp_f32 v80, v80
    v_exp_f32 v81, v81
    v_exp_f32 v82, v82
    v_exp_f32 v83, v83
    v_exp_f32 v84, v84
    v_mfma_f32_32x32x16_bf16 v[96:111], v[56:59], v[20:23], 0
    ds_read_b128 v[60:63], v113 offset:2080
    ds_read_b128 v[72:75], v114 offset:2080
    ds_read_b128 v[76:79], v115 offset:2080
    v_exp_f32 v85, v85
    v_exp_f32 v86, v86
    v_exp_f32 v87, v87
    v_exp_f32 v88, v88
    v_exp_f32 v89, v89
    v_smfmac_f32_32x32x32_bf16 v[24:39], v[64:67], v[80:87], v112
    s_add_u32 s37, s37, 17408
    v_exp_f32 v90, v90
    v_exp_f32 v91, v91
    v_exp_f32 v92, v92
    v_exp_f32 v93, v93
    v_exp_f32 v94, v94
    v_exp_f32 v95, v95
    v_exp_f32 v96, v96
    v_exp_f32 v97, v97
    v_smfmac_f32_32x32x32_bf16 v[24:39], v[68:71], v[88:95], v112
    s_waitcnt lgkmcnt(0)
    v_exp_f32 v98, v98
    v_exp_f32 v99, v99
    v_exp_f32 v100, v100
    v_mfma_f32_32x32x16_bf16 v[80:95], v[60:63], v[16:19], 0
    v_exp_f32 v101, v101
    v_exp_f32 v102, v102
    v_exp_f32 v103, v103
    v_exp_f32 v104, v104
    v_exp_f32 v105, v105
    v_smfmac_f32_32x32x32_bf16 v[40:55], v[64:67], v[96:103], v112
    s_cmp_ge_u32 s37, 139264
    s_cselect_b32 s37, 0, s37
    v_exp_f32 v106, v106
    v_exp_f32 v107, v107
    v_exp_f32 v108, v108
    v_exp_f32 v109, v109
    v_exp_f32 v110, v110
    v_exp_f32 v111, v111
    v_exp_f32 v80, v80
    v_exp_f32 v81, v81
    v_smfmac_f32_32x32x32_bf16 v[40:55], v[68:71], v[104:111], v112
    s_add_u32 s39, s37, s27
    s_add_u32 m0, s27, 41984
    v_exp_f32 v82, v82
    v_exp_f32 v83, v83
    v_exp_f32 v84, v84
    v_mfma_f32_32x32x16_bf16 v[96:111], v[60:63], v[20:23], 0
    ds_read_b128 v[56:59], v113 offset:4160
    ds_read_b128 v[64:67], v114 offset:4160
    ds_read_b128 v[68:71], v115 offset:4160
    v_exp_f32 v85, v85
    v_exp_f32 v86, v86
    v_exp_f32 v87, v87
    v_exp_f32 v88, v88
    v_exp_f32 v89, v89
    v_smfmac_f32_32x32x32_bf16 v[24:39], v[72:75], v[80:87], v112
    s_add_u32 s43, s39, 14315520
    buffer_load_dwordx4 v2, s[4:7], s43 offen offset:0 sc1 lds
    v_exp_f32 v90, v90
    v_exp_f32 v91, v91
    v_exp_f32 v92, v92
    v_exp_f32 v93, v93
    v_exp_f32 v94, v94
    v_exp_f32 v95, v95
    v_exp_f32 v96, v96
    v_exp_f32 v97, v97
    v_smfmac_f32_32x32x32_bf16 v[24:39], v[76:79], v[88:95], v112
    s_waitcnt lgkmcnt(0)
    buffer_load_dwordx4 v2, s[4:7], s43 offen offset:1024 sc1 lds
    v_exp_f32 v98, v98
    v_exp_f32 v99, v99
    v_exp_f32 v100, v100
    v_mfma_f32_32x32x16_bf16 v[80:95], v[56:59], v[16:19], 0
    v_exp_f32 v101, v101
    v_exp_f32 v102, v102
    v_exp_f32 v103, v103
    v_exp_f32 v104, v104
    v_exp_f32 v105, v105
    v_smfmac_f32_32x32x32_bf16 v[40:55], v[72:75], v[96:103], v112
    buffer_load_dwordx4 v2, s[4:7], s43 offen offset:2048 sc1 lds
    v_exp_f32 v106, v106
    v_exp_f32 v107, v107
    v_exp_f32 v108, v108
    v_exp_f32 v109, v109
    v_exp_f32 v110, v110
    v_exp_f32 v111, v111
    v_exp_f32 v80, v80
    v_exp_f32 v81, v81
    v_smfmac_f32_32x32x32_bf16 v[40:55], v[76:79], v[104:111], v112
    buffer_load_dwordx4 v2, s[4:7], s43 offen offset:3072 sc1 lds
    v_exp_f32 v82, v82
    v_exp_f32 v83, v83
    v_exp_f32 v84, v84
    v_mfma_f32_32x32x16_bf16 v[96:111], v[56:59], v[20:23], 0
    ds_read_b128 v[60:63], v113 offset:6240
    ds_read_b128 v[72:75], v114 offset:6240
    ds_read_b128 v[76:79], v115 offset:6240
    v_exp_f32 v85, v85
    v_exp_f32 v86, v86
    v_exp_f32 v87, v87
    v_exp_f32 v88, v88
    v_exp_f32 v89, v89
    v_smfmac_f32_32x32x32_bf16 v[24:39], v[64:67], v[80:87], v112
    s_mov_b32 m0, 58368
    s_add_u32 s43, s37, 14331904
    v_exp_f32 v90, v90
    v_exp_f32 v91, v91
    v_exp_f32 v92, v92
    v_exp_f32 v93, v93
    v_exp_f32 v94, v94
    v_exp_f32 v95, v95
    v_exp_f32 v96, v96
    v_exp_f32 v97, v97
    v_smfmac_f32_32x32x32_bf16 v[24:39], v[68:71], v[88:95], v112
    s_waitcnt lgkmcnt(0)
    buffer_load_dwordx4 v2, s[4:7], s43 offen offset:0 sc1 lds
    v_exp_f32 v98, v98
    v_exp_f32 v99, v99
    v_exp_f32 v100, v100
    v_mfma_f32_32x32x16_bf16 v[80:95], v[60:63], v[16:19], 0
    s_add_u32 s37, s37, 17408
    v_exp_f32 v101, v101
    v_exp_f32 v102, v102
    v_exp_f32 v103, v103
    v_exp_f32 v104, v104
    v_exp_f32 v105, v105
    v_smfmac_f32_32x32x32_bf16 v[40:55], v[64:67], v[96:103], v112
    s_cmp_ge_u32 s37, 139264
    s_cselect_b32 s37, 0, s37
    v_exp_f32 v106, v106
    v_exp_f32 v107, v107
    v_exp_f32 v108, v108
    v_exp_f32 v109, v109
    v_exp_f32 v110, v110
    v_exp_f32 v111, v111
    v_exp_f32 v80, v80
    v_exp_f32 v81, v81
    v_smfmac_f32_32x32x32_bf16 v[40:55], v[68:71], v[104:111], v112
    s_add_u32 s39, s37, s27
    s_add_u32 m0, s27, 59392
    v_exp_f32 v82, v82
    v_exp_f32 v83, v83
    v_exp_f32 v84, v84
    v_mfma_f32_32x32x16_bf16 v[96:111], v[60:63], v[20:23], 0
    ds_read_b128 v[56:59], v113 offset:8320
    ds_read_b128 v[64:67], v114 offset:8320
    ds_read_b128 v[68:71], v115 offset:8320
    v_exp_f32 v85, v85
    v_exp_f32 v86, v86
    v_exp_f32 v87, v87
    v_exp_f32 v88, v88
    v_exp_f32 v89, v89
    v_smfmac_f32_32x32x32_bf16 v[24:39], v[72:75], v[80:87], v112
    s_add_u32 s43, s39, 14315520
    buffer_load_dwordx4 v2, s[4:7], s43 offen offset:0 sc1 lds
    v_exp_f32 v90, v90
    v_exp_f32 v91, v91
    v_exp_f32 v92, v92
    v_exp_f32 v93, v93
    v_exp_f32 v94, v94
    v_exp_f32 v95, v95
    v_exp_f32 v96, v96
    v_exp_f32 v97, v97
    v_smfmac_f32_32x32x32_bf16 v[24:39], v[76:79], v[88:95], v112
    s_waitcnt lgkmcnt(0)
    buffer_load_dwordx4 v2, s[4:7], s43 offen offset:1024 sc1 lds
    v_exp_f32 v98, v98
    v_exp_f32 v99, v99
    v_exp_f32 v100, v100
    v_mfma_f32_32x32x16_bf16 v[80:95], v[56:59], v[16:19], 0
    v_exp_f32 v101, v101
    v_exp_f32 v102, v102
    v_exp_f32 v103, v103
    v_exp_f32 v104, v104
    v_exp_f32 v105, v105
    v_smfmac_f32_32x32x32_bf16 v[40:55], v[72:75], v[96:103], v112
    buffer_load_dwordx4 v2, s[4:7], s43 offen offset:2048 sc1 lds
    v_exp_f32 v106, v106
    v_exp_f32 v107, v107
    v_exp_f32 v108, v108
    v_exp_f32 v109, v109
    v_exp_f32 v110, v110
    v_exp_f32 v111, v111
    v_exp_f32 v80, v80
    v_exp_f32 v81, v81
    v_smfmac_f32_32x32x32_bf16 v[40:55], v[76:79], v[104:111], v112
    buffer_load_dwordx4 v2, s[4:7], s43 offen offset:3072 sc1 lds
    v_exp_f32 v82, v82
    v_exp_f32 v83, v83
    v_exp_f32 v84, v84
    v_mfma_f32_32x32x16_bf16 v[96:111], v[56:59], v[20:23], 0
    ds_read_b128 v[60:63], v113 offset:10400
    ds_read_b128 v[72:75], v114 offset:10400
    ds_read_b128 v[76:79], v115 offset:10400
    v_exp_f32 v85, v85
    v_exp_f32 v86, v86
    v_exp_f32 v87, v87
    v_exp_f32 v88, v88
    v_exp_f32 v89, v89
    v_smfmac_f32_32x32x32_bf16 v[24:39], v[64:67], v[80:87], v112
    s_mov_b32 m0, 75776
    s_add_u32 s43, s37, 14331904
    v_exp_f32 v90, v90
    v_exp_f32 v91, v91
    v_exp_f32 v92, v92
    v_exp_f32 v93, v93
    v_exp_f32 v94, v94
    v_exp_f32 v95, v95
    v_exp_f32 v96, v96
    v_exp_f32 v97, v97
    v_smfmac_f32_32x32x32_bf16 v[24:39], v[68:71], v[88:95], v112
    s_waitcnt lgkmcnt(0)
    buffer_load_dwordx4 v2, s[4:7], s43 offen offset:0 sc1 lds
    v_exp_f32 v98, v98
    v_exp_f32 v99, v99
    v_exp_f32 v100, v100
    v_mfma_f32_32x32x16_bf16 v[80:95], v[60:63], v[16:19], 0
    s_add_u32 s37, s37, 17408
    v_exp_f32 v101, v101
    v_exp_f32 v102, v102
    v_exp_f32 v103, v103
    v_exp_f32 v104, v104
    v_exp_f32 v105, v105
    v_smfmac_f32_32x32x32_bf16 v[40:55], v[64:67], v[96:103], v112
    s_cmp_ge_u32 s37, 139264
    s_cselect_b32 s37, 0, s37
    v_exp_f32 v106, v106
    v_exp_f32 v107, v107
    v_exp_f32 v108, v108
    v_exp_f32 v109, v109
    v_exp_f32 v110, v110
    v_exp_f32 v111, v111
    v_exp_f32 v80, v80
    v_exp_f32 v81, v81
    v_smfmac_f32_32x32x32_bf16 v[40:55], v[68:71], v[104:111], v112
    s_add_u32 s39, s37, s27
    s_add_u32 m0, s27, 76800
    v_exp_f32 v82, v82
    v_exp_f32 v83, v83
    v_exp_f32 v84, v84
    v_mfma_f32_32x32x16_bf16 v[96:111], v[60:63], v[20:23], 0
    ds_read_b128 v[56:59], v113 offset:12480
    ds_read_b128 v[64:67], v114 offset:12480
    ds_read_b128 v[68:71], v115 offset:12480
    v_exp_f32 v85, v85
    v_exp_f32 v86, v86
    v_exp_f32 v87, v87
    v_exp_f32 v88, v88
    v_exp_f32 v89, v89
    v_smfmac_f32_32x32x32_bf16 v[24:39], v[72:75], v[80:87], v112
    s_add_u32 s43, s39, 14315520
    buffer_load_dwordx4 v2, s[4:7], s43 offen offset:0 sc1 lds
    v_exp_f32 v90, v90
    v_exp_f32 v91, v91
    v_exp_f32 v92, v92
    v_exp_f32 v93, v93
    v_exp_f32 v94, v94
    v_exp_f32 v95, v95
    v_exp_f32 v96, v96
    v_exp_f32 v97, v97
    v_smfmac_f32_32x32x32_bf16 v[24:39], v[76:79], v[88:95], v112
    s_waitcnt lgkmcnt(0)
    buffer_load_dwordx4 v2, s[4:7], s43 offen offset:1024 sc1 lds
    v_exp_f32 v98, v98
    v_exp_f32 v99, v99
    v_exp_f32 v100, v100
    v_mfma_f32_32x32x16_bf16 v[80:95], v[56:59], v[16:19], 0
    v_exp_f32 v101, v101
    v_exp_f32 v102, v102
    v_exp_f32 v103, v103
    v_exp_f32 v104, v104
    v_exp_f32 v105, v105
    v_smfmac_f32_32x32x32_bf16 v[40:55], v[72:75], v[96:103], v112
    buffer_load_dwordx4 v2, s[4:7], s43 offen offset:2048 sc1 lds
    v_exp_f32 v106, v106
    v_exp_f32 v107, v107
    v_exp_f32 v108, v108
    v_exp_f32 v109, v109
    v_exp_f32 v110, v110
    v_exp_f32 v111, v111
    v_exp_f32 v80, v80
    v_exp_f32 v81, v81
    v_smfmac_f32_32x32x32_bf16 v[40:55], v[76:79], v[104:111], v112
    buffer_load_dwordx4 v2, s[4:7], s43 offen offset:3072 sc1 lds
    v_exp_f32 v82, v82
    v_exp_f32 v83, v83
    v_exp_f32 v84, v84
    v_mfma_f32_32x32x16_bf16 v[96:111], v[56:59], v[20:23], 0
    ds_read_b128 v[60:63], v113 offset:14560
    ds_read_b128 v[72:75], v114 offset:14560
    ds_read_b128 v[76:79], v115 offset:14560
    v_exp_f32 v85, v85
    v_exp_f32 v86, v86
    v_exp_f32 v87, v87
    v_exp_f32 v88, v88
    v_exp_f32 v89, v89
    v_smfmac_f32_32x32x32_bf16 v[24:39], v[64:67], v[80:87], v112
    s_mov_b32 m0, 93184
    s_add_u32 s43, s37, 14331904
    v_exp_f32 v90, v90
    v_exp_f32 v91, v91
    v_exp_f32 v92, v92
    v_exp_f32 v93, v93
    v_exp_f32 v94, v94
    v_exp_f32 v95, v95
    v_exp_f32 v96, v96
    v_exp_f32 v97, v97
    v_smfmac_f32_32x32x32_bf16 v[24:39], v[68:71], v[88:95], v112
    s_waitcnt lgkmcnt(0)
    buffer_load_dwordx4 v2, s[4:7], s43 offen offset:0 sc1 lds
    v_exp_f32 v98, v98
    v_exp_f32 v99, v99
    v_exp_f32 v100, v100
    v_mfma_f32_32x32x16_bf16 v[80:95], v[60:63], v[16:19], 0
    s_add_u32 s37, s37, 17408
    v_exp_f32 v101, v101
    v_exp_f32 v102, v102
    v_exp_f32 v103, v103
    v_exp_f32 v104, v104
    v_exp_f32 v105, v105
    v_smfmac_f32_32x32x32_bf16 v[40:55], v[64:67], v[96:103], v112
    s_cmp_ge_u32 s37, 139264
    s_cselect_b32 s37, 0, s37
    v_exp_f32 v106, v106
    v_exp_f32 v107, v107
    v_exp_f32 v108, v108
    v_exp_f32 v109, v109
    v_exp_f32 v110, v110
    v_exp_f32 v111, v111
    v_exp_f32 v80, v80
    v_exp_f32 v81, v81
    v_smfmac_f32_32x32x32_bf16 v[40:55], v[68:71], v[104:111], v112
    s_waitcnt vmcnt(10)
    s_barrier
    v_exp_f32 v82, v82
    v_exp_f32 v83, v83
    v_exp_f32 v84, v84
    v_mfma_f32_32x32x16_bf16 v[96:111], v[60:63], v[20:23], 0
    ds_read_b128 v[56:59], v113 offset:17408
    ds_read_b128 v[64:67], v114 offset:17408
    ds_read_b128 v[68:71], v115 offset:17408
    v_exp_f32 v85, v85
    v_exp_f32 v86, v86
    v_exp_f32 v87, v87
    v_exp_f32 v88, v88
    v_exp_f32 v89, v89
    v_smfmac_f32_32x32x32_bf16 v[24:39], v[72:75], v[80:87], v112
    s_add_u32 s39, s37, s27
    s_add_u32 m0, s27, 94208
    v_exp_f32 v90, v90
    v_exp_f32 v91, v91
    v_exp_f32 v92, v92
    v_exp_f32 v93, v93
    v_exp_f32 v94, v94
    v_exp_f32 v95, v95
    v_exp_f32 v96, v96
    v_exp_f32 v97, v97
    v_smfmac_f32_32x32x32_bf16 v[24:39], v[76:79], v[88:95], v112
    s_waitcnt lgkmcnt(0)
    s_add_u32 s43, s39, 14315520
    v_exp_f32 v98, v98
    v_exp_f32 v99, v99
    v_exp_f32 v100, v100
    v_mfma_f32_32x32x16_bf16 v[80:95], v[56:59], v[16:19], 0
    v_exp_f32 v101, v101
    v_exp_f32 v102, v102
    v_exp_f32 v103, v103
    v_exp_f32 v104, v104
    v_exp_f32 v105, v105
    v_smfmac_f32_32x32x32_bf16 v[40:55], v[72:75], v[96:103], v112
    buffer_load_dwordx4 v2, s[4:7], s43 offen offset:0 sc1 lds
    v_exp_f32 v106, v106
    v_exp_f32 v107, v107
    v_exp_f32 v108, v108
    v_exp_f32 v109, v109
    v_exp_f32 v110, v110
    v_exp_f32 v111, v111
    v_exp_f32 v80, v80
    v_exp_f32 v81, v81
    v_smfmac_f32_32x32x32_bf16 v[40:55], v[76:79], v[104:111], v112
    buffer_load_dwordx4 v2, s[4:7], s43 offen offset:1024 sc1 lds
    v_exp_f32 v82, v82
    v_exp_f32 v83, v83
    v_exp_f32 v84, v84
    v_mfma_f32_32x32x16_bf16 v[96:111], v[56:59], v[20:23], 0
    ds_read_b128 v[60:63], v113 offset:19488
    ds_read_b128 v[72:75], v114 offset:19488
    ds_read_b128 v[76:79], v115 offset:19488
    v_exp_f32 v85, v85
    v_exp_f32 v86, v86
    v_exp_f32 v87, v87
    v_exp_f32 v88, v88
    v_exp_f32 v89, v89
    v_smfmac_f32_32x32x32_bf16 v[24:39], v[64:67], v[80:87], v112
    buffer_load_dwordx4 v2, s[4:7], s43 offen offset:2048 sc1 lds
    v_exp_f32 v90, v90
    v_exp_f32 v91, v91
    v_exp_f32 v92, v92
    v_exp_f32 v93, v93
    v_exp_f32 v94, v94
    v_exp_f32 v95, v95
    v_exp_f32 v96, v96
    v_exp_f32 v97, v97
    v_smfmac_f32_32x32x32_bf16 v[24:39], v[68:71], v[88:95], v112
    s_waitcnt lgkmcnt(0)
    buffer_load_dwordx4 v2, s[4:7], s43 offen offset:3072 sc1 lds
    v_exp_f32 v98, v98
    v_exp_f32 v99, v99
    v_exp_f32 v100, v100
    v_mfma_f32_32x32x16_bf16 v[80:95], v[60:63], v[16:19], 0
    s_mov_b32 m0, 110592
    v_exp_f32 v101, v101
    v_exp_f32 v102, v102
    v_exp_f32 v103, v103
    v_exp_f32 v104, v104
    v_exp_f32 v105, v105
    v_smfmac_f32_32x32x32_bf16 v[40:55], v[64:67], v[96:103], v112
    s_add_u32 s43, s37, 14331904
    buffer_load_dwordx4 v2, s[4:7], s43 offen offset:0 sc1 lds
    v_exp_f32 v106, v106
    v_exp_f32 v107, v107
    v_exp_f32 v108, v108
    v_exp_f32 v109, v109
    v_exp_f32 v110, v110
    v_exp_f32 v111, v111
    v_exp_f32 v80, v80
    v_exp_f32 v81, v81
    v_smfmac_f32_32x32x32_bf16 v[40:55], v[68:71], v[104:111], v112
    s_add_u32 s37, s37, 17408
    v_exp_f32 v82, v82
    v_exp_f32 v83, v83
    v_exp_f32 v84, v84
    v_mfma_f32_32x32x16_bf16 v[96:111], v[60:63], v[20:23], 0
    ds_read_b128 v[56:59], v113 offset:21568
    ds_read_b128 v[64:67], v114 offset:21568
    ds_read_b128 v[68:71], v115 offset:21568
    v_exp_f32 v85, v85
    v_exp_f32 v86, v86
    v_exp_f32 v87, v87
    v_exp_f32 v88, v88
    v_exp_f32 v89, v89
    v_smfmac_f32_32x32x32_bf16 v[24:39], v[72:75], v[80:87], v112
    s_cmp_ge_u32 s37, 139264
    s_cselect_b32 s37, 0, s37
    v_exp_f32 v90, v90
    v_exp_f32 v91, v91
    v_exp_f32 v92, v92
    v_exp_f32 v93, v93
    v_exp_f32 v94, v94
    v_exp_f32 v95, v95
    v_exp_f32 v96, v96
    v_exp_f32 v97, v97
    v_smfmac_f32_32x32x32_bf16 v[24:39], v[76:79], v[88:95], v112
    s_waitcnt lgkmcnt(0)
    s_add_u32 s39, s37, s27
    v_exp_f32 v98, v98
    v_exp_f32 v99, v99
    v_exp_f32 v100, v100
    v_mfma_f32_32x32x16_bf16 v[80:95], v[56:59], v[16:19], 0
    s_add_u32 m0, s27, 111616
    v_exp_f32 v101, v101
    v_exp_f32 v102, v102
    v_exp_f32 v103, v103
    v_exp_f32 v104, v104
    v_exp_f32 v105, v105
    v_smfmac_f32_32x32x32_bf16 v[40:55], v[72:75], v[96:103], v112
    s_add_u32 s43, s39, 14315520
    buffer_load_dwordx4 v2, s[4:7], s43 offen offset:0 sc1 lds
    v_exp_f32 v106, v106
    v_exp_f32 v107, v107
    v_exp_f32 v108, v108
    v_exp_f32 v109, v109
    v_exp_f32 v110, v110
    v_exp_f32 v111, v111
    v_exp_f32 v80, v80
    v_exp_f32 v81, v81
    v_smfmac_f32_32x32x32_bf16 v[40:55], v[76:79], v[104:111], v112
    buffer_load_dwordx4 v2, s[4:7], s43 offen offset:1024 sc1 lds
    v_exp_f32 v82, v82
    v_exp_f32 v83, v83
    v_exp_f32 v84, v84
    v_mfma_f32_32x32x16_bf16 v[96:111], v[56:59], v[20:23], 0
    ds_read_b128 v[60:63], v113 offset:23648
    ds_read_b128 v[72:75], v114 offset:23648
    ds_read_b128 v[76:79], v115 offset:23648
    v_exp_f32 v85, v85
    v_exp_f32 v86, v86
    v_exp_f32 v87, v87
    v_exp_f32 v88, v88
    v_exp_f32 v89, v89
    v_smfmac_f32_32x32x32_bf16 v[24:39], v[64:67], v[80:87], v112
    buffer_load_dwordx4 v2, s[4:7], s43 offen offset:2048 sc1 lds
    v_exp_f32 v90, v90
    v_exp_f32 v91, v91
    v_exp_f32 v92, v92
    v_exp_f32 v93, v93
    v_exp_f32 v94, v94
    v_exp_f32 v95, v95
    v_exp_f32 v96, v96
    v_exp_f32 v97, v97
    v_smfmac_f32_32x32x32_bf16 v[24:39], v[68:71], v[88:95], v112
    s_waitcnt lgkmcnt(0)
    buffer_load_dwordx4 v2, s[4:7], s43 offen offset:3072 sc1 lds
    v_exp_f32 v98, v98
    v_exp_f32 v99, v99
    v_exp_f32 v100, v100
    v_mfma_f32_32x32x16_bf16 v[80:95], v[60:63], v[16:19], 0
    s_mov_b32 m0, 128000
    v_exp_f32 v101, v101
    v_exp_f32 v102, v102
    v_exp_f32 v103, v103
    v_exp_f32 v104, v104
    v_exp_f32 v105, v105
    v_smfmac_f32_32x32x32_bf16 v[40:55], v[64:67], v[96:103], v112
    s_add_u32 s43, s37, 14331904
    buffer_load_dwordx4 v2, s[4:7], s43 offen offset:0 sc1 lds
    v_exp_f32 v106, v106
    v_exp_f32 v107, v107
    v_exp_f32 v108, v108
    v_exp_f32 v109, v109
    v_exp_f32 v110, v110
    v_exp_f32 v111, v111
    v_exp_f32 v80, v80
    v_exp_f32 v81, v81
    v_smfmac_f32_32x32x32_bf16 v[40:55], v[68:71], v[104:111], v112
    s_add_u32 s37, s37, 17408
    v_exp_f32 v82, v82
    v_exp_f32 v83, v83
    v_exp_f32 v84, v84
    v_mfma_f32_32x32x16_bf16 v[96:111], v[60:63], v[20:23], 0
    ds_read_b128 v[56:59], v113 offset:25728
    ds_read_b128 v[64:67], v114 offset:25728
    ds_read_b128 v[68:71], v115 offset:25728
    v_exp_f32 v85, v85
    v_exp_f32 v86, v86
    v_exp_f32 v87, v87
    v_exp_f32 v88, v88
    v_exp_f32 v89, v89
    v_smfmac_f32_32x32x32_bf16 v[24:39], v[72:75], v[80:87], v112
    s_cmp_ge_u32 s37, 139264
    s_cselect_b32 s37, 0, s37
    v_exp_f32 v90, v90
    v_exp_f32 v91, v91
    v_exp_f32 v92, v92
    v_exp_f32 v93, v93
    v_exp_f32 v94, v94
    v_exp_f32 v95, v95
    v_exp_f32 v96, v96
    v_exp_f32 v97, v97
    v_smfmac_f32_32x32x32_bf16 v[24:39], v[76:79], v[88:95], v112
    s_waitcnt lgkmcnt(0)
    s_add_u32 s39, s37, s27
    v_exp_f32 v98, v98
    v_exp_f32 v99, v99
    v_exp_f32 v100, v100
    v_mfma_f32_32x32x16_bf16 v[80:95], v[56:59], v[16:19], 0
    s_add_u32 m0, s27, 129024
    v_exp_f32 v101, v101
    v_exp_f32 v102, v102
    v_exp_f32 v103, v103
    v_exp_f32 v104, v104
    v_exp_f32 v105, v105
    v_smfmac_f32_32x32x32_bf16 v[40:55], v[72:75], v[96:103], v112
    s_add_u32 s43, s39, 14315520
    buffer_load_dwordx4 v2, s[4:7], s43 offen offset:0 sc1 lds
    v_exp_f32 v106, v106
    v_exp_f32 v107, v107
    v_exp_f32 v108, v108
    v_exp_f32 v109, v109
    v_exp_f32 v110, v110
    v_exp_f32 v111, v111
    v_exp_f32 v80, v80
    v_exp_f32 v81, v81
    v_smfmac_f32_32x32x32_bf16 v[40:55], v[76:79], v[104:111], v112
    buffer_load_dwordx4 v2, s[4:7], s43 offen offset:1024 sc1 lds
    v_exp_f32 v82, v82
    v_exp_f32 v83, v83
    v_exp_f32 v84, v84
    v_mfma_f32_32x32x16_bf16 v[96:111], v[56:59], v[20:23], 0
    ds_read_b128 v[60:63], v113 offset:27808
    ds_read_b128 v[72:75], v114 offset:27808
    ds_read_b128 v[76:79], v115 offset:27808
    v_exp_f32 v85, v85
    v_exp_f32 v86, v86
    v_exp_f32 v87, v87
    v_exp_f32 v88, v88
    v_exp_f32 v89, v89
    v_smfmac_f32_32x32x32_bf16 v[24:39], v[64:67], v[80:87], v112
    buffer_load_dwordx4 v2, s[4:7], s43 offen offset:2048 sc1 lds
    v_exp_f32 v90, v90
    v_exp_f32 v91, v91
    v_exp_f32 v92, v92
    v_exp_f32 v93, v93
    v_exp_f32 v94, v94
    v_exp_f32 v95, v95
    v_exp_f32 v96, v96
    v_exp_f32 v97, v97
    v_smfmac_f32_32x32x32_bf16 v[24:39], v[68:71], v[88:95], v112
    s_waitcnt lgkmcnt(0)
    buffer_load_dwordx4 v2, s[4:7], s43 offen offset:3072 sc1 lds
    v_exp_f32 v98, v98
    v_exp_f32 v99, v99
    v_exp_f32 v100, v100
    v_mfma_f32_32x32x16_bf16 v[80:95], v[60:63], v[16:19], 0
    s_mov_b32 m0, 145408
    v_exp_f32 v101, v101
    v_exp_f32 v102, v102
    v_exp_f32 v103, v103
    v_exp_f32 v104, v104
    v_exp_f32 v105, v105
    v_smfmac_f32_32x32x32_bf16 v[40:55], v[64:67], v[96:103], v112
    s_add_u32 s43, s37, 14331904
    buffer_load_dwordx4 v2, s[4:7], s43 offen offset:0 sc1 lds
    v_exp_f32 v106, v106
    v_exp_f32 v107, v107
    v_exp_f32 v108, v108
    v_exp_f32 v109, v109
    v_exp_f32 v110, v110
    v_exp_f32 v111, v111
    v_exp_f32 v80, v80
    v_exp_f32 v81, v81
    v_smfmac_f32_32x32x32_bf16 v[40:55], v[68:71], v[104:111], v112
    s_add_u32 s37, s37, 17408
    v_exp_f32 v82, v82
    v_exp_f32 v83, v83
    v_exp_f32 v84, v84
    v_mfma_f32_32x32x16_bf16 v[96:111], v[60:63], v[20:23], 0
    ds_read_b128 v[56:59], v113 offset:29888
    ds_read_b128 v[64:67], v114 offset:29888
    ds_read_b128 v[68:71], v115 offset:29888
    v_exp_f32 v85, v85
    v_exp_f32 v86, v86
    v_exp_f32 v87, v87
    v_exp_f32 v88, v88
    v_exp_f32 v89, v89
    v_smfmac_f32_32x32x32_bf16 v[24:39], v[72:75], v[80:87], v112
    s_cmp_ge_u32 s37, 139264
    s_cselect_b32 s37, 0, s37
    v_exp_f32 v90, v90
    v_exp_f32 v91, v91
    v_exp_f32 v92, v92
    v_exp_f32 v93, v93
    v_exp_f32 v94, v94
    v_exp_f32 v95, v95
    v_exp_f32 v96, v96
    v_exp_f32 v97, v97
    v_smfmac_f32_32x32x32_bf16 v[24:39], v[76:79], v[88:95], v112
    s_waitcnt lgkmcnt(0)
    s_add_u32 s39, s37, s27
    v_exp_f32 v98, v98
    v_exp_f32 v99, v99
    v_exp_f32 v100, v100
    v_mfma_f32_32x32x16_bf16 v[80:95], v[56:59], v[16:19], 0
    s_add_u32 m0, s27, 146432
    v_exp_f32 v101, v101
    v_exp_f32 v102, v102
    v_exp_f32 v103, v103
    v_exp_f32 v104, v104
    v_exp_f32 v105, v105
    v_smfmac_f32_32x32x32_bf16 v[40:55], v[72:75], v[96:103], v112
    s_add_u32 s43, s39, 14315520
    buffer_load_dwordx4 v2, s[4:7], s43 offen offset:0 sc1 lds
    v_exp_f32 v106, v106
    v_exp_f32 v107, v107
    v_exp_f32 v108, v108
    v_exp_f32 v109, v109
    v_exp_f32 v110, v110
    v_exp_f32 v111, v111
    v_exp_f32 v80, v80
    v_exp_f32 v81, v81
    v_smfmac_f32_32x32x32_bf16 v[40:55], v[76:79], v[104:111], v112
    buffer_load_dwordx4 v2, s[4:7], s43 offen offset:1024 sc1 lds
    v_exp_f32 v82, v82
    v_exp_f32 v83, v83
    v_exp_f32 v84, v84
    v_mfma_f32_32x32x16_bf16 v[96:111], v[56:59], v[20:23], 0
    ds_read_b128 v[60:63], v113 offset:31968
    ds_read_b128 v[72:75], v114 offset:31968
    ds_read_b128 v[76:79], v115 offset:31968
    v_exp_f32 v85, v85
    v_exp_f32 v86, v86
    v_exp_f32 v87, v87
    v_exp_f32 v88, v88
    v_exp_f32 v89, v89
    v_smfmac_f32_32x32x32_bf16 v[24:39], v[64:67], v[80:87], v112
    buffer_load_dwordx4 v2, s[4:7], s43 offen offset:2048 sc1 lds
    v_exp_f32 v90, v90
    v_exp_f32 v91, v91
    v_exp_f32 v92, v92
    v_exp_f32 v93, v93
    v_exp_f32 v94, v94
    v_exp_f32 v95, v95
    v_exp_f32 v96, v96
    v_exp_f32 v97, v97
    v_smfmac_f32_32x32x32_bf16 v[24:39], v[68:71], v[88:95], v112
    s_waitcnt lgkmcnt(0)
    buffer_load_dwordx4 v2, s[4:7], s43 offen offset:3072 sc1 lds
    v_exp_f32 v98, v98
    v_exp_f32 v99, v99
    v_exp_f32 v100, v100
    v_mfma_f32_32x32x16_bf16 v[80:95], v[60:63], v[16:19], 0
    s_mov_b32 m0, 162816
    v_exp_f32 v101, v101
    v_exp_f32 v102, v102
    v_exp_f32 v103, v103
    v_exp_f32 v104, v104
    v_exp_f32 v105, v105
    v_smfmac_f32_32x32x32_bf16 v[40:55], v[64:67], v[96:103], v112
    s_add_u32 s43, s37, 14331904
    buffer_load_dwordx4 v2, s[4:7], s43 offen offset:0 sc1 lds
    v_exp_f32 v106, v106
    v_exp_f32 v107, v107
    v_exp_f32 v108, v108
    v_exp_f32 v109, v109
    v_exp_f32 v110, v110
    v_exp_f32 v111, v111
    v_exp_f32 v80, v80
    v_exp_f32 v81, v81
    v_smfmac_f32_32x32x32_bf16 v[40:55], v[68:71], v[104:111], v112
    s_waitcnt vmcnt(15)
    s_barrier
    v_exp_f32 v82, v82
    v_exp_f32 v83, v83
    v_exp_f32 v84, v84
    v_mfma_f32_32x32x16_bf16 v[96:111], v[60:63], v[20:23], 0
    ds_read_b128 v[56:59], v113 offset:34816
    ds_read_b128 v[64:67], v114 offset:34816
    ds_read_b128 v[68:71], v115 offset:34816
    v_exp_f32 v85, v85
    v_exp_f32 v86, v86
    v_exp_f32 v87, v87
    v_exp_f32 v88, v88
    v_exp_f32 v89, v89
    v_smfmac_f32_32x32x32_bf16 v[24:39], v[72:75], v[80:87], v112
    v_exp_f32 v90, v90
    v_exp_f32 v91, v91
    v_exp_f32 v92, v92
    v_exp_f32 v93, v93
    v_exp_f32 v94, v94
    v_exp_f32 v95, v95
    v_exp_f32 v96, v96
    v_exp_f32 v97, v97
    v_smfmac_f32_32x32x32_bf16 v[24:39], v[76:79], v[88:95], v112
    s_waitcnt lgkmcnt(0)
    s_add_u32 m0, s26, 0
    v_exp_f32 v98, v98
    v_exp_f32 v99, v99
    v_exp_f32 v100, v100
    v_mfma_f32_32x32x16_bf16 v[80:95], v[56:59], v[16:19], 0
    s_add_u32 s43, s25, 1081344
    v_exp_f32 v101, v101
    v_exp_f32 v102, v102
    v_exp_f32 v103, v103
    v_exp_f32 v104, v104
    v_exp_f32 v105, v105
    v_smfmac_f32_32x32x32_bf16 v[40:55], v[72:75], v[96:103], v112
    buffer_load_dwordx4 v2, s[4:7], s43 offen offset:0  lds
    v_exp_f32 v106, v106
    v_exp_f32 v107, v107
    v_exp_f32 v108, v108
    v_exp_f32 v109, v109
    v_exp_f32 v110, v110
    v_exp_f32 v111, v111
    v_exp_f32 v80, v80
    v_exp_f32 v81, v81
    v_smfmac_f32_32x32x32_bf16 v[40:55], v[76:79], v[104:111], v112
    buffer_load_dwordx4 v2, s[4:7], s43 offen offset:1024  lds
    v_exp_f32 v82, v82
    v_exp_f32 v83, v83
    v_exp_f32 v84, v84
    v_mfma_f32_32x32x16_bf16 v[96:111], v[56:59], v[20:23], 0
    ds_read_b128 v[60:63], v113 offset:36896
    ds_read_b128 v[72:75], v114 offset:36896
    ds_read_b128 v[76:79], v115 offset:36896
    v_exp_f32 v85, v85
    v_exp_f32 v86, v86
    v_exp_f32 v87, v87
    v_exp_f32 v88, v88
    v_exp_f32 v89, v89
    v_smfmac_f32_32x32x32_bf16 v[24:39], v[64:67], v[80:87], v112
    buffer_load_dwordx4 v2, s[4:7], s43 offen offset:2048  lds
    v_exp_f32 v90, v90
    v_exp_f32 v91, v91
    v_exp_f32 v92, v92
    v_exp_f32 v93, v93
    v_exp_f32 v94, v94
    v_exp_f32 v95, v95
    v_exp_f32 v96, v96
    v_exp_f32 v97, v97
    v_smfmac_f32_32x32x32_bf16 v[24:39], v[68:71], v[88:95], v112
    s_waitcnt lgkmcnt(0)
    buffer_load_dwordx4 v2, s[4:7], s43 offen offset:3072  lds
    v_exp_f32 v98, v98
    v_exp_f32 v99, v99
    v_exp_f32 v100, v100
    v_mfma_f32_32x32x16_bf16 v[80:95], v[60:63], v[16:19], 0
    s_add_u32 m0, s26, 4096
    v_exp_f32 v101, v101
    v_exp_f32 v102, v102
    v_exp_f32 v103, v103
    v_exp_f32 v104, v104
    v_exp_f32 v105, v105
    v_smfmac_f32_32x32x32_bf16 v[40:55], v[64:67], v[96:103], v112
    s_add_u32 s43, s25, 1085440
    buffer_load_dwordx4 v2, s[4:7], s43 offen offset:0  lds
    v_exp_f32 v106, v106
    v_exp_f32 v107, v107
    v_exp_f32 v108, v108
    v_exp_f32 v109, v109
    v_exp_f32 v110, v110
    v_exp_f32 v111, v111
    v_exp_f32 v80, v80
    v_exp_f32 v81, v81
    v_smfmac_f32_32x32x32_bf16 v[40:55], v[68:71], v[104:111], v112
    buffer_load_dwordx4 v2, s[4:7], s43 offen offset:1024  lds
    v_exp_f32 v82, v82
    v_exp_f32 v83, v83
    v_exp_f32 v84, v84
    v_mfma_f32_32x32x16_bf16 v[96:111], v[60:63], v[20:23], 0
    ds_read_b128 v[56:59], v113 offset:38976
    ds_read_b128 v[64:67], v114 offset:38976
    ds_read_b128 v[68:71], v115 offset:38976
    v_exp_f32 v85, v85
    v_exp_f32 v86, v86
    v_exp_f32 v87, v87
    v_exp_f32 v88, v88
    v_exp_f32 v89, v89
    v_smfmac_f32_32x32x32_bf16 v[24:39], v[72:75], v[80:87], v112
    buffer_load_dwordx4 v2, s[4:7], s43 offen offset:2048  lds
    v_exp_f32 v90, v90
    v_exp_f32 v91, v91
    v_exp_f32 v92, v92
    v_exp_f32 v93, v93
    v_exp_f32 v94, v94
    v_exp_f32 v95, v95
    v_exp_f32 v96, v96
    v_exp_f32 v97, v97
    v_smfmac_f32_32x32x32_bf16 v[24:39], v[76:79], v[88:95], v112
    s_waitcnt lgkmcnt(0)
    buffer_load_dwordx4 v2, s[4:7], s43 offen offset:3072  lds
    v_exp_f32 v98, v98
    v_exp_f32 v99, v99
    v_exp_f32 v100, v100
    v_mfma_f32_32x32x16_bf16 v[80:95], v[56:59], v[16:19], 0
    s_add_u32 s42, s28, 14602240
    v_exp_f32 v101, v101
    v_exp_f32 v102, v102
    v_exp_f32 v103, v103
    v_exp_f32 v104, v104
    v_exp_f32 v105, v105
    v_smfmac_f32_32x32x32_bf16 v[40:55], v[72:75], v[96:103], v112
    buffer_store_dwordx4 v[16:19], v2, s[4:7], s42 offen
    v_exp_f32 v106, v106
    v_exp_f32 v107, v107
    v_exp_f32 v108, v108
    v_exp_f32 v109, v109
    v_exp_f32 v110, v110
    v_exp_f32 v111, v111
    v_exp_f32 v80, v80
    v_exp_f32 v81, v81
    v_smfmac_f32_32x32x32_bf16 v[40:55], v[76:79], v[104:111], v112
    s_add_u32 s42, s28, 14618624
    buffer_store_dwordx4 v[16:19], v2, s[4:7], s42 offen
    v_exp_f32 v82, v82
    v_exp_f32 v83, v83
    v_exp_f32 v84, v84
    v_mfma_f32_32x32x16_bf16 v[96:111], v[56:59], v[20:23], 0
    ds_read_b128 v[60:63], v113 offset:41056
    ds_read_b128 v[72:75], v114 offset:41056
    ds_read_b128 v[76:79], v115 offset:41056
    v_exp_f32 v85, v85
    v_exp_f32 v86, v86
    v_exp_f32 v87, v87
    v_exp_f32 v88, v88
    v_exp_f32 v89, v89
    v_smfmac_f32_32x32x32_bf16 v[24:39], v[64:67], v[80:87], v112
    s_add_u32 s42, s28, 14635008
    buffer_store_dwordx4 v[16:19], v2, s[4:7], s42 offen
    v_exp_f32 v90, v90
    v_exp_f32 v91, v91
    v_exp_f32 v92, v92
    v_exp_f32 v93, v93
    v_exp_f32 v94, v94
    v_exp_f32 v95, v95
    v_exp_f32 v96, v96
    v_exp_f32 v97, v97
    v_smfmac_f32_32x32x32_bf16 v[24:39], v[68:71], v[88:95], v112
    s_waitcnt lgkmcnt(0)
    s_add_u32 s42, s28, 14651392
    v_exp_f32 v98, v98
    v_exp_f32 v99, v99
    v_exp_f32 v100, v100
    v_mfma_f32_32x32x16_bf16 v[80:95], v[60:63], v[16:19], 0
    v_exp_f32 v101, v101
    v_exp_f32 v102, v102
    v_exp_f32 v103, v103
    v_exp_f32 v104, v104
    v_exp_f32 v105, v105
    v_smfmac_f32_32x32x32_bf16 v[40:55], v[64:67], v[96:103], v112
    buffer_store_dwordx4 v[16:19], v2, s[4:7], s42 offen
    v_exp_f32 v106, v106
    v_exp_f32 v107, v107
    v_exp_f32 v108, v108
    v_exp_f32 v109, v109
    v_exp_f32 v110, v110
    v_exp_f32 v111, v111
    v_exp_f32 v80, v80
    v_exp_f32 v81, v81
    v_smfmac_f32_32x32x32_bf16 v[40:55], v[68:71], v[104:111], v112
    s_add_u32 s42, s28, 14667776
    buffer_store_dwordx4 v[16:19], v2, s[4:7], s42 offen
    v_exp_f32 v82, v82
    v_exp_f32 v83, v83
    v_exp_f32 v84, v84
    v_mfma_f32_32x32x16_bf16 v[96:111], v[60:63], v[20:23], 0
    ds_read_b128 v[56:59], v113 offset:43136
    ds_read_b128 v[64:67], v114 offset:43136
    ds_read_b128 v[68:71], v115 offset:43136
    v_exp_f32 v85, v85
    v_exp_f32 v86, v86
    v_exp_f32 v87, v87
    v_exp_f32 v88, v88
    v_exp_f32 v89, v89
    v_smfmac_f32_32x32x32_bf16 v[24:39], v[72:75], v[80:87], v112
    s_add_u32 s42, s28, 14684160
    v_exp_f32 v90, v90
    v_exp_f32 v91, v91
    v_exp_f32 v92, v92
    v_exp_f32 v93, v93
    v_exp_f32 v94, v94
    v_exp_f32 v95, v95
    v_exp_f32 v96, v96
    v_exp_f32 v97, v97
    v_smfmac_f32_32x32x32_bf16 v[24:39], v[76:79], v[88:95], v112
    s_waitcnt lgkmcnt(0)
    v_exp_f32 v98, v98
    v_exp_f32 v99, v99
    v_exp_f32 v100, v100
    v_mfma_f32_32x32x16_bf16 v[80:95], v[56:59], v[16:19], 0
    v_exp_f32 v101, v101
    v_exp_f32 v102, v102
    v_exp_f32 v103, v103
    v_exp_f32 v104, v104
    v_exp_f32 v105, v105
    v_smfmac_f32_32x32x32_bf16 v[40:55], v[72:75], v[96:103], v112
    s_cmp_ge_u32 s15, 6
    s_cselect_b32 s42, 2147418112, s42
    v_exp_f32 v106, v106
    v_exp_f32 v107, v107
    v_exp_f32 v108, v108
    v_exp_f32 v109, v109
    v_exp_f32 v110, v110
    v_exp_f32 v111, v111
    v_exp_f32 v80, v80
    v_exp_f32 v81, v81
    v_smfmac_f32_32x32x32_bf16 v[40:55], v[76:79], v[104:111], v112
    buffer_store_dwordx4 v[16:19], v2, s[4:7], s42 offen
    v_exp_f32 v82, v82
    v_exp_f32 v83, v83
    v_exp_f32 v84, v84
    v_mfma_f32_32x32x16_bf16 v[96:111], v[56:59], v[20:23], 0
    ds_read_b128 v[60:63], v113 offset:45216
    ds_read_b128 v[72:75], v114 offset:45216
    ds_read_b128 v[76:79], v115 offset:45216
    v_exp_f32 v85, v85
    v_exp_f32 v86, v86
    v_exp_f32 v87, v87
    v_exp_f32 v88, v88
    v_exp_f32 v89, v89
    v_smfmac_f32_32x32x32_bf16 v[24:39], v[64:67], v[80:87], v112
    s_add_u32 s42, s16, 5402624
    buffer_store_dwordx4 v[16:19], v2, s[4:7], s42 offen
    v_exp_f32 v90, v90
    v_exp_f32 v91, v91
    v_exp_f32 v92, v92
    v_exp_f32 v93, v93
    v_exp_f32 v94, v94
    v_exp_f32 v95, v95
    v_exp_f32 v96, v96
    v_exp_f32 v97, v97
    v_smfmac_f32_32x32x32_bf16 v[24:39], v[68:71], v[88:95], v112
    s_waitcnt lgkmcnt(0)
    buffer_store_dwordx4 v[16:19], v2, s[4:7], s42 offen offset:1024
    v_exp_f32 v98, v98
    v_exp_f32 v99, v99
    v_exp_f32 v100, v100
    v_mfma_f32_32x32x16_bf16 v[80:95], v[60:63], v[16:19], 0
    s_add_u32 s42, s30, 13791232
    v_exp_f32 v101, v101
    v_exp_f32 v102, v102
    v_exp_f32 v103, v103
    v_exp_f32 v104, v104
    v_exp_f32 v105, v105
    v_smfmac_f32_32x32x32_bf16 v[40:55], v[64:67], v[96:103], v112
    buffer_store_dword v16, v123, s[4:7], s42 offen
    v_exp_f32 v106, v106
    v_exp_f32 v107, v107
    v_exp_f32 v108, v108
    v_exp_f32 v109, v109
    v_exp_f32 v110, v110
    v_exp_f32 v111, v111
    v_exp_f32 v80, v80
    v_exp_f32 v81, v81
    v_smfmac_f32_32x32x32_bf16 v[40:55], v[68:71], v[104:111], v112
    s_add_u32 s38, s24, 3921920
    buffer_load_dwordx4 a[128:131], v2, s[4:7], s38 offen offset:0
    v_exp_f32 v82, v82
    v_exp_f32 v83, v83
    v_exp_f32 v84, v84
    v_mfma_f32_32x32x16_bf16 v[96:111], v[60:63], v[20:23], 0
    ds_read_b128 v[56:59], v113 offset:47296
    ds_read_b128 v[64:67], v114 offset:47296
    ds_read_b128 v[68:71], v115 offset:47296
    v_exp_f32 v85, v85
    v_exp_f32 v86, v86
    v_exp_f32 v87, v87
    v_exp_f32 v88, v88
    v_exp_f32 v89, v89
    v_smfmac_f32_32x32x32_bf16 v[24:39], v[72:75], v[80:87], v112
    buffer_load_dwordx4 a[132:135], v2, s[4:7], s38 offen offset:1024
    v_exp_f32 v90, v90
    v_exp_f32 v91, v91
    v_exp_f32 v92, v92
    v_exp_f32 v93, v93
    v_exp_f32 v94, v94
    v_exp_f32 v95, v95
    v_exp_f32 v96, v96
    v_exp_f32 v97, v97
    v_smfmac_f32_32x32x32_bf16 v[24:39], v[76:79], v[88:95], v112
    s_waitcnt lgkmcnt(0)
    buffer_load_dwordx4 a[136:139], v2, s[4:7], s38 offen offset:2048
    v_exp_f32 v98, v98
    v_exp_f32 v99, v99
    v_exp_f32 v100, v100
    v_mfma_f32_32x32x16_bf16 v[80:95], v[56:59], v[16:19], 0
    v_exp_f32 v101, v101
    v_exp_f32 v102, v102
    v_exp_f32 v103, v103
    v_exp_f32 v104, v104
    v_exp_f32 v105, v105
    v_smfmac_f32_32x32x32_bf16 v[40:55], v[72:75], v[96:103], v112
    buffer_load_dwordx4 a[140:143], v2, s[4:7], s38 offen offset:3072
    v_exp_f32 v106, v106
    v_exp_f32 v107, v107
    v_exp_f32 v108, v108
    v_exp_f32 v109, v109
    v_exp_f32 v110, v110
    v_exp_f32 v111, v111
    v_exp_f32 v80, v80
    v_exp_f32 v81, v81
    v_smfmac_f32_32x32x32_bf16 v[40:55], v[76:79], v[104:111], v112
    s_add_u32 s38, s24, 3926016
    buffer_load_dwordx4 a[144:147], v2, s[4:7], s38 offen offset:0
    v_exp_f32 v82, v82
    v_exp_f32 v83, v83
    v_exp_f32 v84, v84
    v_mfma_f32_32x32x16_bf16 v[96:111], v[56:59], v[20:23], 0
    ds_read_b128 v[60:63], v113 offset:49376
    ds_read_b128 v[72:75], v114 offset:49376
    ds_read_b128 v[76:79], v115 offset:49376
    v_exp_f32 v85, v85
    v_exp_f32 v86, v86
    v_exp_f32 v87, v87
    v_exp_f32 v88, v88
    v_exp_f32 v89, v89
    v_smfmac_f32_32x32x32_bf16 v[24:39], v[64:67], v[80:87], v112
    buffer_load_dwordx4 a[148:151], v2, s[4:7], s38 offen offset:1024
    v_exp_f32 v90, v90
    v_exp_f32 v91, v91
    v_exp_f32 v92, v92
    v_exp_f32 v93, v93
    v_exp_f32 v94, v94
    v_exp_f32 v95, v95
    v_exp_f32 v96, v96
    v_exp_f32 v97, v97
    v_smfmac_f32_32x32x32_bf16 v[24:39], v[68:71], v[88:95], v112
    s_waitcnt lgkmcnt(0)
    buffer_load_dwordx4 a[152:155], v2, s[4:7], s38 offen offset:2048
    v_exp_f32 v98, v98
    v_exp_f32 v99, v99
    v_exp_f32 v100, v100
    v_mfma_f32_32x32x16_bf16 v[80:95], v[60:63], v[16:19], 0
    v_exp_f32 v101, v101
    v_exp_f32 v102, v102
    v_exp_f32 v103, v103
    v_exp_f32 v104, v104
    v_exp_f32 v105, v105
    v_smfmac_f32_32x32x32_bf16 v[40:55], v[64:67], v[96:103], v112
    buffer_load_dwordx4 a[156:159], v2, s[4:7], s38 offen offset:3072
    v_exp_f32 v106, v106
    v_exp_f32 v107, v107
    v_exp_f32 v108, v108
    v_exp_f32 v109, v109
    v_exp_f32 v110, v110
    v_exp_f32 v111, v111
    v_exp_f32 v80, v80
    v_exp_f32 v81, v81
    v_smfmac_f32_32x32x32_bf16 v[40:55], v[68:71], v[104:111], v112
    s_add_u32 s38, s24, 3930112
    buffer_load_dwordx4 a[160:163], v2, s[4:7], s38 offen offset:0
    v_exp_f32 v82, v82
    v_exp_f32 v83, v83
    v_exp_f32 v84, v84
    v_mfma_f32_32x32x16_bf16 v[96:111], v[60:63], v[20:23], 0
    ds_read_b128 v[56:59], v113 offset:52224
    ds_read_b128 v[64:67], v114 offset:52224
    ds_read_b128 v[68:71], v115 offset:52224
    v_exp_f32 v85, v85
    v_exp_f32 v86, v86
    v_exp_f32 v87, v87
    v_exp_f32 v88, v88
    v_exp_f32 v89, v89
    v_smfmac_f32_32x32x32_bf16 v[24:39], v[72:75], v[80:87], v112
    buffer_load_dwordx4 a[164:167], v2, s[4:7], s38 offen offset:1024
    v_exp_f32 v90, v90
    v_exp_f32 v91, v91
    v_exp_f32 v92, v92
    v_exp_f32 v93, v93
    v_exp_f32 v94, v94
    v_exp_f32 v95, v95
    v_exp_f32 v96, v96
    v_exp_f32 v97, v97
    v_smfmac_f32_32x32x32_bf16 v[24:39], v[76:79], v[88:95], v112
    s_waitcnt lgkmcnt(0)
    buffer_load_dwordx4 a[168:171], v2, s[4:7], s38 offen offset:2048
    v_exp_f32 v98, v98
    v_exp_f32 v99, v99
    v_exp_f32 v100, v100
    v_mfma_f32_32x32x16_bf16 v[80:95], v[56:59], v[16:19], 0
    v_exp_f32 v101, v101
    v_exp_f32 v102, v102
    v_exp_f32 v103, v103
    v_exp_f32 v104, v104
    v_exp_f32 v105, v105
    v_smfmac_f32_32x32x32_bf16 v[40:55], v[72:75], v[96:103], v112
    buffer_load_dwordx4 a[172:175], v2, s[4:7], s38 offen offset:3072
    v_exp_f32 v106, v106
    v_exp_f32 v107, v107
    v_exp_f32 v108, v108
    v_exp_f32 v109, v109
    v_exp_f32 v110, v110
    v_exp_f32 v111, v111
    v_exp_f32 v80, v80
    v_exp_f32 v81, v81
    v_smfmac_f32_32x32x32_bf16 v[40:55], v[76:79], v[104:111], v112
    s_add_u32 s38, s24, 3934208
    buffer_load_dwordx4 a[176:179], v2, s[4:7], s38 offen offset:0
    v_exp_f32 v82, v82
    v_exp_f32 v83, v83
    v_exp_f32 v84, v84
    v_mfma_f32_32x32x16_bf16 v[96:111], v[56:59], v[20:23], 0
    ds_read_b128 v[60:63], v113 offset:54304
    ds_read_b128 v[72:75], v114 offset:54304
    ds_read_b128 v[76:79], v115 offset:54304
    v_exp_f32 v85, v85
    v_exp_f32 v86, v86
    v_exp_f32 v87, v87
    v_exp_f32 v88, v88
    v_exp_f32 v89, v89
    v_smfmac_f32_32x32x32_bf16 v[24:39], v[64:67], v[80:87], v112
    buffer_load_dwordx4 a[180:183], v2, s[4:7], s38 offen offset:1024
    v_exp_f32 v90, v90
    v_exp_f32 v91, v91
    v_exp_f32 v92, v92
    v_exp_f32 v93, v93
    v_exp_f32 v94, v94
    v_exp_f32 v95, v95
    v_exp_f32 v96, v96
    v_exp_f32 v97, v97
    v_smfmac_f32_32x32x32_bf16 v[24:39], v[68:71], v[88:95], v112
    s_waitcnt lgkmcnt(0)
    buffer_load_dwordx4 a[184:187], v2, s[4:7], s38 offen offset:2048
    v_exp_f32 v98, v98
    v_exp_f32 v99, v99
    v_exp_f32 v100, v100
    v_mfma_f32_32x32x16_bf16 v[80:95], v[60:63], v[16:19], 0
    v_exp_f32 v101, v101
    v_exp_f32 v102, v102
    v_exp_f32 v103, v103
    v_exp_f32 v104, v104
    v_exp_f32 v105, v105
    v_smfmac_f32_32x32x32_bf16 v[40:55], v[64:67], v[96:103], v112
    buffer_load_dwordx4 a[188:191], v2, s[4:7], s38 offen offset:3072
    v_exp_f32 v106, v106
    v_exp_f32 v107, v107
    v_exp_f32 v108, v108
    v_exp_f32 v109, v109
    v_exp_f32 v110, v110
    v_exp_f32 v111, v111
    v_exp_f32 v80, v80
    v_exp_f32 v81, v81
    v_smfmac_f32_32x32x32_bf16 v[40:55], v[68:71], v[104:111], v112
    s_add_u32 s38, s24, 3938304
    buffer_load_dwordx4 a[192:195], v2, s[4:7], s38 offen offset:0
    v_exp_f32 v82, v82
    v_exp_f32 v83, v83
    v_exp_f32 v84, v84
    v_mfma_f32_32x32x16_bf16 v[96:111], v[60:63], v[20:23], 0
    ds_read_b128 v[56:59], v113 offset:56384
    ds_read_b128 v[64:67], v114 offset:56384
    ds_read_b128 v[68:71], v115 offset:56384
    v_exp_f32 v85, v85
    v_exp_f32 v86, v86
    v_exp_f32 v87, v87
    v_exp_f32 v88, v88
    v_exp_f32 v89, v89
    v_smfmac_f32_32x32x32_bf16 v[24:39], v[72:75], v[80:87], v112
    buffer_load_dwordx4 a[196:199], v2, s[4:7], s38 offen offset:1024
    v_exp_f32 v90, v90
    v_exp_f32 v91, v91
    v_exp_f32 v92, v92
    v_exp_f32 v93, v93
    v_exp_f32 v94, v94
    v_exp_f32 v95, v95
    v_exp_f32 v96, v96
    v_exp_f32 v97, v97
    v_smfmac_f32_32x32x32_bf16 v[24:39], v[76:79], v[88:95], v112
    s_waitcnt lgkmcnt(0)
    buffer_load_dwordx4 a[200:203], v2, s[4:7], s38 offen offset:2048
    v_exp_f32 v98, v98
    v_exp_f32 v99, v99
    v_exp_f32 v100, v100
    v_mfma_f32_32x32x16_bf16 v[80:95], v[56:59], v[16:19], 0
    v_exp_f32 v101, v101
    v_exp_f32 v102, v102
    v_exp_f32 v103, v103
    v_exp_f32 v104, v104
    v_exp_f32 v105, v105
    v_smfmac_f32_32x32x32_bf16 v[40:55], v[72:75], v[96:103], v112
    buffer_load_dwordx4 a[204:207], v2, s[4:7], s38 offen offset:3072
    v_exp_f32 v106, v106
    v_exp_f32 v107, v107
    v_exp_f32 v108, v108
    v_exp_f32 v109, v109
    v_exp_f32 v110, v110
    v_exp_f32 v111, v111
    v_exp_f32 v80, v80
    v_exp_f32 v81, v81
    v_smfmac_f32_32x32x32_bf16 v[40:55], v[76:79], v[104:111], v112
    s_add_u32 s38, s24, 3942400
    buffer_load_dwordx4 a[208:211], v2, s[4:7], s38 offen offset:0
    v_exp_f32 v82, v82
    v_exp_f32 v83, v83
    v_exp_f32 v84, v84
    v_mfma_f32_32x32x16_bf16 v[96:111], v[56:59], v[20:23], 0
    ds_read_b128 v[60:63], v113 offset:58464
    ds_read_b128 v[72:75], v114 offset:58464
    ds_read_b128 v[76:79], v115 offset:58464
    v_exp_f32 v85, v85
    v_exp_f32 v86, v86
    v_exp_f32 v87, v87
    v_exp_f32 v88, v88
    v_exp_f32 v89, v89
    v_smfmac_f32_32x32x32_bf16 v[24:39], v[64:67], v[80:87], v112
    buffer_load_dwordx4 a[212:215], v2, s[4:7], s38 offen offset:1024
    v_exp_f32 v90, v90
    v_exp_f32 v91, v91
    v_exp_f32 v92, v92
    v_exp_f32 v93, v93
    v_exp_f32 v94, v94
    v_exp_f32 v95, v95
    v_exp_f32 v96, v96
    v_exp_f32 v97, v97
    v_smfmac_f32_32x32x32_bf16 v[24:39], v[68:71], v[88:95], v112
    s_waitcnt lgkmcnt(0)
    buffer_load_dwordx4 a[216:219], v2, s[4:7], s38 offen offset:2048
    v_exp_f32 v98, v98
    v_exp_f32 v99, v99
    v_exp_f32 v100, v100
    v_mfma_f32_32x32x16_bf16 v[80:95], v[60:63], v[16:19], 0
    v_exp_f32 v101, v101
    v_exp_f32 v102, v102
    v_exp_f32 v103, v103
    v_exp_f32 v104, v104
    v_exp_f32 v105, v105
    v_smfmac_f32_32x32x32_bf16 v[40:55], v[64:67], v[96:103], v112
    buffer_load_dwordx4 a[220:223], v2, s[4:7], s38 offen offset:3072
    v_exp_f32 v106, v106
    v_exp_f32 v107, v107
    v_exp_f32 v108, v108
    v_exp_f32 v109, v109
    v_exp_f32 v110, v110
    v_exp_f32 v111, v111
    v_exp_f32 v80, v80
    v_exp_f32 v81, v81
    v_smfmac_f32_32x32x32_bf16 v[40:55], v[68:71], v[104:111], v112
    s_add_u32 s38, s24, 3946496
    buffer_load_dwordx4 a[224:227], v2, s[4:7], s38 offen offset:0
    v_exp_f32 v82, v82
    v_exp_f32 v83, v83
    v_exp_f32 v84, v84
    v_mfma_f32_32x32x16_bf16 v[96:111], v[60:63], v[20:23], 0
    ds_read_b128 v[56:59], v113 offset:60544
    ds_read_b128 v[64:67], v114 offset:60544
    ds_read_b128 v[68:71], v115 offset:60544
    v_exp_f32 v85, v85
    v_exp_f32 v86, v86
    v_exp_f32 v87, v87
    v_exp_f32 v88, v88
    v_exp_f32 v89, v89
    v_smfmac_f32_32x32x32_bf16 v[24:39], v[72:75], v[80:87], v112
    buffer_load_dwordx4 a[228:231], v2, s[4:7], s38 offen offset:1024
    v_exp_f32 v90, v90
    v_exp_f32 v91, v91
    v_exp_f32 v92, v92
    v_exp_f32 v93, v93
    v_exp_f32 v94, v94
    v_exp_f32 v95, v95
    v_exp_f32 v96, v96
    v_exp_f32 v97, v97
    v_smfmac_f32_32x32x32_bf16 v[24:39], v[76:79], v[88:95], v112
    s_waitcnt lgkmcnt(0)
    buffer_load_dwordx4 a[232:235], v2, s[4:7], s38 offen offset:2048
    v_exp_f32 v98, v98
    v_exp_f32 v99, v99
    v_exp_f32 v100, v100
    v_mfma_f32_32x32x16_bf16 v[80:95], v[56:59], v[16:19], 0
    v_exp_f32 v101, v101
    v_exp_f32 v102, v102
    v_exp_f32 v103, v103
    v_exp_f32 v104, v104
    v_exp_f32 v105, v105
    v_smfmac_f32_32x32x32_bf16 v[40:55], v[72:75], v[96:103], v112
    buffer_load_dwordx4 a[236:239], v2, s[4:7], s38 offen offset:3072
    v_exp_f32 v106, v106
    v_exp_f32 v107, v107
    v_exp_f32 v108, v108
    v_exp_f32 v109, v109
    v_exp_f32 v110, v110
    v_exp_f32 v111, v111
    v_exp_f32 v80, v80
    v_exp_f32 v81, v81
    v_smfmac_f32_32x32x32_bf16 v[40:55], v[76:79], v[104:111], v112
    s_add_u32 s38, s24, 3950592
    s_waitcnt vmcnt(32)
    buffer_load_dwordx4 a[240:243], v2, s[4:7], s38 offen offset:0
    v_exp_f32 v82, v82
    v_exp_f32 v83, v83
    v_exp_f32 v84, v84
    v_mfma_f32_32x32x16_bf16 v[96:111], v[56:59], v[20:23], 0
    ds_read_b128 v[60:63], v113 offset:62624
    ds_read_b128 v[72:75], v114 offset:62624
    ds_read_b128 v[76:79], v115 offset:62624
    v_exp_f32 v85, v85
    v_exp_f32 v86, v86
    v_exp_f32 v87, v87
    v_exp_f32 v88, v88
    v_exp_f32 v89, v89
    v_smfmac_f32_32x32x32_bf16 v[24:39], v[64:67], v[80:87], v112
    buffer_load_dwordx4 a[244:247], v2, s[4:7], s38 offen offset:1024
    v_exp_f32 v90, v90
    v_exp_f32 v91, v91
    v_exp_f32 v92, v92
    v_exp_f32 v93, v93
    v_exp_f32 v94, v94
    v_exp_f32 v95, v95
    v_exp_f32 v96, v96
    v_exp_f32 v97, v97
    v_smfmac_f32_32x32x32_bf16 v[24:39], v[68:71], v[88:95], v112
    s_waitcnt lgkmcnt(0)
    buffer_load_dwordx4 a[248:251], v2, s[4:7], s38 offen offset:2048
    v_exp_f32 v98, v98
    v_exp_f32 v99, v99
    v_exp_f32 v100, v100
    v_mfma_f32_32x32x16_bf16 v[80:95], v[60:63], v[16:19], 0
    v_exp_f32 v101, v101
    v_exp_f32 v102, v102
    v_exp_f32 v103, v103
    v_exp_f32 v104, v104
    v_exp_f32 v105, v105
    v_smfmac_f32_32x32x32_bf16 v[40:55], v[64:67], v[96:103], v112
    buffer_load_dwordx4 a[252:255], v2, s[4:7], s38 offen offset:3072
    v_exp_f32 v106, v106
    v_exp_f32 v107, v107
    v_exp_f32 v108, v108
    v_exp_f32 v109, v109
    v_exp_f32 v110, v110
    v_exp_f32 v111, v111
    v_exp_f32 v80, v80
    v_exp_f32 v81, v81
    v_smfmac_f32_32x32x32_bf16 v[40:55], v[68:71], v[104:111], v112
    s_add_u32 s38, s24, 3954688
    buffer_load_dwordx4 v[128:131], v2, s[4:7], s38 offen offset:0
    v_exp_f32 v82, v82
    v_exp_f32 v83, v83
    v_exp_f32 v84, v84
    v_mfma_f32_32x32x16_bf16 v[96:111], v[60:63], v[20:23], 0
    ds_read_b128 v[56:59], v113 offset:64704
    ds_read_b128 v[64:67], v114 offset:64704
    ds_read_b128 v[68:71], v115 offset:64704
    v_exp_f32 v85, v85
    v_exp_f32 v86, v86
    v_exp_f32 v87, v87
    v_exp_f32 v88, v88
    v_exp_f32 v89, v89
    v_smfmac_f32_32x32x32_bf16 v[24:39], v[72:75], v[80:87], v112
    buffer_load_dwordx4 v[132:135], v2, s[4:7], s38 offen offset:1024
    v_exp_f32 v90, v90
    v_exp_f32 v91, v91
    v_exp_f32 v92, v92
    v_exp_f32 v93, v93
    v_exp_f32 v94, v94
    v_exp_f32 v95, v95
    v_exp_f32 v96, v96
    v_exp_f32 v97, v97
    v_smfmac_f32_32x32x32_bf16 v[24:39], v[76:79], v[88:95], v112
    s_waitcnt lgkmcnt(0)
    buffer_load_dwordx4 v[136:139], v2, s[4:7], s38 offen offset:2048
    v_exp_f32 v98, v98
    v_exp_f32 v99, v99
    v_exp_f32 v100, v100
    v_mfma_f32_32x32x16_bf16 v[80:95], v[56:59], v[16:19], 0
    v_exp_f32 v101, v101
    v_exp_f32 v102, v102
    v_exp_f32 v103, v103
    v_exp_f32 v104, v104
    v_exp_f32 v105, v105
    v_smfmac_f32_32x32x32_bf16 v[40:55], v[72:75], v[96:103], v112
    buffer_load_dwordx4 v[140:143], v2, s[4:7], s38 offen offset:3072
    v_exp_f32 v106, v106
    v_exp_f32 v107, v107
    v_exp_f32 v108, v108
    v_exp_f32 v109, v109
    v_exp_f32 v110, v110
    v_exp_f32 v111, v111
    v_exp_f32 v80, v80
    v_exp_f32 v81, v81
    v_smfmac_f32_32x32x32_bf16 v[40:55], v[76:79], v[104:111], v112
    s_add_u32 s38, s24, 3958784
    buffer_load_dwordx4 v[144:147], v2, s[4:7], s38 offen offset:0
    v_exp_f32 v82, v82
    v_exp_f32 v83, v83
    v_exp_f32 v84, v84
    v_mfma_f32_32x32x16_bf16 v[96:111], v[56:59], v[20:23], 0
    v_add_u32 v113, 66784, v113
    v_add_u32 v114, 66784, v114
    v_add_u32 v115, 66784, v115
    ds_read_b128 v[60:63], v113 offset:0
    ds_read_b128 v[72:75], v114 offset:0
    ds_read_b128 v[76:79], v115 offset:0
    v_exp_f32 v85, v85
    v_exp_f32 v86, v86
    v_exp_f32 v87, v87
    v_exp_f32 v88, v88
    v_exp_f32 v89, v89
    v_smfmac_f32_32x32x32_bf16 v[24:39], v[64:67], v[80:87], v112
    buffer_load_dwordx4 v[148:151], v2, s[4:7], s38 offen offset:1024
    v_exp_f32 v90, v90
    v_exp_f32 v91, v91
    v_exp_f32 v92, v92
    v_exp_f32 v93, v93
    v_exp_f32 v94, v94
    v_exp_f32 v95, v95
    v_exp_f32 v96, v96
    v_exp_f32 v97, v97
    v_smfmac_f32_32x32x32_bf16 v[24:39], v[68:71], v[88:95], v112
    s_waitcnt lgkmcnt(0)
    buffer_load_dwordx4 v[152:155], v2, s[4:7], s38 offen offset:2048
    v_exp_f32 v98, v98
    v_exp_f32 v99, v99
    v_exp_f32 v100, v100
    v_mfma_f32_32x32x16_bf16 v[80:95], v[60:63], v[16:19], 0
    v_exp_f32 v101, v101
    v_exp_f32 v102, v102
    v_exp_f32 v103, v103
    v_exp_f32 v104, v104
    v_exp_f32 v105, v105
    v_smfmac_f32_32x32x32_bf16 v[40:55], v[64:67], v[96:103], v112
    buffer_load_dwordx4 v[156:159], v2, s[4:7], s38 offen offset:3072
    v_exp_f32 v106, v106
    v_exp_f32 v107, v107
    v_exp_f32 v108, v108
    v_exp_f32 v109, v109
    v_exp_f32 v110, v110
    v_exp_f32 v111, v111
    v_exp_f32 v80, v80
    v_exp_f32 v81, v81
    v_smfmac_f32_32x32x32_bf16 v[40:55], v[68:71], v[104:111], v112
    s_add_u32 s38, s24, 3962880
    buffer_load_dwordx4 v[160:163], v2, s[4:7], s38 offen offset:0
    v_exp_f32 v82, v82
    v_exp_f32 v83, v83
    v_exp_f32 v84, v84
    v_mfma_f32_32x32x16_bf16 v[96:111], v[60:63], v[20:23], 0
    ds_read_b128 v[56:59], v113 offset:2848
    ds_read_b128 v[64:67], v114 offset:2848
    ds_read_b128 v[68:71], v115 offset:2848
    v_exp_f32 v85, v85
    v_exp_f32 v86, v86
    v_exp_f32 v87, v87
    v_exp_f32 v88, v88
    v_exp_f32 v89, v89
    v_smfmac_f32_32x32x32_bf16 v[24:39], v[72:75], v[80:87], v112
    buffer_load_dwordx4 v[164:167], v2, s[4:7], s38 offen offset:1024
    v_exp_f32 v90, v90
    v_exp_f32 v91, v91
    v_exp_f32 v92, v92
    v_exp_f32 v93, v93
    v_exp_f32 v94, v94
    v_exp_f32 v95, v95
    v_exp_f32 v96, v96
    v_exp_f32 v97, v97
    v_smfmac_f32_32x32x32_bf16 v[24:39], v[76:79], v[88:95], v112
    s_waitcnt lgkmcnt(0)
    buffer_load_dwordx4 v[168:171], v2, s[4:7], s38 offen offset:2048
    v_exp_f32 v98, v98
    v_exp_f32 v99, v99
    v_exp_f32 v100, v100
    v_mfma_f32_32x32x16_bf16 v[80:95], v[56:59], v[16:19], 0
    v_exp_f32 v101, v101
    v_exp_f32 v102, v102
    v_exp_f32 v103, v103
    v_exp_f32 v104, v104
    v_exp_f32 v105, v105
    v_smfmac_f32_32x32x32_bf16 v[40:55], v[72:75], v[96:103], v112
    buffer_load_dwordx4 v[172:175], v2, s[4:7], s38 offen offset:3072
    v_exp_f32 v106, v106
    v_exp_f32 v107, v107
    v_exp_f32 v108, v108
    v_exp_f32 v109, v109
    v_exp_f32 v110, v110
    v_exp_f32 v111, v111
    v_exp_f32 v80, v80
    v_exp_f32 v81, v81
    v_smfmac_f32_32x32x32_bf16 v[40:55], v[76:79], v[104:111], v112
    s_add_u32 s38, s24, 3966976
    buffer_load_dwordx4 v[176:179], v2, s[4:7], s38 offen offset:0
    v_exp_f32 v82, v82
    v_exp_f32 v83, v83
    v_exp_f32 v84, v84
    v_mfma_f32_32x32x16_bf16 v[96:111], v[56:59], v[20:23], 0
    ds_read_b128 v[60:63], v113 offset:4928
    ds_read_b128 v[72:75], v114 offset:4928
    ds_read_b128 v[76:79], v115 offset:4928
    v_exp_f32 v85, v85
    v_exp_f32 v86, v86
    v_exp_f32 v87, v87
    v_exp_f32 v88, v88
    v_exp_f32 v89, v89
    v_smfmac_f32_32x32x32_bf16 v[24:39], v[64:67], v[80:87], v112
    buffer_load_dwordx4 v[180:183], v2, s[4:7], s38 offen offset:1024
    v_exp_f32 v90, v90
    v_exp_f32 v91, v91
    v_exp_f32 v92, v92
    v_exp_f32 v93, v93
    v_exp_f32 v94, v94
    v_exp_f32 v95, v95
    v_exp_f32 v96, v96
    v_exp_f32 v97, v97
    v_smfmac_f32_32x32x32_bf16 v[24:39], v[68:71], v[88:95], v112
    s_waitcnt lgkmcnt(0)
    buffer_load_dwordx4 v[184:187], v2, s[4:7], s38 offen offset:2048
    v_exp_f32 v98, v98
    v_exp_f32 v99, v99
    v_exp_f32 v100, v100
    v_mfma_f32_32x32x16_bf16 v[80:95], v[60:63], v[16:19], 0
    v_exp_f32 v101, v101
    v_exp_f32 v102, v102
    v_exp_f32 v103, v103
    v_exp_f32 v104, v104
    v_exp_f32 v105, v105
    v_smfmac_f32_32x32x32_bf16 v[40:55], v[64:67], v[96:103], v112
    buffer_load_dwordx4 v[188:191], v2, s[4:7], s38 offen offset:3072
    v_exp_f32 v106, v106
    v_exp_f32 v107, v107
    v_exp_f32 v108, v108
    v_exp_f32 v109, v109
    v_exp_f32 v110, v110
    v_exp_f32 v111, v111
    v_exp_f32 v80, v80
    v_exp_f32 v81, v81
    v_smfmac_f32_32x32x32_bf16 v[40:55], v[68:71], v[104:111], v112
    s_add_u32 s38, s24, 3971072
    buffer_load_dwordx4 v[192:195], v2, s[4:7], s38 offen offset:0
    v_exp_f32 v82, v82
    v_exp_f32 v83, v83
    v_exp_f32 v84, v84
    v_mfma_f32_32x32x16_bf16 v[96:111], v[60:63], v[20:23], 0
    ds_read_b128 v[56:59], v113 offset:7008
    ds_read_b128 v[64:67], v114 offset:7008
    ds_read_b128 v[68:71], v115 offset:7008
    v_exp_f32 v85, v85
    v_exp_f32 v86, v86
    v_exp_f32 v87, v87
    v_exp_f32 v88, v88
    v_exp_f32 v89, v89
    v_smfmac_f32_32x32x32_bf16 v[24:39], v[72:75], v[80:87], v112
    buffer_load_dwordx4 v[196:199], v2, s[4:7], s38 offen offset:1024
    v_exp_f32 v90, v90
    v_exp_f32 v91, v91
    v_exp_f32 v92, v92
    v_exp_f32 v93, v93
    v_exp_f32 v94, v94
    v_exp_f32 v95, v95
    v_exp_f32 v96, v96
    v_exp_f32 v97, v97
    v_smfmac_f32_32x32x32_bf16 v[24:39], v[76:79], v[88:95], v112
    s_waitcnt lgkmcnt(0)
    buffer_load_dwordx4 v[200:203], v2, s[4:7], s38 offen offset:2048
    v_exp_f32 v98, v98
    v_exp_f32 v99, v99
    v_exp_f32 v100, v100
    v_mfma_f32_32x32x16_bf16 v[80:95], v[56:59], v[16:19], 0
    v_exp_f32 v101, v101
    v_exp_f32 v102, v102
    v_exp_f32 v103, v103
    v_exp_f32 v104, v104
    v_exp_f32 v105, v105
    v_smfmac_f32_32x32x32_bf16 v[40:55], v[72:75], v[96:103], v112
    buffer_load_dwordx4 v[204:207], v2, s[4:7], s38 offen offset:3072
    v_exp_f32 v106, v106
    v_exp_f32 v107, v107
    v_exp_f32 v108, v108
    v_exp_f32 v109, v109
    v_exp_f32 v110, v110
    v_exp_f32 v111, v111
    v_exp_f32 v80, v80
    v_exp_f32 v81, v81
    v_smfmac_f32_32x32x32_bf16 v[40:55], v[76:79], v[104:111], v112
    s_barrier
    v_exp_f32 v82, v82
    v_exp_f32 v83, v83
    v_exp_f32 v84, v84
    v_mfma_f32_32x32x16_bf16 v[96:111], v[56:59], v[20:23], 0
    ds_read_b128 v[60:63], v113 offset:9088
    ds_read_b128 v[72:75], v114 offset:9088
    ds_read_b128 v[76:79], v115 offset:9088
    v_exp_f32 v85, v85
    v_exp_f32 v86, v86
    v_exp_f32 v87, v87
    v_exp_f32 v88, v88
    v_exp_f32 v89, v89
    v_smfmac_f32_32x32x32_bf16 v[24:39], v[64:67], v[80:87], v112
    global_load_dword v0, v124, s[92:93]
    v_exp_f32 v90, v90
    v_exp_f32 v91, v91
    v_exp_f32 v92, v92
    v_exp_f32 v93, v93
    v_exp_f32 v94, v94
    v_exp_f32 v95, v95
    v_exp_f32 v96, v96
    v_exp_f32 v97, v97
    v_smfmac_f32_32x32x32_bf16 v[24:39], v[68:71], v[88:95], v112
    s_waitcnt lgkmcnt(0)
    s_add_u32 m0, s26, 32768
    v_exp_f32 v98, v98
    v_exp_f32 v99, v99
    v_exp_f32 v100, v100
    v_mfma_f32_32x32x16_bf16 v[80:95], v[60:63], v[16:19], 0
    s_add_u32 s43, s25, 1114112
    v_exp_f32 v101, v101
    v_exp_f32 v102, v102
    v_exp_f32 v103, v103
    v_exp_f32 v104, v104
    v_exp_f32 v105, v105
    v_smfmac_f32_32x32x32_bf16 v[40:55], v[64:67], v[96:103], v112
    buffer_load_dwordx4 v2, s[4:7], s43 offen offset:0  lds
    v_exp_f32 v106, v106
    v_exp_f32 v107, v107
    v_exp_f32 v108, v108
    v_exp_f32 v109, v109
    v_exp_f32 v110, v110
    v_exp_f32 v111, v111
    v_exp_f32 v80, v80
    v_exp_f32 v81, v81
    v_smfmac_f32_32x32x32_bf16 v[40:55], v[68:71], v[104:111], v112
    buffer_load_dwordx4 v2, s[4:7], s43 offen offset:1024  lds
    v_exp_f32 v82, v82
    v_exp_f32 v83, v83
    v_exp_f32 v84, v84
    v_mfma_f32_32x32x16_bf16 v[96:111], v[60:63], v[20:23], 0
    ds_read_b128 v[56:59], v113 offset:11168
    ds_read_b128 v[64:67], v114 offset:11168
    ds_read_b128 v[68:71], v115 offset:11168
    v_exp_f32 v85, v85
    v_exp_f32 v86, v86
    v_exp_f32 v87, v87
    v_exp_f32 v88, v88
    v_exp_f32 v89, v89
    v_smfmac_f32_32x32x32_bf16 v[24:39], v[72:75], v[80:87], v112
    buffer_load_dwordx4 v2, s[4:7], s43 offen offset:2048  lds
    v_exp_f32 v90, v90
    v_exp_f32 v91, v91
    v_exp_f32 v92, v92
    v_exp_f32 v93, v93
    v_exp_f32 v94, v94
    v_exp_f32 v95, v95
    v_exp_f32 v96, v96
    v_exp_f32 v97, v97
    v_smfmac_f32_32x32x32_bf16 v[24:39], v[76:79], v[88:95], v112
    s_waitcnt lgkmcnt(0)
    s_waitcnt vmcnt(32)
    buffer_load_dwordx4 v2, s[4:7], s43 offen offset:3072  lds
    v_exp_f32 v98, v98
    v_exp_f32 v99, v99
    v_exp_f32 v100, v100
    v_mfma_f32_32x32x16_bf16 v[80:95], v[56:59], v[16:19], 0
    s_add_u32 m0, s26, 36864
    v_exp_f32 v101, v101
    v_exp_f32 v102, v102
    v_exp_f32 v103, v103
    v_exp_f32 v104, v104
    v_exp_f32 v105, v105
    v_smfmac_f32_32x32x32_bf16 v[40:55], v[72:75], v[96:103], v112
    s_add_u32 s43, s25, 1118208
    buffer_load_dwordx4 v2, s[4:7], s43 offen offset:0  lds
    v_exp_f32 v106, v106
    v_exp_f32 v107, v107
    v_exp_f32 v108, v108
    v_exp_f32 v109, v109
    v_exp_f32 v110, v110
    v_exp_f32 v111, v111
    v_exp_f32 v80, v80
    v_exp_f32 v81, v81
    v_smfmac_f32_32x32x32_bf16 v[40:55], v[76:79], v[104:111], v112
    buffer_load_dwordx4 v2, s[4:7], s43 offen offset:1024  lds
    v_exp_f32 v82, v82
    v_exp_f32 v83, v83
    v_exp_f32 v84, v84
    v_mfma_f32_32x32x16_bf16 v[96:111], v[56:59], v[20:23], 0
    ds_read_b128 v[60:63], v113 offset:13248
    ds_read_b128 v[72:75], v114 offset:13248
    ds_read_b128 v[76:79], v115 offset:13248
    v_exp_f32 v85, v85
    v_exp_f32 v86, v86
    v_exp_f32 v87, v87
    v_exp_f32 v88, v88
    v_exp_f32 v89, v89
    v_smfmac_f32_32x32x32_bf16 v[24:39], v[64:67], v[80:87], v112
    buffer_load_dwordx4 v2, s[4:7], s43 offen offset:2048  lds
    v_exp_f32 v90, v90
    v_exp_f32 v91, v91
    v_exp_f32 v92, v92
    v_exp_f32 v93, v93
    v_exp_f32 v94, v94
    v_exp_f32 v95, v95
    v_exp_f32 v96, v96
    v_exp_f32 v97, v97
    v_smfmac_f32_32x32x32_bf16 v[24:39], v[68:71], v[88:95], v112
    s_waitcnt lgkmcnt(0)
    buffer_load_dwordx4 v2, s[4:7], s43 offen offset:3072  lds
    v_exp_f32 v98, v98
    v_exp_f32 v99, v99
    v_exp_f32 v100, v100
    v_mfma_f32_32x32x16_bf16 v[80:95], v[60:63], v[16:19], 0
    s_add_u32 m0, s26, 65536
    v_exp_f32 v101, v101
    v_exp_f32 v102, v102
    v_exp_f32 v103, v103
    v_exp_f32 v104, v104
    v_exp_f32 v105, v105
    v_smfmac_f32_32x32x32_bf16 v[40:55], v[64:67], v[96:103], v112
    s_add_u32 s43, s25, 1146880
    buffer_load_dwordx4 v2, s[4:7], s43 offen offset:0  lds
    v_exp_f32 v106, v106
    v_exp_f32 v107, v107
    v_exp_f32 v108, v108
    v_exp_f32 v109, v109
    v_exp_f32 v110, v110
    v_exp_f32 v111, v111
    v_exp_f32 v80, v80
    v_exp_f32 v81, v81
    v_smfmac_f32_32x32x32_bf16 v[40:55], v[68:71], v[104:111], v112
    buffer_load_dwordx4 v2, s[4:7], s43 offen offset:1024  lds
    v_exp_f32 v82, v82
    v_exp_f32 v83, v83
    v_exp_f32 v84, v84
    v_mfma_f32_32x32x16_bf16 v[96:111], v[60:63], v[20:23], 0
    ds_read_b128 v[56:59], v113 offset:15328
    ds_read_b128 v[64:67], v114 offset:15328
    ds_read_b128 v[68:71], v115 offset:15328
    v_exp_f32 v85, v85
    v_exp_f32 v86, v86
    v_exp_f32 v87, v87
    v_exp_f32 v88, v88
    v_exp_f32 v89, v89
    v_smfmac_f32_32x32x32_bf16 v[24:39], v[72:75], v[80:87], v112
    buffer_load_dwordx4 v2, s[4:7], s43 offen offset:2048  lds
    v_exp_f32 v90, v90
    v_exp_f32 v91, v91
    v_exp_f32 v92, v92
    v_exp_f32 v93, v93
    v_exp_f32 v94, v94
    v_exp_f32 v95, v95
    v_exp_f32 v96, v96
    v_exp_f32 v97, v97
    v_smfmac_f32_32x32x32_bf16 v[24:39], v[76:79], v[88:95], v112
    s_waitcnt lgkmcnt(0)
    buffer_load_dwordx4 v2, s[4:7], s43 offen offset:3072  lds
    v_exp_f32 v98, v98
    v_exp_f32 v99, v99
    v_exp_f32 v100, v100
    v_mfma_f32_32x32x16_bf16 v[80:95], v[56:59], v[16:19], 0
    s_add_u32 m0, s26, 69632
    v_exp_f32 v101, v101
    v_exp_f32 v102, v102
    v_exp_f32 v103, v103
    v_exp_f32 v104, v104
    v_exp_f32 v105, v105
    v_smfmac_f32_32x32x32_bf16 v[40:55], v[72:75], v[96:103], v112
    s_add_u32 s43, s25, 1150976
    buffer_load_dwordx4 v2, s[4:7], s43 offen offset:0  lds
    v_exp_f32 v106, v106
    v_exp_f32 v107, v107
    v_exp_f32 v108, v108
    v_exp_f32 v109, v109
    v_exp_f32 v110, v110
    v_exp_f32 v111, v111
    v_exp_f32 v80, v80
    v_exp_f32 v81, v81
    v_smfmac_f32_32x32x32_bf16 v[40:55], v[76:79], v[104:111], v112
    buffer_load_dwordx4 v2, s[4:7], s43 offen offset:1024  lds
    v_exp_f32 v82, v82
    v_exp_f32 v83, v83
    v_exp_f32 v84, v84
    v_mfma_f32_32x32x16_bf16 v[96:111], v[56:59], v[20:23], 0
    ds_read_b128 v[60:63], v113 offset:17408
    ds_read_b128 v[72:75], v114 offset:17408
    ds_read_b128 v[76:79], v115 offset:17408
    v_exp_f32 v85, v85
    v_exp_f32 v86, v86
    v_exp_f32 v87, v87
    v_exp_f32 v88, v88
    v_exp_f32 v89, v89
    v_smfmac_f32_32x32x32_bf16 v[24:39], v[64:67], v[80:87], v112
    buffer_load_dwordx4 v2, s[4:7], s43 offen offset:2048  lds
    v_exp_f32 v90, v90
    v_exp_f32 v91, v91
    v_exp_f32 v92, v92
    v_exp_f32 v93, v93
    v_exp_f32 v94, v94
    v_exp_f32 v95, v95
    v_exp_f32 v96, v96
    v_exp_f32 v97, v97
    v_smfmac_f32_32x32x32_bf16 v[24:39], v[68:71], v[88:95], v112
    s_waitcnt lgkmcnt(0)
    buffer_load_dwordx4 v2, s[4:7], s43 offen offset:3072  lds
    v_exp_f32 v98, v98
    v_exp_f32 v99, v99
    v_exp_f32 v100, v100
    v_mfma_f32_32x32x16_bf16 v[80:95], v[60:63], v[16:19], 0
    s_add_u32 s38, s24, 3975168
    v_exp_f32 v101, v101
    v_exp_f32 v102, v102
    v_exp_f32 v103, v103
    v_exp_f32 v104, v104
    v_exp_f32 v105, v105
    v_smfmac_f32_32x32x32_bf16 v[40:55], v[64:67], v[96:103], v112
    buffer_load_dwordx4 v[208:211], v2, s[4:7], s38 offen offset:0
    v_exp_f32 v106, v106
    v_exp_f32 v107, v107
    v_exp_f32 v108, v108
    v_exp_f32 v109, v109
    v_exp_f32 v110, v110
    v_exp_f32 v111, v111
    v_exp_f32 v80, v80
    v_exp_f32 v81, v81
    v_smfmac_f32_32x32x32_bf16 v[40:55], v[68:71], v[104:111], v112
    buffer_load_dwordx4 v[212:215], v2, s[4:7], s38 offen offset:1024
    v_exp_f32 v82, v82
    v_exp_f32 v83, v83
    v_exp_f32 v84, v84
    v_mfma_f32_32x32x16_bf16 v[96:111], v[60:63], v[20:23], 0
    ds_read_b128 v[56:59], v113 offset:20256
    ds_read_b128 v[64:67], v114 offset:20256
    ds_read_b128 v[68:71], v115 offset:20256
    v_exp_f32 v85, v85
    v_exp_f32 v86, v86
    v_exp_f32 v87, v87
    v_exp_f32 v88, v88
    v_exp_f32 v89, v89
    v_smfmac_f32_32x32x32_bf16 v[24:39], v[72:75], v[80:87], v112
    buffer_load_dwordx4 v[216:219], v2, s[4:7], s38 offen offset:2048
    v_exp_f32 v90, v90
    v_exp_f32 v91, v91
    v_exp_f32 v92, v92
    v_exp_f32 v93, v93
    v_exp_f32 v94, v94
    v_exp_f32 v95, v95
    v_exp_f32 v96, v96
    v_exp_f32 v97, v97
    v_smfmac_f32_32x32x32_bf16 v[24:39], v[76:79], v[88:95], v112
    s_waitcnt lgkmcnt(0)
    buffer_load_dwordx4 v[220:223], v2, s[4:7], s38 offen offset:3072
    v_exp_f32 v98, v98
    v_exp_f32 v99, v99
    v_exp_f32 v100, v100
    v_mfma_f32_32x32x16_bf16 v[80:95], v[56:59], v[16:19], 0
    s_add_u32 s38, s24, 3979264
    v_exp_f32 v101, v101
    v_exp_f32 v102, v102
    v_exp_f32 v103, v103
    v_exp_f32 v104, v104
    v_exp_f32 v105, v105
    v_smfmac_f32_32x32x32_bf16 v[40:55], v[72:75], v[96:103], v112
    buffer_load_dwordx4 v[224:227], v2, s[4:7], s38 offen offset:0
    v_exp_f32 v106, v106
    v_exp_f32 v107, v107
    v_exp_f32 v108, v108
    v_exp_f32 v109, v109
    v_exp_f32 v110, v110
    v_exp_f32 v111, v111
    v_exp_f32 v80, v80
    v_exp_f32 v81, v81
    v_smfmac_f32_32x32x32_bf16 v[40:55], v[76:79], v[104:111], v112
    buffer_load_dwordx4 v[228:231], v2, s[4:7], s38 offen offset:1024
    v_exp_f32 v82, v82
    v_exp_f32 v83, v83
    v_exp_f32 v84, v84
    v_mfma_f32_32x32x16_bf16 v[96:111], v[56:59], v[20:23], 0
    ds_read_b128 v[60:63], v113 offset:22336
    ds_read_b128 v[72:75], v114 offset:22336
    ds_read_b128 v[76:79], v115 offset:22336
    v_exp_f32 v85, v85
    v_exp_f32 v86, v86
    v_exp_f32 v87, v87
    v_exp_f32 v88, v88
    v_exp_f32 v89, v89
    v_smfmac_f32_32x32x32_bf16 v[24:39], v[64:67], v[80:87], v112
    buffer_load_dwordx4 v[232:235], v2, s[4:7], s38 offen offset:2048
    v_exp_f32 v90, v90
    v_exp_f32 v91, v91
    v_exp_f32 v92, v92
    v_exp_f32 v93, v93
    v_exp_f32 v94, v94
    v_exp_f32 v95, v95
    v_exp_f32 v96, v96
    v_exp_f32 v97, v97
    v_smfmac_f32_32x32x32_bf16 v[24:39], v[68:71], v[88:95], v112
    s_waitcnt lgkmcnt(0)
    buffer_load_dwordx4 v[236:239], v2, s[4:7], s38 offen offset:3072
    v_exp_f32 v98, v98
    v_exp_f32 v99, v99
    v_exp_f32 v100, v100
    v_mfma_f32_32x32x16_bf16 v[80:95], v[60:63], v[16:19], 0
    s_add_u32 s38, s24, 3983360
    v_exp_f32 v101, v101
    v_exp_f32 v102, v102
    v_exp_f32 v103, v103
    v_exp_f32 v104, v104
    v_exp_f32 v105, v105
    v_smfmac_f32_32x32x32_bf16 v[40:55], v[64:67], v[96:103], v112
    buffer_load_dwordx4 v[240:243], v2, s[4:7], s38 offen offset:0
    v_exp_f32 v106, v106
    v_exp_f32 v107, v107
    v_exp_f32 v108, v108
    v_exp_f32 v109, v109
    v_exp_f32 v110, v110
    v_exp_f32 v111, v111
    v_exp_f32 v80, v80
    v_exp_f32 v81, v81
    v_smfmac_f32_32x32x32_bf16 v[40:55], v[68:71], v[104:111], v112
    buffer_load_dwordx4 v[244:247], v2, s[4:7], s38 offen offset:1024
    v_exp_f32 v82, v82
    v_exp_f32 v83, v83
    v_exp_f32 v84, v84
    v_mfma_f32_32x32x16_bf16 v[96:111], v[60:63], v[20:23], 0
    ds_read_b128 v[56:59], v113 offset:24416
    ds_read_b128 v[64:67], v114 offset:24416
    ds_read_b128 v[68:71], v115 offset:24416
    v_exp_f32 v85, v85
    v_exp_f32 v86, v86
    v_exp_f32 v87, v87
    v_exp_f32 v88, v88
    v_exp_f32 v89, v89
    v_smfmac_f32_32x32x32_bf16 v[24:39], v[72:75], v[80:87], v112
    buffer_load_dwordx4 v[248:251], v2, s[4:7], s38 offen offset:2048
    v_exp_f32 v90, v90
    v_exp_f32 v91, v91
    v_exp_f32 v92, v92
    v_exp_f32 v93, v93
    v_exp_f32 v94, v94
    v_exp_f32 v95, v95
    v_exp_f32 v96, v96
    v_exp_f32 v97, v97
    v_smfmac_f32_32x32x32_bf16 v[24:39], v[76:79], v[88:95], v112
    s_waitcnt lgkmcnt(0)
    buffer_load_dwordx4 v[252:255], v2, s[4:7], s38 offen offset:3072
    v_exp_f32 v98, v98
    v_exp_f32 v99, v99
    v_exp_f32 v100, v100
    v_mfma_f32_32x32x16_bf16 v[80:95], v[56:59], v[16:19], 0
    s_add_u32 s38, s23, 557056
    v_exp_f32 v101, v101
    v_exp_f32 v102, v102
    v_exp_f32 v103, v103
    v_exp_f32 v104, v104
    v_exp_f32 v105, v105
    v_smfmac_f32_32x32x32_bf16 v[40:55], v[72:75], v[96:103], v112
    buffer_load_dwordx4 a[0:3], v2, s[4:7], s38 offen offset:0
    v_exp_f32 v106, v106
    v_exp_f32 v107, v107
    v_exp_f32 v108, v108
    v_exp_f32 v109, v109
    v_exp_f32 v110, v110
    v_exp_f32 v111, v111
    v_exp_f32 v80, v80
    v_exp_f32 v81, v81
    v_smfmac_f32_32x32x32_bf16 v[40:55], v[76:79], v[104:111], v112
    buffer_load_dwordx4 a[4:7], v2, s[4:7], s38 offen offset:1024
    v_exp_f32 v82, v82
    v_exp_f32 v83, v83
    v_exp_f32 v84, v84
    v_mfma_f32_32x32x16_bf16 v[96:111], v[56:59], v[20:23], 0
    ds_read_b128 v[60:63], v113 offset:26496
    ds_read_b128 v[72:75], v114 offset:26496
    ds_read_b128 v[76:79], v115 offset:26496
    v_exp_f32 v85, v85
    v_exp_f32 v86, v86
    v_exp_f32 v87, v87
    v_exp_f32 v88, v88
    v_exp_f32 v89, v89
    v_smfmac_f32_32x32x32_bf16 v[24:39], v[64:67], v[80:87], v112
    buffer_load_dwordx4 a[8:11], v2, s[4:7], s38 offen offset:2048
    v_exp_f32 v90, v90
    v_exp_f32 v91, v91
    v_exp_f32 v92, v92
    v_exp_f32 v93, v93
    v_exp_f32 v94, v94
    v_exp_f32 v95, v95
    v_exp_f32 v96, v96
    v_exp_f32 v97, v97
    v_smfmac_f32_32x32x32_bf16 v[24:39], v[68:71], v[88:95], v112
    s_waitcnt lgkmcnt(0)
    s_waitcnt vmcnt(32)
    buffer_load_dwordx4 a[12:15], v2, s[4:7], s38 offen offset:3072
    v_exp_f32 v98, v98
    v_exp_f32 v99, v99
    v_exp_f32 v100, v100
    v_mfma_f32_32x32x16_bf16 v[80:95], v[60:63], v[16:19], 0
    s_add_u32 s38, s23, 561152
    v_exp_f32 v101, v101
    v_exp_f32 v102, v102
    v_exp_f32 v103, v103
    v_exp_f32 v104, v104
    v_exp_f32 v105, v105
    v_smfmac_f32_32x32x32_bf16 v[40:55], v[64:67], v[96:103], v112
    buffer_load_dwordx4 a[16:19], v2, s[4:7], s38 offen offset:0
    v_exp_f32 v106, v106
    v_exp_f32 v107, v107
    v_exp_f32 v108, v108
    v_exp_f32 v109, v109
    v_exp_f32 v110, v110
    v_exp_f32 v111, v111
    v_exp_f32 v80, v80
    v_exp_f32 v81, v81
    v_smfmac_f32_32x32x32_bf16 v[40:55], v[68:71], v[104:111], v112
    buffer_load_dwordx4 a[20:23], v2, s[4:7], s38 offen offset:1024
    v_exp_f32 v82, v82
    v_exp_f32 v83, v83
    v_exp_f32 v84, v84
    v_mfma_f32_32x32x16_bf16 v[96:111], v[60:63], v[20:23], 0
    ds_read_b128 v[56:59], v113 offset:28576
    ds_read_b128 v[64:67], v114 offset:28576
    ds_read_b128 v[68:71], v115 offset:28576
    v_exp_f32 v85, v85
    v_exp_f32 v86, v86
    v_exp_f32 v87, v87
    v_exp_f32 v88, v88
    v_exp_f32 v89, v89
    v_smfmac_f32_32x32x32_bf16 v[24:39], v[72:75], v[80:87], v112
    buffer_load_dwordx4 a[24:27], v2, s[4:7], s38 offen offset:2048
    v_exp_f32 v90, v90
    v_exp_f32 v91, v91
    v_exp_f32 v92, v92
    v_exp_f32 v93, v93
    v_exp_f32 v94, v94
    v_exp_f32 v95, v95
    v_exp_f32 v96, v96
    v_exp_f32 v97, v97
    v_smfmac_f32_32x32x32_bf16 v[24:39], v[76:79], v[88:95], v112
    s_waitcnt lgkmcnt(0)
    buffer_load_dwordx4 a[28:31], v2, s[4:7], s38 offen offset:3072
    v_exp_f32 v98, v98
    v_exp_f32 v99, v99
    v_exp_f32 v100, v100
    v_mfma_f32_32x32x16_bf16 v[80:95], v[56:59], v[16:19], 0
    s_add_u32 s38, s23, 565248
    v_exp_f32 v101, v101
    v_exp_f32 v102, v102
    v_exp_f32 v103, v103
    v_exp_f32 v104, v104
    v_exp_f32 v105, v105
    v_smfmac_f32_32x32x32_bf16 v[40:55], v[72:75], v[96:103], v112
    buffer_load_dwordx4 a[32:35], v2, s[4:7], s38 offen offset:0
    v_exp_f32 v106, v106
    v_exp_f32 v107, v107
    v_exp_f32 v108, v108
    v_exp_f32 v109, v109
    v_exp_f32 v110, v110
    v_exp_f32 v111, v111
    v_exp_f32 v80, v80
    v_exp_f32 v81, v81
    v_smfmac_f32_32x32x32_bf16 v[40:55], v[76:79], v[104:111], v112
    buffer_load_dwordx4 a[36:39], v2, s[4:7], s38 offen offset:1024
    v_exp_f32 v82, v82
    v_exp_f32 v83, v83
    v_exp_f32 v84, v84
    v_mfma_f32_32x32x16_bf16 v[96:111], v[56:59], v[20:23], 0
    ds_read_b128 v[60:63], v113 offset:30656
    ds_read_b128 v[72:75], v114 offset:30656
    ds_read_b128 v[76:79], v115 offset:30656
    v_exp_f32 v85, v85
    v_exp_f32 v86, v86
    v_exp_f32 v87, v87
    v_exp_f32 v88, v88
    v_exp_f32 v89, v89
    v_smfmac_f32_32x32x32_bf16 v[24:39], v[64:67], v[80:87], v112
    buffer_load_dwordx4 a[40:43], v2, s[4:7], s38 offen offset:2048
    v_exp_f32 v90, v90
    v_exp_f32 v91, v91
    v_exp_f32 v92, v92
    v_exp_f32 v93, v93
    v_exp_f32 v94, v94
    v_exp_f32 v95, v95
    v_exp_f32 v96, v96
    v_exp_f32 v97, v97
    v_smfmac_f32_32x32x32_bf16 v[24:39], v[68:71], v[88:95], v112
    s_waitcnt lgkmcnt(0)
    buffer_load_dwordx4 a[44:47], v2, s[4:7], s38 offen offset:3072
    v_exp_f32 v98, v98
    v_exp_f32 v99, v99
    v_exp_f32 v100, v100
    v_mfma_f32_32x32x16_bf16 v[80:95], v[60:63], v[16:19], 0
    s_add_u32 s38, s23, 569344
    v_exp_f32 v101, v101
    v_exp_f32 v102, v102
    v_exp_f32 v103, v103
    v_exp_f32 v104, v104
    v_exp_f32 v105, v105
    v_smfmac_f32_32x32x32_bf16 v[40:55], v[64:67], v[96:103], v112
    buffer_load_dwordx4 a[48:51], v2, s[4:7], s38 offen offset:0
    v_exp_f32 v106, v106
    v_exp_f32 v107, v107
    v_exp_f32 v108, v108
    v_exp_f32 v109, v109
    v_exp_f32 v110, v110
    v_exp_f32 v111, v111
    v_exp_f32 v80, v80
    v_exp_f32 v81, v81
    v_smfmac_f32_32x32x32_bf16 v[40:55], v[68:71], v[104:111], v112
    buffer_load_dwordx4 a[52:55], v2, s[4:7], s38 offen offset:1024
    v_exp_f32 v82, v82
    v_exp_f32 v83, v83
    v_exp_f32 v84, v84
    v_mfma_f32_32x32x16_bf16 v[96:111], v[60:63], v[20:23], 0
    ds_read_b128 v[56:59], v113 offset:32736
    ds_read_b128 v[64:67], v114 offset:32736
    ds_read_b128 v[68:71], v115 offset:32736
    v_exp_f32 v85, v85
    v_exp_f32 v86, v86
    v_exp_f32 v87, v87
    v_exp_f32 v88, v88
    v_exp_f32 v89, v89
    v_smfmac_f32_32x32x32_bf16 v[24:39], v[72:75], v[80:87], v112
    buffer_load_dwordx4 a[56:59], v2, s[4:7], s38 offen offset:2048
    v_exp_f32 v90, v90
    v_exp_f32 v91, v91
    v_exp_f32 v92, v92
    v_exp_f32 v93, v93
    v_exp_f32 v94, v94
    v_exp_f32 v95, v95
    v_exp_f32 v96, v96
    v_exp_f32 v97, v97
    v_smfmac_f32_32x32x32_bf16 v[24:39], v[76:79], v[88:95], v112
    s_waitcnt lgkmcnt(0)
    buffer_load_dwordx4 a[60:63], v2, s[4:7], s38 offen offset:3072
    v_exp_f32 v98, v98
    v_exp_f32 v99, v99
    v_exp_f32 v100, v100
    v_mfma_f32_32x32x16_bf16 v[80:95], v[56:59], v[16:19], 0
    s_add_u32 s38, s23, 573440
    v_exp_f32 v101, v101
    v_exp_f32 v102, v102
    v_exp_f32 v103, v103
    v_exp_f32 v104, v104
    v_exp_f32 v105, v105
    v_smfmac_f32_32x32x32_bf16 v[40:55], v[72:75], v[96:103], v112
    buffer_load_dwordx4 a[64:67], v2, s[4:7], s38 offen offset:0
    v_exp_f32 v106, v106
    v_exp_f32 v107, v107
    v_exp_f32 v108, v108
    v_exp_f32 v109, v109
    v_exp_f32 v110, v110
    v_exp_f32 v111, v111
    v_exp_f32 v80, v80
    v_exp_f32 v81, v81
    v_smfmac_f32_32x32x32_bf16 v[40:55], v[76:79], v[104:111], v112
    buffer_load_dwordx4 a[68:71], v2, s[4:7], s38 offen offset:1024
    v_exp_f32 v82, v82
    v_exp_f32 v83, v83
    v_exp_f32 v84, v84
    v_mfma_f32_32x32x16_bf16 v[96:111], v[56:59], v[20:23], 0
    ds_read_b128 v[60:63], v113 offset:34816
    ds_read_b128 v[72:75], v114 offset:34816
    ds_read_b128 v[76:79], v115 offset:34816
    v_exp_f32 v85, v85
    v_exp_f32 v86, v86
    v_exp_f32 v87, v87
    v_exp_f32 v88, v88
    v_exp_f32 v89, v89
    v_smfmac_f32_32x32x32_bf16 v[24:39], v[64:67], v[80:87], v112
    buffer_load_dwordx4 a[72:75], v2, s[4:7], s38 offen offset:2048
    v_exp_f32 v90, v90
    v_exp_f32 v91, v91
    v_exp_f32 v92, v92
    v_exp_f32 v93, v93
    v_exp_f32 v94, v94
    v_exp_f32 v95, v95
    v_exp_f32 v96, v96
    v_exp_f32 v97, v97
    v_smfmac_f32_32x32x32_bf16 v[24:39], v[68:71], v[88:95], v112
    s_waitcnt lgkmcnt(0)
    buffer_load_dwordx4 a[76:79], v2, s[4:7], s38 offen offset:3072
    v_exp_f32 v98, v98
    v_exp_f32 v99, v99
    v_exp_f32 v100, v100
    v_mfma_f32_32x32x16_bf16 v[80:95], v[60:63], v[16:19], 0
    s_add_u32 s38, s23, 577536
    v_exp_f32 v101, v101
    v_exp_f32 v102, v102
    v_exp_f32 v103, v103
    v_exp_f32 v104, v104
    v_exp_f32 v105, v105
    v_smfmac_f32_32x32x32_bf16 v[40:55], v[64:67], v[96:103], v112
    buffer_load_dwordx4 a[80:83], v2, s[4:7], s38 offen offset:0
    v_exp_f32 v106, v106
    v_exp_f32 v107, v107
    v_exp_f32 v108, v108
    v_exp_f32 v109, v109
    v_exp_f32 v110, v110
    v_exp_f32 v111, v111
    v_exp_f32 v80, v80
    v_exp_f32 v81, v81
    v_smfmac_f32_32x32x32_bf16 v[40:55], v[68:71], v[104:111], v112
    buffer_load_dwordx4 a[84:87], v2, s[4:7], s38 offen offset:1024
    v_exp_f32 v82, v82
    v_exp_f32 v83, v83
    v_exp_f32 v84, v84
    v_mfma_f32_32x32x16_bf16 v[96:111], v[60:63], v[20:23], 0
    ds_read_b128 v[56:59], v113 offset:37664
    ds_read_b128 v[64:67], v114 offset:37664
    ds_read_b128 v[68:71], v115 offset:37664
    v_exp_f32 v85, v85
    v_exp_f32 v86, v86
    v_exp_f32 v87, v87
    v_exp_f32 v88, v88
    v_exp_f32 v89, v89
    v_smfmac_f32_32x32x32_bf16 v[24:39], v[72:75], v[80:87], v112
    buffer_load_dwordx4 a[88:91], v2, s[4:7], s38 offen offset:2048
    v_exp_f32 v90, v90
    v_exp_f32 v91, v91
    v_exp_f32 v92, v92
    v_exp_f32 v93, v93
    v_exp_f32 v94, v94
    v_exp_f32 v95, v95
    v_exp_f32 v96, v96
    v_exp_f32 v97, v97
    v_smfmac_f32_32x32x32_bf16 v[24:39], v[76:79], v[88:95], v112
    s_waitcnt lgkmcnt(0)
    buffer_load_dwordx4 a[92:95], v2, s[4:7], s38 offen offset:3072
    v_exp_f32 v98, v98
    v_exp_f32 v99, v99
    v_exp_f32 v100, v100
    v_mfma_f32_32x32x16_bf16 v[80:95], v[56:59], v[16:19], 0
    s_add_u32 s38, s23, 581632
    v_exp_f32 v101, v101
    v_exp_f32 v102, v102
    v_exp_f32 v103, v103
    v_exp_f32 v104, v104
    v_exp_f32 v105, v105
    v_smfmac_f32_32x32x32_bf16 v[40:55], v[72:75], v[96:103], v112
    buffer_load_dwordx4 a[96:99], v2, s[4:7], s38 offen offset:0
    v_exp_f32 v106, v106
    v_exp_f32 v107, v107
    v_exp_f32 v108, v108
    v_exp_f32 v109, v109
    v_exp_f32 v110, v110
    v_exp_f32 v111, v111
    v_exp_f32 v80, v80
    v_exp_f32 v81, v81
    v_smfmac_f32_32x32x32_bf16 v[40:55], v[76:79], v[104:111], v112
    buffer_load_dwordx4 a[100:103], v2, s[4:7], s38 offen offset:1024
    v_exp_f32 v82, v82
    v_exp_f32 v83, v83
    v_exp_f32 v84, v84
    v_mfma_f32_32x32x16_bf16 v[96:111], v[56:59], v[20:23], 0
    ds_read_b128 v[60:63], v113 offset:39744
    ds_read_b128 v[72:75], v114 offset:39744
    ds_read_b128 v[76:79], v115 offset:39744
    v_exp_f32 v85, v85
    v_exp_f32 v86, v86
    v_exp_f32 v87, v87
    v_exp_f32 v88, v88
    v_exp_f32 v89, v89
    v_smfmac_f32_32x32x32_bf16 v[24:39], v[64:67], v[80:87], v112
    buffer_load_dwordx4 a[104:107], v2, s[4:7], s38 offen offset:2048
    v_exp_f32 v90, v90
    v_exp_f32 v91, v91
    v_exp_f32 v92, v92
    v_exp_f32 v93, v93
    v_exp_f32 v94, v94
    v_exp_f32 v95, v95
    v_exp_f32 v96, v96
    v_exp_f32 v97, v97
    v_smfmac_f32_32x32x32_bf16 v[24:39], v[68:71], v[88:95], v112
    s_waitcnt lgkmcnt(0)
    buffer_load_dwordx4 a[108:111], v2, s[4:7], s38 offen offset:3072
    v_exp_f32 v98, v98
    v_exp_f32 v99, v99
    v_exp_f32 v100, v100
    v_mfma_f32_32x32x16_bf16 v[80:95], v[60:63], v[16:19], 0
    s_add_u32 s38, s23, 585728
    v_exp_f32 v101, v101
    v_exp_f32 v102, v102
    v_exp_f32 v103, v103
    v_exp_f32 v104, v104
    v_exp_f32 v105, v105
    v_smfmac_f32_32x32x32_bf16 v[40:55], v[64:67], v[96:103], v112
    buffer_load_dwordx4 a[112:115], v2, s[4:7], s38 offen offset:0
    v_exp_f32 v106, v106
    v_exp_f32 v107, v107
    v_exp_f32 v108, v108
    v_exp_f32 v109, v109
    v_exp_f32 v110, v110
    v_exp_f32 v111, v111
    v_exp_f32 v80, v80
    v_exp_f32 v81, v81
    v_smfmac_f32_32x32x32_bf16 v[40:55], v[68:71], v[104:111], v112
    buffer_load_dwordx4 a[116:119], v2, s[4:7], s38 offen offset:1024
    v_exp_f32 v82, v82
    v_exp_f32 v83, v83
    v_exp_f32 v84, v84
    v_mfma_f32_32x32x16_bf16 v[96:111], v[60:63], v[20:23], 0
    ds_read_b128 v[56:59], v113 offset:41824
    ds_read_b128 v[64:67], v114 offset:41824
    ds_read_b128 v[68:71], v115 offset:41824
    v_exp_f32 v85, v85
    v_exp_f32 v86, v86
    v_exp_f32 v87, v87
    v_exp_f32 v88, v88
    v_exp_f32 v89, v89
    v_smfmac_f32_32x32x32_bf16 v[24:39], v[72:75], v[80:87], v112
    buffer_load_dwordx4 a[120:123], v2, s[4:7], s38 offen offset:2048
    v_exp_f32 v90, v90
    v_exp_f32 v91, v91
    v_exp_f32 v92, v92
    v_exp_f32 v93, v93
    v_exp_f32 v94, v94
    v_exp_f32 v95, v95
    v_exp_f32 v96, v96
    v_exp_f32 v97, v97
    v_smfmac_f32_32x32x32_bf16 v[24:39], v[76:79], v[88:95], v112
    s_waitcnt lgkmcnt(0)
    s_waitcnt vmcnt(32)
    buffer_load_dwordx4 a[124:127], v2, s[4:7], s38 offen offset:3072
    v_exp_f32 v98, v98
    v_exp_f32 v99, v99
    v_exp_f32 v100, v100
    v_mfma_f32_32x32x16_bf16 v[80:95], v[56:59], v[16:19], 0
    s_add_u32 s42, s28, 14602240
    v_exp_f32 v101, v101
    v_exp_f32 v102, v102
    v_exp_f32 v103, v103
    v_exp_f32 v104, v104
    v_exp_f32 v105, v105
    v_smfmac_f32_32x32x32_bf16 v[40:55], v[72:75], v[96:103], v112
    buffer_load_dword v0, v120, s[4:7], s42 offen
    v_exp_f32 v106, v106
    v_exp_f32 v107, v107
    v_exp_f32 v108, v108
    v_exp_f32 v109, v109
    v_exp_f32 v110, v110
    v_exp_f32 v111, v111
    v_exp_f32 v80, v80
    v_exp_f32 v81, v81
    v_smfmac_f32_32x32x32_bf16 v[40:55], v[76:79], v[104:111], v112
    s_add_u32 s42, s28, 14618624
    buffer_load_dword v0, v120, s[4:7], s42 offen
    v_exp_f32 v82, v82
    v_exp_f32 v83, v83
    v_exp_f32 v84, v84
    v_mfma_f32_32x32x16_bf16 v[96:111], v[56:59], v[20:23], 0
    ds_read_b128 v[60:63], v113 offset:43904
    ds_read_b128 v[72:75], v114 offset:43904
    ds_read_b128 v[76:79], v115 offset:43904
    v_exp_f32 v85, v85
    v_exp_f32 v86, v86
    v_exp_f32 v87, v87
    v_exp_f32 v88, v88
    v_exp_f32 v89, v89
    v_smfmac_f32_32x32x32_bf16 v[24:39], v[64:67], v[80:87], v112
    s_add_u32 s42, s28, 14635008
    buffer_load_dword v0, v120, s[4:7], s42 offen
    v_exp_f32 v90, v90
    v_exp_f32 v91, v91
    v_exp_f32 v92, v92
    v_exp_f32 v93, v93
    v_exp_f32 v94, v94
    v_exp_f32 v95, v95
    v_exp_f32 v96, v96
    v_exp_f32 v97, v97
    v_smfmac_f32_32x32x32_bf16 v[24:39], v[68:71], v[88:95], v112
    s_waitcnt lgkmcnt(0)
    s_add_u32 s42, s28, 14651392
    v_exp_f32 v98, v98
    v_exp_f32 v99, v99
    v_exp_f32 v100, v100
    v_mfma_f32_32x32x16_bf16 v[80:95], v[60:63], v[16:19], 0
    v_exp_f32 v101, v101
    v_exp_f32 v102, v102
    v_exp_f32 v103, v103
    v_exp_f32 v104, v104
    v_exp_f32 v105, v105
    v_smfmac_f32_32x32x32_bf16 v[40:55], v[64:67], v[96:103], v112
    buffer_load_dword v0, v120, s[4:7], s42 offen
    v_exp_f32 v106, v106
    v_exp_f32 v107, v107
    v_exp_f32 v108, v108
    v_exp_f32 v109, v109
    v_exp_f32 v110, v110
    v_exp_f32 v111, v111
    v_exp_f32 v80, v80
    v_exp_f32 v81, v81
    v_smfmac_f32_32x32x32_bf16 v[40:55], v[68:71], v[104:111], v112
    s_add_u32 s42, s28, 14667776
    buffer_load_dword v0, v120, s[4:7], s42 offen
    v_exp_f32 v82, v82
    v_exp_f32 v83, v83
    v_exp_f32 v84, v84
    v_mfma_f32_32x32x16_bf16 v[96:111], v[60:63], v[20:23], 0
    ds_read_b128 v[56:59], v113 offset:45984
    ds_read_b128 v[64:67], v114 offset:45984
    ds_read_b128 v[68:71], v115 offset:45984
    v_exp_f32 v85, v85
    v_exp_f32 v86, v86
    v_exp_f32 v87, v87
    v_exp_f32 v88, v88
    v_exp_f32 v89, v89
    v_smfmac_f32_32x32x32_bf16 v[24:39], v[72:75], v[80:87], v112
    s_add_u32 s42, s28, 14684160
    buffer_load_dword v0, v120, s[4:7], s42 offen
    v_exp_f32 v90, v90
    v_exp_f32 v91, v91
    v_exp_f32 v92, v92
    v_exp_f32 v93, v93
    v_exp_f32 v94, v94
    v_exp_f32 v95, v95
    v_exp_f32 v96, v96
    v_exp_f32 v97, v97
    v_smfmac_f32_32x32x32_bf16 v[24:39], v[76:79], v[88:95], v112
    s_waitcnt lgkmcnt(0)
    s_add_u32 s42, s16, 7499776
    v_exp_f32 v98, v98
    v_exp_f32 v99, v99
    v_exp_f32 v100, v100
    v_mfma_f32_32x32x16_bf16 v[80:95], v[56:59], v[16:19], 0
    v_exp_f32 v101, v101
    v_exp_f32 v102, v102
    v_exp_f32 v103, v103
    v_exp_f32 v104, v104
    v_exp_f32 v105, v105
    v_smfmac_f32_32x32x32_bf16 v[40:55], v[72:75], v[96:103], v112
    buffer_load_dword v0, v3, s[4:7], s42 offen
    v_exp_f32 v106, v106
    v_exp_f32 v107, v107
    v_exp_f32 v108, v108
    v_exp_f32 v109, v109
    v_exp_f32 v110, v110
    v_exp_f32 v111, v111
    v_exp_f32 v80, v80
    v_exp_f32 v81, v81
    v_smfmac_f32_32x32x32_bf16 v[40:55], v[76:79], v[104:111], v112
    s_add_u32 s42, s18, 35205120
    buffer_load_dword v0, v118, s[4:7], s42 offen
    v_exp_f32 v82, v82
    v_exp_f32 v83, v83
    v_exp_f32 v84, v84
    v_mfma_f32_32x32x16_bf16 v[96:111], v[56:59], v[20:23], 0
    ds_read_b128 v[60:63], v113 offset:48064
    ds_read_b128 v[72:75], v114 offset:48064
    ds_read_b128 v[76:79], v115 offset:48064
    v_exp_f32 v85, v85
    v_exp_f32 v86, v86
    v_exp_f32 v87, v87
    v_exp_f32 v88, v88
    v_exp_f32 v89, v89
    v_smfmac_f32_32x32x32_bf16 v[24:39], v[64:67], v[80:87], v112
    s_add_u32 s42, s30, 13791232
    buffer_load_dword v0, v117, s[4:7], s42 offen
    v_exp_f32 v90, v90
    v_exp_f32 v91, v91
    v_exp_f32 v92, v92
    v_exp_f32 v93, v93
    v_exp_f32 v94, v94
    v_exp_f32 v95, v95
    v_exp_f32 v96, v96
    v_exp_f32 v97, v97
    v_smfmac_f32_32x32x32_bf16 v[24:39], v[68:71], v[88:95], v112
    s_waitcnt lgkmcnt(0)
    s_add_u32 s42, s16, 5402624
    v_exp_f32 v98, v98
    v_exp_f32 v99, v99
    v_exp_f32 v100, v100
    v_mfma_f32_32x32x16_bf16 v[80:95], v[60:63], v[16:19], 0
    v_exp_f32 v101, v101
    v_exp_f32 v102, v102
    v_exp_f32 v103, v103
    v_exp_f32 v104, v104
    v_exp_f32 v105, v105
    v_smfmac_f32_32x32x32_bf16 v[40:55], v[64:67], v[96:103], v112
    buffer_load_dword v0, v3, s[4:7], s42 offen
    v_exp_f32 v106, v106
    v_exp_f32 v107, v107
    v_exp_f32 v108, v108
    v_exp_f32 v109, v109
    v_exp_f32 v110, v110
    v_exp_f32 v111, v111
    v_exp_f32 v80, v80
    v_exp_f32 v81, v81
    v_smfmac_f32_32x32x32_bf16 v[40:55], v[68:71], v[104:111], v112
    s_barrier
    v_exp_f32 v82, v82
    v_exp_f32 v83, v83
    v_exp_f32 v84, v84
    v_mfma_f32_32x32x16_bf16 v[96:111], v[60:63], v[20:23], 0
    ds_read_b128 v[56:59], v113 offset:50144
    ds_read_b128 v[64:67], v114 offset:50144
    ds_read_b128 v[68:71], v115 offset:50144
    v_exp_f32 v85, v85
    v_exp_f32 v86, v86
    v_exp_f32 v87, v87
    v_exp_f32 v88, v88
    v_exp_f32 v89, v89
    v_smfmac_f32_32x32x32_bf16 v[24:39], v[72:75], v[80:87], v112
    global_load_dword v0, v124, s[92:93]
    v_exp_f32 v90, v90
    v_exp_f32 v91, v91
    v_exp_f32 v92, v92
    v_exp_f32 v93, v93
    v_exp_f32 v94, v94
    v_exp_f32 v95, v95
    v_exp_f32 v96, v96
    v_exp_f32 v97, v97
    v_smfmac_f32_32x32x32_bf16 v[24:39], v[76:79], v[88:95], v112
    s_waitcnt lgkmcnt(0)
    s_add_u32 m0, s26, 98304
    v_exp_f32 v98, v98
    v_exp_f32 v99, v99
    v_exp_f32 v100, v100
    v_mfma_f32_32x32x16_bf16 v[80:95], v[56:59], v[16:19], 0
    s_add_u32 s43, s25, 1179648
    v_exp_f32 v101, v101
    v_exp_f32 v102, v102
    v_exp_f32 v103, v103
    v_exp_f32 v104, v104
    v_exp_f32 v105, v105
    v_smfmac_f32_32x32x32_bf16 v[40:55], v[72:75], v[96:103], v112
    buffer_load_dwordx4 v2, s[4:7], s43 offen offset:0  lds
    v_exp_f32 v106, v106
    v_exp_f32 v107, v107
    v_exp_f32 v108, v108
    v_exp_f32 v109, v109
    v_exp_f32 v110, v110
    v_exp_f32 v111, v111
    v_exp_f32 v80, v80
    v_exp_f32 v81, v81
    v_smfmac_f32_32x32x32_bf16 v[40:55], v[76:79], v[104:111], v112
    buffer_load_dwordx4 v2, s[4:7], s43 offen offset:1024  lds
    v_exp_f32 v82, v82
    v_exp_f32 v83, v83
    v_exp_f32 v84, v84
    v_mfma_f32_32x32x16_bf16 v[96:111], v[56:59], v[20:23], 0
    ds_read_b128 v[60:63], v113 offset:52224
    ds_read_b128 v[72:75], v114 offset:52224
    ds_read_b128 v[76:79], v115 offset:52224
    v_exp_f32 v85, v85
    v_exp_f32 v86, v86
    v_exp_f32 v87, v87
    v_exp_f32 v88, v88
    v_exp_f32 v89, v89
    v_smfmac_f32_32x32x32_bf16 v[24:39], v[64:67], v[80:87], v112
    buffer_load_dwordx4 v2, s[4:7], s43 offen offset:2048  lds
    v_exp_f32 v90, v90
    v_exp_f32 v91, v91
    v_exp_f32 v92, v92
    v_exp_f32 v93, v93
    v_exp_f32 v94, v94
    v_exp_f32 v95, v95
    v_exp_f32 v96, v96
    v_exp_f32 v97, v97
    v_smfmac_f32_32x32x32_bf16 v[24:39], v[68:71], v[88:95], v112
    s_waitcnt lgkmcnt(0)
    buffer_load_dwordx4 v2, s[4:7], s43 offen offset:3072  lds
    v_exp_f32 v98, v98
    v_exp_f32 v99, v99
    v_exp_f32 v100, v100
    v_mfma_f32_32x32x16_bf16 v[80:95], v[60:63], v[16:19], 0
    s_add_u32 m0, s26, 102400
    v_exp_f32 v101, v101
    v_exp_f32 v102, v102
    v_exp_f32 v103, v103
    v_exp_f32 v104, v104
    v_exp_f32 v105, v105
    v_smfmac_f32_32x32x32_bf16 v[40:55], v[64:67], v[96:103], v112
    s_add_u32 s43, s25, 1183744
    buffer_load_dwordx4 v2, s[4:7], s43 offen offset:0  lds
    v_exp_f32 v106, v106
    v_exp_f32 v107, v107
    v_exp_f32 v108, v108
    v_exp_f32 v109, v109
    v_exp_f32 v110, v110
    v_exp_f32 v111, v111
    v_exp_f32 v80, v80
    v_exp_f32 v81, v81
    v_smfmac_f32_32x32x32_bf16 v[40:55], v[68:71], v[104:111], v112
    buffer_load_dwordx4 v2, s[4:7], s43 offen offset:1024  lds
    v_exp_f32 v82, v82
    v_exp_f32 v83, v83
    v_exp_f32 v84, v84
    v_mfma_f32_32x32x16_bf16 v[96:111], v[60:63], v[20:23], 0
    ds_read_b128 v[56:59], v113 offset:55072
    ds_read_b128 v[64:67], v114 offset:55072
    ds_read_b128 v[68:71], v115 offset:55072
    v_exp_f32 v85, v85
    v_exp_f32 v86, v86
    v_exp_f32 v87, v87
    v_exp_f32 v88, v88
    v_exp_f32 v89, v89
    v_smfmac_f32_32x32x32_bf16 v[24:39], v[72:75], v[80:87], v112
    buffer_load_dwordx4 v2, s[4:7], s43 offen offset:2048  lds
    v_exp_f32 v90, v90
    v_exp_f32 v91, v91
    v_exp_f32 v92, v92
    v_exp_f32 v93, v93
    v_exp_f32 v94, v94
    v_exp_f32 v95, v95
    v_exp_f32 v96, v96
    v_exp_f32 v97, v97
    v_smfmac_f32_32x32x32_bf16 v[24:39], v[76:79], v[88:95], v112
    s_waitcnt lgkmcnt(0)
    buffer_load_dwordx4 v2, s[4:7], s43 offen offset:3072  lds
    v_exp_f32 v98, v98
    v_exp_f32 v99, v99
    v_exp_f32 v100, v100
    v_mfma_f32_32x32x16_bf16 v[80:95], v[56:59], v[16:19], 0
    v_exp_f32 v101, v101
    v_exp_f32 v102, v102
    v_exp_f32 v103, v103
    v_exp_f32 v104, v104
    v_exp_f32 v105, v105
    v_smfmac_f32_32x32x32_bf16 v[40:55], v[72:75], v[96:103], v112
    v_exp_f32 v106, v106
    v_exp_f32 v107, v107
    v_exp_f32 v108, v108
    v_exp_f32 v109, v109
    v_exp_f32 v110, v110
    v_exp_f32 v111, v111
    v_exp_f32 v80, v80
    v_exp_f32 v81, v81
    v_smfmac_f32_32x32x32_bf16 v[40:55], v[76:79], v[104:111], v112
    s_mul_i32 s39, s36, 11
    s_lshr_b32 s39, s39, 4
    v_exp_f32 v82, v82
    v_exp_f32 v83, v83
    v_exp_f32 v84, v84
    v_mfma_f32_32x32x16_bf16 v[96:111], v[56:59], v[20:23], 0
    ds_read_b128 v[60:63], v113 offset:57152
    ds_read_b128 v[72:75], v114 offset:57152
    ds_read_b128 v[76:79], v115 offset:57152
    v_exp_f32 v85, v85
    v_exp_f32 v86, v86
    v_exp_f32 v87, v87
    v_exp_f32 v88, v88
    v_exp_f32 v89, v89
    v_smfmac_f32_32x32x32_bf16 v[24:39], v[64:67], v[80:87], v112
    s_add_u32 s39, s39, s24
    s_add_u32 s42, s39, 3899392
    v_exp_f32 v90, v90
    v_exp_f32 v91, v91
    v_exp_f32 v92, v92
    v_exp_f32 v93, v93
    v_exp_f32 v94, v94
    v_exp_f32 v95, v95
    v_exp_f32 v96, v96
    v_exp_f32 v97, v97
    v_smfmac_f32_32x32x32_bf16 v[24:39], v[68:71], v[88:95], v112
    s_waitcnt lgkmcnt(0)
    buffer_load_dword v0, v122, s[4:7], s42 offen
    v_exp_f32 v98, v98
    v_exp_f32 v99, v99
    v_exp_f32 v100, v100
    v_mfma_f32_32x32x16_bf16 v[80:95], v[60:63], v[16:19], 0
    s_lshr_b32 s39, s13, 4
    v_exp_f32 v101, v101
    v_exp_f32 v102, v102
    v_exp_f32 v103, v103
    v_exp_f32 v104, v104
    v_exp_f32 v105, v105
    v_smfmac_f32_32x32x32_bf16 v[40:55], v[64:67], v[96:103], v112
    s_lshl_b32 s39, s39, 15
    s_add_u32 s39, s39, s25
    v_exp_f32 v106, v106
    v_exp_f32 v107, v107
    v_exp_f32 v108, v108
    v_exp_f32 v109, v109
    v_exp_f32 v110, v110
    v_exp_f32 v111, v111
    v_exp_f32 v80, v80
    v_exp_f32 v81, v81
    v_smfmac_f32_32x32x32_bf16 v[40:55], v[68:71], v[104:111], v112
    s_add_u32 s42, s39, 1212416
    buffer_load_dword v0, v122, s[4:7], s42 offen
    v_exp_f32 v82, v82
    v_exp_f32 v83, v83
    v_exp_f32 v84, v84
    v_mfma_f32_32x32x16_bf16 v[96:111], v[60:63], v[20:23], 0
    ds_read_b128 v[56:59], v113 offset:59232
    ds_read_b128 v[64:67], v114 offset:59232
    ds_read_b128 v[68:71], v115 offset:59232
    v_exp_f32 v85, v85
    v_exp_f32 v86, v86
    v_exp_f32 v87, v87
    v_exp_f32 v88, v88
    v_exp_f32 v89, v89
    v_smfmac_f32_32x32x32_bf16 v[24:39], v[72:75], v[80:87], v112
    s_add_u32 s42, s39, 1216512
    buffer_load_dword v0, v122, s[4:7], s42 offen
    v_exp_f32 v90, v90
    v_exp_f32 v91, v91
    v_exp_f32 v92, v92
    v_exp_f32 v93, v93
    v_exp_f32 v94, v94
    v_exp_f32 v95, v95
    v_exp_f32 v96, v96
    v_exp_f32 v97, v97
    v_smfmac_f32_32x32x32_bf16 v[24:39], v[76:79], v[88:95], v112
    s_waitcnt lgkmcnt(0)
    s_add_u32 s42, s35, 5312512
    v_exp_f32 v98, v98
    v_exp_f32 v99, v99
    v_exp_f32 v100, v100
    v_mfma_f32_32x32x16_bf16 v[80:95], v[56:59], v[16:19], 0
    v_exp_f32 v101, v101
    v_exp_f32 v102, v102
    v_exp_f32 v103, v103
    v_exp_f32 v104, v104
    v_exp_f32 v105, v105
    v_smfmac_f32_32x32x32_bf16 v[40:55], v[72:75], v[96:103], v112
    buffer_load_dword v0, v4, s[4:7], s42 offen
    v_exp_f32 v106, v106
    v_exp_f32 v107, v107
    v_exp_f32 v108, v108
    v_exp_f32 v109, v109
    v_exp_f32 v110, v110
    v_exp_f32 v111, v111
    v_exp_f32 v80, v80
    v_exp_f32 v81, v81
    v_smfmac_f32_32x32x32_bf16 v[40:55], v[76:79], v[104:111], v112
    v_exp_f32 v82, v82
    v_exp_f32 v83, v83
    v_exp_f32 v84, v84
    v_mfma_f32_32x32x16_bf16 v[96:111], v[56:59], v[20:23], 0
    ds_read_b128 v[60:63], v113 offset:61312
    ds_read_b128 v[72:75], v114 offset:61312
    ds_read_b128 v[76:79], v115 offset:61312
    v_exp_f32 v85, v85
    v_exp_f32 v86, v86
    v_exp_f32 v87, v87
    v_exp_f32 v88, v88
    v_exp_f32 v89, v89
    v_smfmac_f32_32x32x32_bf16 v[24:39], v[64:67], v[80:87], v112
    v_exp_f32 v90, v90
    v_exp_f32 v91, v91
    v_exp_f32 v92, v92
    v_exp_f32 v93, v93
    v_exp_f32 v94, v94
    v_exp_f32 v95, v95
    v_exp_f32 v96, v96
    v_exp_f32 v97, v97
    v_smfmac_f32_32x32x32_bf16 v[24:39], v[68:71], v[88:95], v112
    s_waitcnt lgkmcnt(0)
    v_exp_f32 v98, v98
    v_exp_f32 v99, v99
    v_exp_f32 v100, v100
    v_mfma_f32_32x32x16_bf16 v[80:95], v[60:63], v[16:19], 0
    v_exp_f32 v101, v101
    v_exp_f32 v102, v102
    v_exp_f32 v103, v103
    v_exp_f32 v104, v104
    v_exp_f32 v105, v105
    v_smfmac_f32_32x32x32_bf16 v[40:55], v[64:67], v[96:103], v112
    v_exp_f32 v106, v106
    v_exp_f32 v107, v107
    v_exp_f32 v108, v108
    v_exp_f32 v109, v109
    v_exp_f32 v110, v110
    v_exp_f32 v111, v111
    v_exp_f32 v80, v80
    v_exp_f32 v81, v81
    v_smfmac_f32_32x32x32_bf16 v[40:55], v[68:71], v[104:111], v112
    v_exp_f32 v82, v82
    v_exp_f32 v83, v83
    v_exp_f32 v84, v84
    v_mfma_f32_32x32x16_bf16 v[96:111], v[60:63], v[20:23], 0
    ds_read_b128 v[56:59], v113 offset:63392
    ds_read_b128 v[64:67], v114 offset:63392
    ds_read_b128 v[68:71], v115 offset:63392
    v_exp_f32 v85, v85
    v_exp_f32 v86, v86
    v_exp_f32 v87, v87
    v_exp_f32 v88, v88
    v_exp_f32 v89, v89
    v_smfmac_f32_32x32x32_bf16 v[24:39], v[72:75], v[80:87], v112
    v_exp_f32 v90, v90
    v_exp_f32 v91, v91
    v_exp_f32 v92, v92
    v_exp_f32 v93, v93
    v_exp_f32 v94, v94
    v_exp_f32 v95, v95
    v_exp_f32 v96, v96
    v_exp_f32 v97, v97
    v_smfmac_f32_32x32x32_bf16 v[24:39], v[76:79], v[88:95], v112
    s_waitcnt lgkmcnt(0)
    v_exp_f32 v98, v98
    v_exp_f32 v99, v99
    v_exp_f32 v100, v100
    v_mfma_f32_32x32x16_bf16 v[80:95], v[56:59], v[16:19], 0
    v_exp_f32 v101, v101
    v_exp_f32 v102, v102
    v_exp_f32 v103, v103
    v_exp_f32 v104, v104
    v_exp_f32 v105, v105
    v_smfmac_f32_32x32x32_bf16 v[40:55], v[72:75], v[96:103], v112
    v_exp_f32 v106, v106
    v_exp_f32 v107, v107
    v_exp_f32 v108, v108
    v_exp_f32 v109, v109
    v_exp_f32 v110, v110
    v_exp_f32 v111, v111
    v_exp_f32 v80, v80
    v_exp_f32 v81, v81
    v_smfmac_f32_32x32x32_bf16 v[40:55], v[76:79], v[104:111], v112
    v_exp_f32 v82, v82
    v_exp_f32 v83, v83
    v_exp_f32 v84, v84
    v_mfma_f32_32x32x16_bf16 v[96:111], v[56:59], v[20:23], 0
    ds_read_b128 v[60:63], v113 offset:65472
    ds_read_b128 v[72:75], v114 offset:65472
    ds_read_b128 v[76:79], v115 offset:65472
    v_exp_f32 v85, v85
    v_exp_f32 v86, v86
    v_exp_f32 v87, v87
    v_exp_f32 v88, v88
    v_exp_f32 v89, v89
    v_smfmac_f32_32x32x32_bf16 v[24:39], v[64:67], v[80:87], v112
    v_exp_f32 v90, v90
    v_exp_f32 v91, v91
    v_exp_f32 v92, v92
    v_exp_f32 v93, v93
    v_exp_f32 v94, v94
    v_exp_f32 v95, v95
    v_exp_f32 v96, v96
    v_exp_f32 v97, v97
    v_smfmac_f32_32x32x32_bf16 v[24:39], v[68:71], v[88:95], v112
    s_waitcnt lgkmcnt(0)
    v_exp_f32 v98, v98
    v_exp_f32 v99, v99
    v_exp_f32 v100, v100
    v_mfma_f32_32x32x16_bf16 v[80:95], v[60:63], v[16:19], 0
    v_exp_f32 v101, v101
    v_exp_f32 v102, v102
    v_exp_f32 v103, v103
    v_exp_f32 v104, v104
    v_exp_f32 v105, v105
    v_smfmac_f32_32x32x32_bf16 v[40:55], v[64:67], v[96:103], v112
    v_exp_f32 v106, v106
    v_exp_f32 v107, v107
    v_exp_f32 v108, v108
    v_exp_f32 v109, v109
    v_exp_f32 v110, v110
    v_exp_f32 v111, v111
    v_exp_f32 v80, v80
    v_exp_f32 v81, v81
    v_smfmac_f32_32x32x32_bf16 v[40:55], v[68:71], v[104:111], v112
    v_exp_f32 v82, v82
    v_exp_f32 v83, v83
    v_exp_f32 v84, v84
    v_mfma_f32_32x32x16_bf16 v[96:111], v[60:63], v[20:23], 0
    v_add_u32 v113, 67552, v113
    v_add_u32 v114, 67552, v114
    v_add_u32 v115, 67552, v115
    ds_read_b128 v[56:59], v113 offset:0
    ds_read_b128 v[64:67], v114 offset:0
    ds_read_b128 v[68:71], v115 offset:0
    v_exp_f32 v85, v85
    v_exp_f32 v86, v86
    v_exp_f32 v87, v87
    v_exp_f32 v88, v88
    v_exp_f32 v89, v89
    v_smfmac_f32_32x32x32_bf16 v[24:39], v[72:75], v[80:87], v112
    v_exp_f32 v90, v90
    v_exp_f32 v91, v91
    v_exp_f32 v92, v92
    v_exp_f32 v93, v93
    v_exp_f32 v94, v94
    v_exp_f32 v95, v95
    v_exp_f32 v96, v96
    v_exp_f32 v97, v97
    v_smfmac_f32_32x32x32_bf16 v[24:39], v[76:79], v[88:95], v112
    s_waitcnt lgkmcnt(0)
    v_exp_f32 v98, v98
    v_exp_f32 v99, v99
    v_exp_f32 v100, v100
    v_mfma_f32_32x32x16_bf16 v[80:95], v[56:59], v[16:19], 0
    v_exp_f32 v101, v101
    v_exp_f32 v102, v102
    v_exp_f32 v103, v103
    v_exp_f32 v104, v104
    v_exp_f32 v105, v105
    v_smfmac_f32_32x32x32_bf16 v[40:55], v[72:75], v[96:103], v112
    v_exp_f32 v106, v106
    v_exp_f32 v107, v107
    v_exp_f32 v108, v108
    v_exp_f32 v109, v109
    v_exp_f32 v110, v110
    v_exp_f32 v111, v111
    v_exp_f32 v80, v80
    v_exp_f32 v81, v81
    v_smfmac_f32_32x32x32_bf16 v[40:55], v[76:79], v[104:111], v112
    v_exp_f32 v82, v82
    v_exp_f32 v83, v83
    v_exp_f32 v84, v84
    v_mfma_f32_32x32x16_bf16 v[96:111], v[56:59], v[20:23], 0
    ds_read_b128 v[60:63], v113 offset:2080
    ds_read_b128 v[72:75], v114 offset:2080
    ds_read_b128 v[76:79], v115 offset:2080
    v_exp_f32 v85, v85
    v_exp_f32 v86, v86
    v_exp_f32 v87, v87
    v_exp_f32 v88, v88
    v_exp_f32 v89, v89
    v_smfmac_f32_32x32x32_bf16 v[24:39], v[64:67], v[80:87], v112
    v_exp_f32 v90, v90
    v_exp_f32 v91, v91
    v_exp_f32 v92, v92
    v_exp_f32 v93, v93
    v_exp_f32 v94, v94
    v_exp_f32 v95, v95
    v_exp_f32 v96, v96
    v_exp_f32 v97, v97
    v_smfmac_f32_32x32x32_bf16 v[24:39], v[68:71], v[88:95], v112
    s_waitcnt lgkmcnt(0)
    v_exp_f32 v98, v98
    v_exp_f32 v99, v99
    v_exp_f32 v100, v100
    v_mfma_f32_32x32x16_bf16 v[80:95], v[60:63], v[16:19], 0
    v_exp_f32 v101, v101
    v_exp_f32 v102, v102
    v_exp_f32 v103, v103
    v_exp_f32 v104, v104
    v_exp_f32 v105, v105
    v_smfmac_f32_32x32x32_bf16 v[40:55], v[64:67], v[96:103], v112
    v_exp_f32 v106, v106
    v_exp_f32 v107, v107
    v_exp_f32 v108, v108
    v_exp_f32 v109, v109
    v_exp_f32 v110, v110
    v_exp_f32 v111, v111
    v_exp_f32 v80, v80
    v_exp_f32 v81, v81
    v_smfmac_f32_32x32x32_bf16 v[40:55], v[68:71], v[104:111], v112
    v_exp_f32 v82, v82
    v_exp_f32 v83, v83
    v_exp_f32 v84, v84
    v_mfma_f32_32x32x16_bf16 v[96:111], v[60:63], v[20:23], 0
    v_exp_f32 v85, v85
    v_exp_f32 v86, v86
    v_exp_f32 v87, v87
    v_exp_f32 v88, v88
    v_exp_f32 v89, v89
    v_smfmac_f32_32x32x32_bf16 v[24:39], v[72:75], v[80:87], v112
    v_exp_f32 v90, v90
    v_exp_f32 v91, v91
    v_exp_f32 v92, v92
    v_exp_f32 v93, v93
    v_exp_f32 v94, v94
    v_exp_f32 v95, v95
    v_exp_f32 v96, v96
    v_exp_f32 v97, v97
    v_smfmac_f32_32x32x32_bf16 v[24:39], v[76:79], v[88:95], v112
    s_waitcnt lgkmcnt(0)
    v_exp_f32 v98, v98
    v_exp_f32 v99, v99
    v_exp_f32 v100, v100
    v_exp_f32 v101, v101
    v_exp_f32 v102, v102
    v_exp_f32 v103, v103
    v_exp_f32 v104, v104
    v_exp_f32 v105, v105
    v_smfmac_f32_32x32x32_bf16 v[40:55], v[72:75], v[96:103], v112
    v_exp_f32 v106, v106
    v_exp_f32 v107, v107
    v_exp_f32 v108, v108
    v_exp_f32 v109, v109
    v_exp_f32 v110, v110
    v_exp_f32 v111, v111
    s_nop 1
    v_smfmac_f32_32x32x32_bf16 v[40:55], v[76:79], v[104:111], v112
    v_mul_f32 v12, 0, v24
    v_fmac_f32 v12, 0, v25
    v_fmac_f32 v12, 0, v26
    v_fmac_f32 v12, 0, v27
    v_fmac_f32 v12, 0, v28
    v_fmac_f32 v12, 0, v29
    v_fmac_f32 v12, 0, v30
    v_fmac_f32 v12, 0, v31
    v_fmac_f32 v12, 0, v32
    s_nop 3
    v_fmac_f32 v12, 0, v40
    v_fmac_f32 v12, 0, v41
    v_fmac_f32 v12, 0, v42
    v_fmac_f32 v12, 0, v43
    v_fmac_f32 v12, 0, v44
    v_fmac_f32 v12, 0, v45
    v_fmac_f32 v12, 0, v46
    v_fmac_f32 v12, 0, v47
    v_fmac_f32 v12, 0, v48
    v_min_f32 v13, v32, v48
    v_max_f32 v14, v32, v48
    v_cmp_u_f32 vcc, v12, v12
    s_mov_b64 s[42:43], vcc
    v_cmp_nle_f32 vcc, 0x1f800000, v13
    s_or_b64 s[42:43], s[42:43], vcc
    v_cmp_nge_f32 vcc, 0x71800000, v14
    s_or_b64 s[42:43], s[42:43], vcc
    s_cmp_lg_u64 s[42:43], 0
    s_cbranch_scc1 L_main_kernel_afb_5
L_main_kernel_afin_4:
    v_rcp_f32 v12, v32
    v_rcp_f32 v13, v48
    v_add_u32 v14, 131072, v5
    v_mul_f32 v24, v24, v12
    v_mul_f32 v25, v25, v12
    v_mul_f32 v26, v26, v12
    v_mul_f32 v27, v27, v12
    v_mul_f32 v28, v28, v12
    v_mul_f32 v29, v29, v12
    v_mul_f32 v30, v30, v12
    v_mul_f32 v31, v31, v12
    v_cvt_pk_bf16_f32 v80, v24, v25
    v_cvt_pk_bf16_f32 v81, v26, v27
    v_cvt_pk_bf16_f32 v82, v28, v29
    v_cvt_pk_bf16_f32 v83, v30, v31
    ds_write_b128 v14, v[80:83] offset:0
    v_mul_f32 v40, v40, v13
    v_mul_f32 v41, v41, v13
    v_mul_f32 v42, v42, v13
    v_mul_f32 v43, v43, v13
    v_mul_f32 v44, v44, v13
    v_mul_f32 v45, v45, v13
    v_mul_f32 v46, v46, v13
    v_mul_f32 v47, v47, v13
    v_cvt_pk_bf16_f32 v84, v40, v41
    v_cvt_pk_bf16_f32 v85, v42, v43
    v_cvt_pk_bf16_f32 v86, v44, v45
    v_cvt_pk_bf16_f32 v87, v46, v47
    ds_write_b128 v14, v[84:87] offset:16
    s_add_u32 s42, s101, 131072
    v_add_u32 v14, s42, v2
    s_add_u32 s42, s31, 7499776
    s_add_u32 s43, s31, 7503872
    s_waitcnt lgkmcnt(0)
    s_barrier
    ds_read_b128 v[88:91], v14
    ds_read_b128 v[92:95], v14 offset:1024
    s_waitcnt lgkmcnt(1)
    buffer_store_dwordx4 v[88:91], v121, s[4:7], s42 offen
    s_waitcnt lgkmcnt(0)
    buffer_store_dwordx4 v[92:95], v121, s[4:7], s43 offen
    s_waitcnt vmcnt(0)
    s_add_u32 s41, s18, 35467264
    v_mov_b32 v15, 1
    buffer_store_dword v15, v8, s[4:7], s41 offen
    v_and_b32 v12, 31, v1
    v_lshlrev_b32 v12, 10, v12
    v_lshrrev_b32 v13, 5, v1
    v_lshl_add_u32 v12, v13, 4, v12
    s_lshl_b32 s42, s14, 6
    s_add_u32 s42, s42, s17
    buffer_load_dwordx4 v[64:67], v12, s[44:47], s42 offen
    buffer_load_dwordx4 v[68:71], v12, s[44:47], s42 offen offset:32
    v_add_u32 v14, 131072, v2
    s_lshl_b32 s39, s3, 11
    s_add_u32 s38, s39, s17
    s_add_u32 s41, s19, 35467264
    s_mov_b32 s40, 0
L_main_kernel_poll_6:
    buffer_load_dword v15, v3, s[4:7], s41 offen sc1
    s_add_u32 s40, s40, 1
    s_waitcnt vmcnt(0)
    v_cmp_gt_u32 vcc, 1, v15
    s_cbranch_vccz L_main_kernel_polld_7
    s_cmp_lt_u32 s40, 262144
    s_cbranch_scc1 L_main_kernel_poll_6
L_main_kernel_polld_7:
    s_add_u32 m0, s39, 131072
    s_add_u32 s43, s38, 7499776
    buffer_load_dwordx4 v2, s[4:7], s43 offen offset:0 sc1 lds
    buffer_load_dwordx4 v2, s[4:7], s43 offen offset:1024 sc1 lds
    s_add_u32 m0, s39, 139264
    s_add_u32 s43, s38, 7507968
    buffer_load_dwordx4 v2, s[4:7], s43 offen offset:0 sc1 lds
    buffer_load_dwordx4 v2, s[4:7], s43 offen offset:1024 sc1 lds
    s_add_u32 m0, s39, 147456
    s_add_u32 s43, s38, 7516160
    buffer_load_dwordx4 v2, s[4:7], s43 offen offset:0 sc1 lds
    buffer_load_dwordx4 v2, s[4:7], s43 offen offset:1024 sc1 lds
    s_add_u32 m0, s39, 155648
    s_add_u32 s43, s38, 7524352
    buffer_load_dwordx4 v2, s[4:7], s43 offen offset:0 sc1 lds
    buffer_load_dwordx4 v2, s[4:7], s43 offen offset:1024 sc1 lds
    v_lshlrev_b32 v72, 16, v64
    v_and_b32 v73, 0xffff0000, v64
    v_lshlrev_b32 v74, 16, v65
    v_and_b32 v75, 0xffff0000, v65
    v_lshlrev_b32 v76, 16, v66
    v_and_b32 v77, 0xffff0000, v66
    v_lshlrev_b32 v78, 16, v67
    v_and_b32 v79, 0xffff0000, v67
    v_lshlrev_b32 v80, 16, v68
    v_and_b32 v81, 0xffff0000, v68
    v_lshlrev_b32 v82, 16, v69
    v_and_b32 v83, 0xffff0000, v69
    v_lshlrev_b32 v84, 16, v70
    v_and_b32 v85, 0xffff0000, v70
    v_lshlrev_b32 v86, 16, v71
    v_and_b32 v87, 0xffff0000, v71
    s_waitcnt vmcnt(6)
    s_barrier
    ds_read_b128 v[32:35], v14 offset:0
    ds_read_b128 v[36:39], v14 offset:1024
    ds_read_b128 v[40:43], v14 offset:2048
    ds_read_b128 v[44:47], v14 offset:3072
    ds_read_b128 v[48:51], v14 offset:4096
    ds_read_b128 v[52:55], v14 offset:5120
    ds_read_b128 v[56:59], v14 offset:6144
    s_waitcnt lgkmcnt(5)
    v_mfma_f32_32x32x16_bf16 v[16:31], a[0:3], v[32:35], v[72:87]
    ds_read_b128 v[60:63], v14 offset:7168
    v_mfma_f32_32x32x16_bf16 v[16:31], a[4:7], v[36:39], v[16:31]
    s_waitcnt vmcnt(0)
    s_barrier
    ds_read_b128 v[32:35], v14 offset:8192
    s_waitcnt lgkmcnt(5)
    v_mfma_f32_32x32x16_bf16 v[16:31], a[8:11], v[40:43], v[16:31]
    ds_read_b128 v[36:39], v14 offset:9216
    v_mfma_f32_32x32x16_bf16 v[16:31], a[12:15], v[44:47], v[16:31]
    ds_read_b128 v[40:43], v14 offset:10240
    s_waitcnt lgkmcnt(5)
    v_mfma_f32_32x32x16_bf16 v[16:31], a[16:19], v[48:51], v[16:31]
    ds_read_b128 v[44:47], v14 offset:11264
    v_mfma_f32_32x32x16_bf16 v[16:31], a[20:23], v[52:55], v[16:31]
    ds_read_b128 v[48:51], v14 offset:12288
    s_waitcnt lgkmcnt(5)
    v_mfma_f32_32x32x16_bf16 v[16:31], a[24:27], v[56:59], v[16:31]
    ds_read_b128 v[52:55], v14 offset:13312
    v_mfma_f32_32x32x16_bf16 v[16:31], a[28:31], v[60:63], v[16:31]
    ds_read_b128 v[56:59], v14 offset:14336
    s_waitcnt lgkmcnt(5)
    v_mfma_f32_32x32x16_bf16 v[16:31], a[32:35], v[32:35], v[16:31]
    ds_read_b128 v[60:63], v14 offset:15360
    v_mfma_f32_32x32x16_bf16 v[16:31], a[36:39], v[36:39], v[16:31]
    ds_read_b128 v[32:35], v14 offset:16384
    s_waitcnt lgkmcnt(5)
    v_mfma_f32_32x32x16_bf16 v[16:31], a[40:43], v[40:43], v[16:31]
    ds_read_b128 v[36:39], v14 offset:17408
    v_mfma_f32_32x32x16_bf16 v[16:31], a[44:47], v[44:47], v[16:31]
    ds_read_b128 v[40:43], v14 offset:18432
    s_waitcnt lgkmcnt(5)
    v_mfma_f32_32x32x16_bf16 v[16:31], a[48:51], v[48:51], v[16:31]
    ds_read_b128 v[44:47], v14 offset:19456
    v_mfma_f32_32x32x16_bf16 v[16:31], a[52:55], v[52:55], v[16:31]
    ds_read_b128 v[48:51], v14 offset:20480
    s_waitcnt lgkmcnt(5)
    v_mfma_f32_32x32x16_bf16 v[16:31], a[56:59], v[56:59], v[16:31]
    ds_read_b128 v[52:55], v14 offset:21504
    v_mfma_f32_32x32x16_bf16 v[16:31], a[60:63], v[60:63], v[16:31]
    ds_read_b128 v[56:59], v14 offset:22528
    s_waitcnt lgkmcnt(5)
    v_mfma_f32_32x32x16_bf16 v[16:31], a[64:67], v[32:35], v[16:31]
    ds_read_b128 v[60:63], v14 offset:23552
    v_mfma_f32_32x32x16_bf16 v[16:31], a[68:71], v[36:39], v[16:31]
    ds_read_b128 v[32:35], v14 offset:24576
    s_waitcnt lgkmcnt(5)
    v_mfma_f32_32x32x16_bf16 v[16:31], a[72:75], v[40:43], v[16:31]
    ds_read_b128 v[36:39], v14 offset:25600
    v_mfma_f32_32x32x16_bf16 v[16:31], a[76:79], v[44:47], v[16:31]
    ds_read_b128 v[40:43], v14 offset:26624
    s_waitcnt lgkmcnt(5)
    v_mfma_f32_32x32x16_bf16 v[16:31], a[80:83], v[48:51], v[16:31]
    ds_read_b128 v[44:47], v14 offset:27648
    v_mfma_f32_32x32x16_bf16 v[16:31], a[84:87], v[52:55], v[16:31]
    ds_read_b128 v[48:51], v14 offset:28672
    s_waitcnt lgkmcnt(5)
    v_mfma_f32_32x32x16_bf16 v[16:31], a[88:91], v[56:59], v[16:31]
    ds_read_b128 v[52:55], v14 offset:29696
    v_mfma_f32_32x32x16_bf16 v[16:31], a[92:95], v[60:63], v[16:31]
    ds_read_b128 v[56:59], v14 offset:30720
    s_waitcnt lgkmcnt(5)
    v_mfma_f32_32x32x16_bf16 v[16:31], a[96:99], v[32:35], v[16:31]
    ds_read_b128 v[60:63], v14 offset:31744
    v_mfma_f32_32x32x16_bf16 v[16:31], a[100:103], v[36:39], v[16:31]
    s_waitcnt lgkmcnt(4)
    v_mfma_f32_32x32x16_bf16 v[16:31], a[104:107], v[40:43], v[16:31]
    v_mfma_f32_32x32x16_bf16 v[16:31], a[108:111], v[44:47], v[16:31]
    s_waitcnt lgkmcnt(2)
    v_mfma_f32_32x32x16_bf16 v[16:31], a[112:115], v[48:51], v[16:31]
    v_mfma_f32_32x32x16_bf16 v[16:31], a[116:119], v[52:55], v[16:31]
    s_waitcnt lgkmcnt(0)
    v_mfma_f32_32x32x16_bf16 v[16:31], a[120:123], v[56:59], v[16:31]
    v_mfma_f32_32x32x16_bf16 v[16:31], a[124:127], v[60:63], v[16:31]
    v_and_b32 v12, 0xffff, v6
    s_add_u32 s42, s16, 5402624
    s_nop 9
    v_cvt_pk_bf16_f32 v48, v16, v17
    v_cvt_pk_bf16_f32 v49, v18, v19
    v_cvt_pk_bf16_f32 v50, v20, v21
    v_cvt_pk_bf16_f32 v51, v22, v23
    buffer_store_dwordx4 v[48:51], v2, s[4:7], s42 offen offset:0
    v_cvt_pk_bf16_f32 v52, v24, v25
    v_cvt_pk_bf16_f32 v53, v26, v27
    v_cvt_pk_bf16_f32 v54, v28, v29
    v_cvt_pk_bf16_f32 v55, v30, v31
    buffer_store_dwordx4 v[52:55], v2, s[4:7], s42 offen offset:1024
    v_pk_mul_f32 v[58:59], v[16:17], v[16:17]
    v_pk_add_f32 v[56:57], v[16:17], v[18:19]
    v_pk_fma_f32 v[58:59], v[18:19], v[18:19], v[58:59]
    v_pk_fma_f32 v[58:59], v[20:21], v[20:21], v[58:59]
    v_pk_add_f32 v[56:57], v[56:57], v[20:21]
    v_pk_fma_f32 v[58:59], v[22:23], v[22:23], v[58:59]
    v_pk_add_f32 v[56:57], v[56:57], v[22:23]
    v_pk_fma_f32 v[58:59], v[24:25], v[24:25], v[58:59]
    v_pk_add_f32 v[56:57], v[56:57], v[24:25]
    v_pk_fma_f32 v[58:59], v[26:27], v[26:27], v[58:59]
    v_pk_add_f32 v[56:57], v[56:57], v[26:27]
    v_pk_fma_f32 v[58:59], v[28:29], v[28:29], v[58:59]
    v_pk_add_f32 v[56:57], v[56:57], v[28:29]
    v_pk_fma_f32 v[58:59], v[30:31], v[30:31], v[58:59]
    v_pk_add_f32 v[56:57], v[56:57], v[30:31]
    v_add_f32 v56, v56, v57
    v_add_f32 v57, v58, v59
    v_mov_b32 v58, v56
    v_mov_b32 v59, v57
    s_add_u32 s42, s30, 13791232
    s_nop 0
    v_permlane32_swap_b32 v56, v58
    v_permlane32_swap_b32 v57, v59
    s_nop 0
    v_add_f32 v56, v56, v58
    v_add_f32 v57, v57, v59
    buffer_store_dwordx2 v[56:57], v12, s[4:7], s42 offen
    s_waitcnt vmcnt(0)
    s_add_u32 s41, s18, 35598336
    v_mov_b32 v15, 1
    buffer_store_dword v15, v8, s[4:7], s41 offen
    v_add_u32 v14, 0x10000, v2
    v_add_u32 v13, 0x20000, v2
    s_add_u32 s42, s35, 5312512
    buffer_load_dwordx4 v[108:111], v2, s[4:7], s42 offen
    s_add_u32 s42, s35, 5313536
    buffer_load_dwordx4 v[112:115], v2, s[4:7], s42 offen
    s_add_u32 s41, s20, 35598336
    s_mov_b32 s40, 0
L_main_kernel_poll_8:
    buffer_load_dword v15, v3, s[4:7], s41 offen sc1
    s_add_u32 s40, s40, 1
    s_waitcnt vmcnt(0)
    v_cmp_gt_u32 vcc, 1, v15
    s_cbranch_vccz L_main_kernel_polld_9
    s_cmp_lt_u32 s40, 262144
    s_cbranch_scc1 L_main_kernel_poll_8
L_main_kernel_polld_9:
    s_add_u32 s38, s22, 5402624
    buffer_load_dwordx4 a[0:3], v2, s[4:7], s38 offen offset:0 sc1
    buffer_load_dwordx4 a[4:7], v2, s[4:7], s38 offen offset:1024 sc1
    buffer_load_dwordx4 a[8:11], v2, s[4:7], s38 offen offset:2048 sc1
    buffer_load_dwordx4 a[12:15], v2, s[4:7], s38 offen offset:3072 sc1
    s_add_u32 s38, s22, 5406720
    buffer_load_dwordx4 a[16:19], v2, s[4:7], s38 offen offset:0 sc1
    buffer_load_dwordx4 a[20:23], v2, s[4:7], s38 offen offset:1024 sc1
    buffer_load_dwordx4 a[24:27], v2, s[4:7], s38 offen offset:2048 sc1
    buffer_load_dwordx4 a[28:31], v2, s[4:7], s38 offen offset:3072 sc1
    ds_read_b128 v[64:67], v2 offset:0
    ds_read_b128 v[68:71], v2 offset:32768
    ds_read_b128 v[72:75], v2 offset:1024
    ds_read_b128 v[76:79], v2 offset:33792
    ds_read_b128 v[80:83], v2 offset:2048
    ds_read_b128 v[84:87], v2 offset:34816
    ds_read_b128 v[88:91], v2 offset:3072
    s_waitcnt lgkmcnt(5)
    s_add_u32 s38, s22, 5410816
    buffer_load_dwordx4 a[32:35], v2, s[4:7], s38 offen offset:0 sc1
    s_waitcnt vmcnt(8)
    v_mfma_f32_32x32x16_bf16 v[16:31], v[64:67], a[0:3], 0
    ds_read_b128 v[92:95], v2 offset:35840
    v_mfma_f32_32x32x16_bf16 v[32:47], v[68:71], a[0:3], 0
    ds_read_b128 v[64:67], v2 offset:4096
    s_waitcnt lgkmcnt(5)
    s_add_u32 s42, s34, 13791232
    buffer_load_dwordx2 v[48:49], v6, s[4:7], s42 offen sc1
    buffer_load_dwordx4 a[36:39], v2, s[4:7], s38 offen offset:1024 sc1
    s_waitcnt vmcnt(9)
    v_mfma_f32_32x32x16_bf16 v[16:31], v[72:75], a[4:7], v[16:31]
    ds_read_b128 v[68:71], v2 offset:36864
    v_mfma_f32_32x32x16_bf16 v[32:47], v[76:79], a[4:7], v[32:47]
    ds_read_b128 v[72:75], v2 offset:5120
    s_waitcnt lgkmcnt(5)
    s_add_u32 s42, s34, 13807616
    buffer_load_dwordx2 v[50:51], v6, s[4:7], s42 offen sc1
    buffer_load_dwordx4 a[40:43], v2, s[4:7], s38 offen offset:2048 sc1
    s_waitcnt vmcnt(10)
    v_mfma_f32_32x32x16_bf16 v[16:31], v[80:83], a[8:11], v[16:31]
    ds_read_b128 v[76:79], v2 offset:37888
    v_mfma_f32_32x32x16_bf16 v[32:47], v[84:87], a[8:11], v[32:47]
    ds_read_b128 v[80:83], v2 offset:6144
    s_waitcnt lgkmcnt(5)
    s_add_u32 s42, s34, 13824000
    buffer_load_dwordx2 v[52:53], v6, s[4:7], s42 offen sc1
    buffer_load_dwordx4 a[44:47], v2, s[4:7], s38 offen offset:3072 sc1
    s_waitcnt vmcnt(11)
    v_mfma_f32_32x32x16_bf16 v[16:31], v[88:91], a[12:15], v[16:31]
    ds_read_b128 v[84:87], v2 offset:38912
    v_mfma_f32_32x32x16_bf16 v[32:47], v[92:95], a[12:15], v[32:47]
    ds_read_b128 v[88:91], v2 offset:7168
    s_waitcnt lgkmcnt(5)
    s_add_u32 s42, s34, 13840384
    buffer_load_dwordx2 v[54:55], v6, s[4:7], s42 offen sc1
    s_add_u32 s38, s22, 5414912
    buffer_load_dwordx4 a[48:51], v2, s[4:7], s38 offen offset:0 sc1
    s_waitcnt vmcnt(12)
    v_mfma_f32_32x32x16_bf16 v[16:31], v[64:67], a[16:19], v[16:31]
    ds_read_b128 v[92:95], v2 offset:39936
    v_mfma_f32_32x32x16_bf16 v[32:47], v[68:71], a[16:19], v[32:47]
    ds_read_b128 v[64:67], v2 offset:8192
    s_waitcnt lgkmcnt(5)
    s_add_u32 s42, s34, 13856768
    buffer_load_dwordx2 v[56:57], v6, s[4:7], s42 offen sc1
    buffer_load_dwordx4 a[52:55], v2, s[4:7], s38 offen offset:1024 sc1
    s_waitcnt vmcnt(13)
    v_mfma_f32_32x32x16_bf16 v[16:31], v[72:75], a[20:23], v[16:31]
    ds_read_b128 v[68:71], v2 offset:40960
    v_mfma_f32_32x32x16_bf16 v[32:47], v[76:79], a[20:23], v[32:47]
    ds_read_b128 v[72:75], v2 offset:9216
    s_waitcnt lgkmcnt(5)
    s_add_u32 s42, s34, 13873152
    buffer_load_dwordx2 v[58:59], v6, s[4:7], s42 offen sc1
    buffer_load_dwordx4 a[56:59], v2, s[4:7], s38 offen offset:2048 sc1
    s_waitcnt vmcnt(14)
    v_mfma_f32_32x32x16_bf16 v[16:31], v[80:83], a[24:27], v[16:31]
    ds_read_b128 v[76:79], v2 offset:41984
    v_mfma_f32_32x32x16_bf16 v[32:47], v[84:87], a[24:27], v[32:47]
    ds_read_b128 v[80:83], v2 offset:10240
    s_waitcnt lgkmcnt(5)
    s_add_u32 s42, s34, 13889536
    buffer_load_dwordx2 v[60:61], v6, s[4:7], s42 offen sc1
    buffer_load_dwordx4 a[60:63], v2, s[4:7], s38 offen offset:3072 sc1
    s_waitcnt vmcnt(15)
    v_mfma_f32_32x32x16_bf16 v[16:31], v[88:91], a[28:31], v[16:31]
    ds_read_b128 v[84:87], v2 offset:43008
    v_mfma_f32_32x32x16_bf16 v[32:47], v[92:95], a[28:31], v[32:47]
    ds_read_b128 v[88:91], v2 offset:11264
    s_waitcnt lgkmcnt(5)
    s_add_u32 s42, s34, 13905920
    buffer_load_dwordx2 v[62:63], v6, s[4:7], s42 offen sc1
    s_add_u32 s38, s22, 5419008
    buffer_load_dwordx4 a[64:67], v2, s[4:7], s38 offen offset:0 sc1
    s_waitcnt vmcnt(16)
    v_mfma_f32_32x32x16_bf16 v[16:31], v[64:67], a[32:35], v[16:31]
    ds_read_b128 v[92:95], v2 offset:44032
    v_mfma_f32_32x32x16_bf16 v[32:47], v[68:71], a[32:35], v[32:47]
    ds_read_b128 v[64:67], v2 offset:12288
    s_waitcnt lgkmcnt(5)
    buffer_load_dwordx4 a[68:71], v2, s[4:7], s38 offen offset:1024 sc1
    s_waitcnt vmcnt(15)
    v_mfma_f32_32x32x16_bf16 v[16:31], v[72:75], a[36:39], v[16:31]
    ds_read_b128 v[68:71], v2 offset:45056
    v_mfma_f32_32x32x16_bf16 v[32:47], v[76:79], a[36:39], v[32:47]
    ds_read_b128 v[72:75], v2 offset:13312
    s_waitcnt lgkmcnt(5)
    buffer_load_dwordx4 a[72:75], v2, s[4:7], s38 offen offset:2048 sc1
    s_waitcnt vmcnt(14)
    v_mfma_f32_32x32x16_bf16 v[16:31], v[80:83], a[40:43], v[16:31]
    ds_read_b128 v[76:79], v2 offset:46080
    v_mfma_f32_32x32x16_bf16 v[32:47], v[84:87], a[40:43], v[32:47]
    ds_read_b128 v[80:83], v2 offset:14336
    s_waitcnt lgkmcnt(5)
    buffer_load_dwordx4 a[76:79], v2, s[4:7], s38 offen offset:3072 sc1
    s_waitcnt vmcnt(13)
    v_mfma_f32_32x32x16_bf16 v[16:31], v[88:91], a[44:47], v[16:31]
    ds_read_b128 v[84:87], v2 offset:47104
    v_mfma_f32_32x32x16_bf16 v[32:47], v[92:95], a[44:47], v[32:47]
    ds_read_b128 v[88:91], v2 offset:15360
    s_waitcnt lgkmcnt(5)
    s_add_u32 s38, s22, 5423104
    buffer_load_dwordx4 a[80:83], v2, s[4:7], s38 offen offset:0 sc1
    s_waitcnt vmcnt(12)
    v_mfma_f32_32x32x16_bf16 v[16:31], v[64:67], a[48:51], v[16:31]
    ds_read_b128 v[92:95], v2 offset:48128
    v_mfma_f32_32x32x16_bf16 v[32:47], v[68:71], a[48:51], v[32:47]
    ds_read_b128 v[64:67], v2 offset:16384
    s_waitcnt lgkmcnt(5)
    buffer_load_dwordx4 a[84:87], v2, s[4:7], s38 offen offset:1024 sc1
    s_waitcnt vmcnt(11)
    v_mfma_f32_32x32x16_bf16 v[16:31], v[72:75], a[52:55], v[16:31]
    ds_read_b128 v[68:71], v2 offset:49152
    v_mfma_f32_32x32x16_bf16 v[32:47], v[76:79], a[52:55], v[32:47]
    ds_read_b128 v[72:75], v2 offset:17408
    s_waitcnt lgkmcnt(5)
    buffer_load_dwordx4 a[88:91], v2, s[4:7], s38 offen offset:2048 sc1
    s_waitcnt vmcnt(10)
    v_mfma_f32_32x32x16_bf16 v[16:31], v[80:83], a[56:59], v[16:31]
    ds_read_b128 v[76:79], v2 offset:50176
    v_mfma_f32_32x32x16_bf16 v[32:47], v[84:87], a[56:59], v[32:47]
    ds_read_b128 v[80:83], v2 offset:18432
    s_waitcnt lgkmcnt(5)
    buffer_load_dwordx4 a[92:95], v2, s[4:7], s38 offen offset:3072 sc1
    s_waitcnt vmcnt(9)
    v_mfma_f32_32x32x16_bf16 v[16:31], v[88:91], a[60:63], v[16:31]
    ds_read_b128 v[84:87], v2 offset:51200
    v_mfma_f32_32x32x16_bf16 v[32:47], v[92:95], a[60:63], v[32:47]
    ds_read_b128 v[88:91], v2 offset:19456
    s_waitcnt lgkmcnt(5)
    s_add_u32 s38, s22, 5427200
    buffer_load_dwordx4 a[96:99], v2, s[4:7], s38 offen offset:0 sc1
    s_waitcnt vmcnt(8)
    v_mfma_f32_32x32x16_bf16 v[16:31], v[64:67], a[64:67], v[16:31]
    ds_read_b128 v[92:95], v2 offset:52224
    v_mfma_f32_32x32x16_bf16 v[32:47], v[68:71], a[64:67], v[32:47]
    ds_read_b128 v[64:67], v2 offset:20480
    s_waitcnt lgkmcnt(5)
    buffer_load_dwordx4 a[100:103], v2, s[4:7], s38 offen offset:1024 sc1
    s_waitcnt vmcnt(8)
    v_mfma_f32_32x32x16_bf16 v[16:31], v[72:75], a[68:71], v[16:31]
    ds_read_b128 v[68:71], v2 offset:53248
    v_mfma_f32_32x32x16_bf16 v[32:47], v[76:79], a[68:71], v[32:47]
    ds_read_b128 v[72:75], v2 offset:21504
    s_waitcnt lgkmcnt(5)
    buffer_load_dwordx4 a[104:107], v2, s[4:7], s38 offen offset:2048 sc1
    s_waitcnt vmcnt(8)
    v_mfma_f32_32x32x16_bf16 v[16:31], v[80:83], a[72:75], v[16:31]
    ds_read_b128 v[76:79], v2 offset:54272
    v_mfma_f32_32x32x16_bf16 v[32:47], v[84:87], a[72:75], v[32:47]
    ds_read_b128 v[80:83], v2 offset:22528
    s_waitcnt lgkmcnt(5)
    buffer_load_dwordx4 a[108:111], v2, s[4:7], s38 offen offset:3072 sc1
    s_waitcnt vmcnt(8)
    v_mfma_f32_32x32x16_bf16 v[16:31], v[88:91], a[76:79], v[16:31]
    ds_read_b128 v[84:87], v2 offset:55296
    v_mfma_f32_32x32x16_bf16 v[32:47], v[92:95], a[76:79], v[32:47]
    ds_read_b128 v[88:91], v2 offset:23552
    s_waitcnt lgkmcnt(5)
    s_add_u32 s38, s22, 5431296
    buffer_load_dwordx4 a[112:115], v2, s[4:7], s38 offen offset:0 sc1
    s_waitcnt vmcnt(8)
    v_mfma_f32_32x32x16_bf16 v[16:31], v[64:67], a[80:83], v[16:31]
    ds_read_b128 v[92:95], v2 offset:56320
    v_mfma_f32_32x32x16_bf16 v[32:47], v[68:71], a[80:83], v[32:47]
    ds_read_b128 v[64:67], v2 offset:24576
    s_waitcnt lgkmcnt(5)
    v_add_f32 v48, v48, v50
    buffer_load_dwordx4 a[116:119], v2, s[4:7], s38 offen offset:1024 sc1
    s_waitcnt vmcnt(8)
    v_mfma_f32_32x32x16_bf16 v[16:31], v[72:75], a[84:87], v[16:31]
    ds_read_b128 v[68:71], v2 offset:57344
    v_add_f32 v49, v49, v51
    v_mfma_f32_32x32x16_bf16 v[32:47], v[76:79], a[84:87], v[32:47]
    ds_read_b128 v[72:75], v2 offset:25600
    s_waitcnt lgkmcnt(5)
    v_add_f32 v48, v48, v52
    buffer_load_dwordx4 a[120:123], v2, s[4:7], s38 offen offset:2048 sc1
    s_waitcnt vmcnt(8)
    v_mfma_f32_32x32x16_bf16 v[16:31], v[80:83], a[88:91], v[16:31]
    ds_read_b128 v[76:79], v2 offset:58368
    v_add_f32 v49, v49, v53
    v_mfma_f32_32x32x16_bf16 v[32:47], v[84:87], a[88:91], v[32:47]
    ds_read_b128 v[80:83], v2 offset:26624
    s_waitcnt lgkmcnt(5)
    v_add_f32 v48, v48, v54
    buffer_load_dwordx4 a[124:127], v2, s[4:7], s38 offen offset:3072 sc1
    s_waitcnt vmcnt(8)
    v_mfma_f32_32x32x16_bf16 v[16:31], v[88:91], a[92:95], v[16:31]
    ds_read_b128 v[84:87], v2 offset:59392
    v_add_f32 v49, v49, v55
    v_mfma_f32_32x32x16_bf16 v[32:47], v[92:95], a[92:95], v[32:47]
    ds_read_b128 v[88:91], v2 offset:27648
    s_waitcnt lgkmcnt(5)
    v_add_f32 v48, v48, v56
    s_waitcnt vmcnt(7)
    v_mfma_f32_32x32x16_bf16 v[16:31], v[64:67], a[96:99], v[16:31]
    ds_read_b128 v[92:95], v2 offset:60416
    v_add_f32 v49, v49, v57
    v_mfma_f32_32x32x16_bf16 v[32:47], v[68:71], a[96:99], v[32:47]
    ds_read_b128 v[64:67], v2 offset:28672
    s_waitcnt lgkmcnt(5)
    v_add_f32 v48, v48, v58
    s_waitcnt vmcnt(6)
    v_mfma_f32_32x32x16_bf16 v[16:31], v[72:75], a[100:103], v[16:31]
    ds_read_b128 v[68:71], v2 offset:61440
    v_add_f32 v49, v49, v59
    v_mfma_f32_32x32x16_bf16 v[32:47], v[76:79], a[100:103], v[32:47]
    ds_read_b128 v[72:75], v2 offset:29696
    s_waitcnt lgkmcnt(5)
    v_add_f32 v48, v48, v60
    s_waitcnt vmcnt(5)
    v_mfma_f32_32x32x16_bf16 v[16:31], v[80:83], a[104:107], v[16:31]
    ds_read_b128 v[76:79], v2 offset:62464
    v_add_f32 v49, v49, v61
    v_mfma_f32_32x32x16_bf16 v[32:47], v[84:87], a[104:107], v[32:47]
    ds_read_b128 v[80:83], v2 offset:30720
    s_waitcnt lgkmcnt(5)
    v_add_f32 v48, v48, v62
    s_waitcnt vmcnt(4)
    v_mfma_f32_32x32x16_bf16 v[16:31], v[88:91], a[108:111], v[16:31]
    ds_read_b128 v[84:87], v2 offset:63488
    v_add_f32 v49, v49, v63
    v_mfma_f32_32x32x16_bf16 v[32:47], v[92:95], a[108:111], v[32:47]
    ds_read_b128 v[88:91], v2 offset:31744
    s_waitcnt lgkmcnt(5)
    v_mov_b32 v50, v48
    v_mov_b32 v51, v49
    s_nop 1
    v_permlane32_swap_b32 v48, v50
    v_permlane32_swap_b32 v49, v51
    s_nop 1
    v_add_f32 v48, v48, v50
    v_add_f32 v49, v49, v51
    s_waitcnt vmcnt(3)
    v_mfma_f32_32x32x16_bf16 v[16:31], v[64:67], a[112:115], v[16:31]
    ds_read_b128 v[92:95], v2 offset:64512
    v_mul_f32 v10, 0x3b000000, v48
    v_mul_f32 v12, 0x3b000000, v49
    v_fma_f32 v12, -v10, v10, v12
    v_max_f32 v12, 0, v12
    v_mfma_f32_32x32x16_bf16 v[32:47], v[68:71], a[112:115], v[32:47]
    ds_read_b128 v[64:67], v14 offset:0
    s_waitcnt lgkmcnt(5)
    v_add_f32 v12, 0x3727c5ac, v12
    v_rsq_f32 v11, v12
    s_nop 0
    s_waitcnt vmcnt(2)
    v_mfma_f32_32x32x16_bf16 v[16:31], v[72:75], a[116:119], v[16:31]
    ds_read_b128 v[68:71], v14 offset:1024
    v_mov_b32 v122, v12
    v_mul_f32 v120, 0xc0135761, v11
    v_mul_f32 v15, v11, v11
    v_mul_f32 v15, v15, v11
    v_mfma_f32_32x32x16_bf16 v[32:47], v[76:79], a[116:119], v[32:47]
    ds_read_b128 v[72:75], v14 offset:2048
    s_waitcnt lgkmcnt(5)
    v_mul_f32 v121, 0xbdd2d3e8, v15
    v_sub_f32 v12, 0, v10
    v_cvt_pk_bf16_f32 v116, v12, v12
    v_and_b32 v15, 0xffff0000, v116
    s_waitcnt vmcnt(1)
    v_mfma_f32_32x32x16_bf16 v[16:31], v[80:83], a[120:123], v[16:31]
    ds_read_b128 v[76:79], v14 offset:3072
    v_sub_f32 v15, v12, v15
    v_cvt_pk_bf16_f32 v117, v15, v8
    v_mov_b32 v118, v116
    v_mov_b32 v119, v117
    v_mfma_f32_32x32x16_bf16 v[32:47], v[84:87], a[120:123], v[32:47]
    ds_read_b128 v[80:83], v14 offset:4096
    s_waitcnt lgkmcnt(5)
    s_waitcnt vmcnt(0)
    v_mfma_f32_32x32x16_bf16 v[16:31], v[88:91], a[124:127], v[16:31]
    ds_read_b128 v[84:87], v14 offset:5120
    v_mfma_f32_32x32x16_bf16 v[32:47], v[92:95], a[124:127], v[32:47]
    s_barrier
    ds_read_b128 v[88:91], v14 offset:6144
    s_waitcnt lgkmcnt(5)
    v_mfma_f32_32x32x16_bf16 v[16:31], v[108:111], v[116:119], v[16:31]
    s_add_u32 s42, s35, 5314560
    buffer_load_dwordx4 v[108:111], v2, s[4:7], s42 offen
    v_mfma_f32_32x32x16_bf16 v[32:47], v[112:115], v[116:119], v[32:47]
    s_add_u32 s42, s35, 5315584
    buffer_load_dwordx4 v[112:115], v2, s[4:7], s42 offen
    v_mfma_f32_32x32x16_bf16 v[48:63], v[64:67], a[0:3], 0
    ds_read_b128 v[92:95], v14 offset:7168
    v_mfma_f32_32x32x16_bf16 v[48:63], v[68:71], a[4:7], v[48:63]
    ds_read_b128 v[64:67], v14 offset:8192
    s_waitcnt lgkmcnt(5)
    v_mfma_f32_32x32x16_bf16 v[48:63], v[72:75], a[8:11], v[48:63]
    ds_read_b128 v[68:71], v14 offset:9216
    v_mfma_f32_32x32x16_bf16 v[48:63], v[76:79], a[12:15], v[48:63]
    ds_read_b128 v[72:75], v14 offset:10240
    s_waitcnt lgkmcnt(5)
    v_mfma_f32_32x32x16_bf16 v[48:63], v[80:83], a[16:19], v[48:63]
    ds_read_b128 v[76:79], v14 offset:11264
    v_mfma_f32_32x32x16_bf16 v[48:63], v[84:87], a[20:23], v[48:63]
    ds_read_b128 v[80:83], v14 offset:12288
    s_waitcnt lgkmcnt(5)
    v_mul_f32 v96, v16, v16
    v_mul_f32 v97, v17, v17
    v_mul_f32 v98, v18, v18
    v_mul_f32 v99, v19, v19
    v_mfma_f32_32x32x16_bf16 v[48:63], v[88:91], a[24:27], v[48:63]
    ds_read_b128 v[84:87], v14 offset:13312
    v_mul_f32 v100, v20, v20
    v_mul_f32 v101, v21, v21
    v_mul_f32 v102, v22, v22
    v_mfma_f32_32x32x16_bf16 v[48:63], v[92:95], a[28:31], v[48:63]
    ds_read_b128 v[88:91], v14 offset:14336
    s_waitcnt lgkmcnt(5)
    v_mul_f32 v103, v23, v23
    v_fma_f32 v96, v96, v121, v120
    v_fma_f32 v97, v97, v121, v120
    v_fma_f32 v98, v98, v121, v120
    v_mfma_f32_32x32x16_bf16 v[48:63], v[64:67], a[32:35], v[48:63]
    ds_read_b128 v[92:95], v14 offset:15360
    s_add_u32 m0, s26, 131072
    s_add_u32 s43, s25, 1212416
    buffer_load_dwordx4 v2, s[4:7], s43 offen offset:0  lds
    v_fma_f32 v99, v99, v121, v120
    v_fma_f32 v100, v100, v121, v120
    v_mfma_f32_32x32x16_bf16 v[48:63], v[68:71], a[36:39], v[48:63]
    ds_read_b128 v[64:67], v14 offset:16384
    s_waitcnt lgkmcnt(5)
    v_fma_f32 v101, v101, v121, v120
    v_fma_f32 v102, v102, v121, v120
    v_fma_f32 v103, v103, v121, v120
    v_mul_f32 v96, v96, v16
    v_mfma_f32_32x32x16_bf16 v[48:63], v[72:75], a[40:43], v[48:63]
    ds_read_b128 v[68:71], v14 offset:17408
    v_mul_f32 v97, v97, v17
    v_mul_f32 v98, v98, v18
    v_mul_f32 v99, v99, v19
    v_mfma_f32_32x32x16_bf16 v[48:63], v[76:79], a[44:47], v[48:63]
    ds_read_b128 v[72:75], v14 offset:18432
    s_waitcnt lgkmcnt(5)
    v_mul_f32 v100, v100, v20
    v_mul_f32 v101, v101, v21
    buffer_load_dwordx4 v2, s[4:7], s43 offen offset:1024  lds
    v_mul_f32 v102, v102, v22
    v_mfma_f32_32x32x16_bf16 v[48:63], v[80:83], a[48:51], v[48:63]
    ds_read_b128 v[76:79], v14 offset:19456
    v_mul_f32 v103, v103, v23
    v_exp_f32 v96, v96
    v_mul_f32 v16, v16, v24
    v_mfma_f32_32x32x16_bf16 v[48:63], v[84:87], a[52:55], v[48:63]
    ds_read_b128 v[80:83], v14 offset:20480
    s_waitcnt lgkmcnt(5)
    v_exp_f32 v97, v97
    v_mul_f32 v17, v17, v25
    v_exp_f32 v98, v98
    v_mul_f32 v18, v18, v26
    v_mfma_f32_32x32x16_bf16 v[48:63], v[88:91], a[56:59], v[48:63]
    ds_read_b128 v[84:87], v14 offset:21504
    v_exp_f32 v99, v99
    v_mul_f32 v19, v19, v27
    v_exp_f32 v100, v100
    v_mfma_f32_32x32x16_bf16 v[48:63], v[92:95], a[60:63], v[48:63]
    ds_read_b128 v[88:91], v14 offset:22528
    s_waitcnt lgkmcnt(5)
    buffer_load_dwordx4 v2, s[4:7], s43 offen offset:2048  lds
    v_mul_f32 v20, v20, v28
    v_exp_f32 v101, v101
    v_mul_f32 v21, v21, v29
    v_mfma_f32_32x32x16_bf16 v[48:63], v[64:67], a[64:67], v[48:63]
    ds_read_b128 v[92:95], v14 offset:23552
    v_exp_f32 v102, v102
    v_mul_f32 v22, v22, v30
    v_exp_f32 v103, v103
    v_mfma_f32_32x32x16_bf16 v[48:63], v[68:71], a[68:71], v[48:63]
    ds_read_b128 v[64:67], v14 offset:24576
    s_waitcnt lgkmcnt(5)
    v_mul_f32 v23, v23, v31
    v_fma_f32 v96, v96, v122, v122
    v_fma_f32 v97, v97, v122, v122
    v_fma_f32 v98, v98, v122, v122
    v_mfma_f32_32x32x16_bf16 v[48:63], v[72:75], a[72:75], v[48:63]
    ds_read_b128 v[68:71], v14 offset:25600
    buffer_load_dwordx4 v2, s[4:7], s43 offen offset:3072  lds
    v_fma_f32 v99, v99, v122, v122
    v_fma_f32 v100, v100, v122, v122
    v_mfma_f32_32x32x16_bf16 v[48:63], v[76:79], a[76:79], v[48:63]
    ds_read_b128 v[72:75], v14 offset:26624
    s_waitcnt lgkmcnt(5)
    v_fma_f32 v101, v101, v122, v122
    v_fma_f32 v102, v102, v122, v122
    v_fma_f32 v103, v103, v122, v122
    v_rcp_f32 v96, v96
    v_mfma_f32_32x32x16_bf16 v[48:63], v[80:83], a[80:83], v[48:63]
    ds_read_b128 v[76:79], v14 offset:27648
    v_rcp_f32 v97, v97
    v_mul_f32 v16, v16, v96
    v_rcp_f32 v98, v98
    v_mfma_f32_32x32x16_bf16 v[48:63], v[84:87], a[84:87], v[48:63]
    ds_read_b128 v[80:83], v14 offset:28672
    s_waitcnt lgkmcnt(5)
    v_mul_f32 v17, v17, v97
    v_rcp_f32 v99, v99
    s_add_u32 m0, s26, 135168
    s_add_u32 s43, s25, 1216512
    buffer_load_dwordx4 v2, s[4:7], s43 offen offset:0  lds
    v_mul_f32 v18, v18, v98
    v_mfma_f32_32x32x16_bf16 v[48:63], v[88:91], a[88:91], v[48:63]
    ds_read_b128 v[84:87], v14 offset:29696
    v_rcp_f32 v100, v100
    v_mul_f32 v19, v19, v99
    v_rcp_f32 v101, v101
    v_mfma_f32_32x32x16_bf16 v[48:63], v[92:95], a[92:95], v[48:63]
    ds_read_b128 v[88:91], v14 offset:30720
    s_waitcnt lgkmcnt(5)
    v_mul_f32 v20, v20, v100
    v_rcp_f32 v102, v102
    v_mul_f32 v21, v21, v101
    v_rcp_f32 v103, v103
    v_mfma_f32_32x32x16_bf16 v[48:63], v[64:67], a[96:99], v[48:63]
    ds_read_b128 v[92:95], v14 offset:31744
    v_mul_f32 v22, v22, v102
    v_cvt_pk_bf16_f32 v104, v16, v17
    v_mul_f32 v23, v23, v103
    v_mfma_f32_32x32x16_bf16 v[48:63], v[68:71], a[100:103], v[48:63]
    ds_read_b128 v[64:67], v14 offset:32768
    s_waitcnt lgkmcnt(5)
    buffer_load_dwordx4 v2, s[4:7], s43 offen offset:1024  lds
    v_cvt_pk_bf16_f32 v105, v18, v19
    v_cvt_pk_bf16_f32 v106, v20, v21
    v_cvt_pk_bf16_f32 v107, v22, v23
    v_mfma_f32_32x32x16_bf16 v[48:63], v[72:75], a[104:107], v[48:63]
    ds_read_b128 v[68:71], v14 offset:33792
    s_add_u32 s42, s28, 14602240
    buffer_store_dwordx4 v[104:107], v2, s[4:7], s42 offen
    v_mul_f32 v96, v32, v32
    v_mul_f32 v97, v33, v33
    v_mfma_f32_32x32x16_bf16 v[48:63], v[76:79], a[108:111], v[48:63]
    ds_read_b128 v[72:75], v14 offset:34816
    s_waitcnt lgkmcnt(5)
    v_mul_f32 v98, v34, v34
    v_mul_f32 v99, v35, v35
    v_mul_f32 v100, v36, v36
    v_mul_f32 v101, v37, v37
    v_mfma_f32_32x32x16_bf16 v[48:63], v[80:83], a[112:115], v[48:63]
    ds_read_b128 v[76:79], v14 offset:35840
    v_mul_f32 v102, v38, v38
    buffer_load_dwordx4 v2, s[4:7], s43 offen offset:2048  lds
    v_mul_f32 v103, v39, v39
    v_mfma_f32_32x32x16_bf16 v[48:63], v[84:87], a[116:119], v[48:63]
    ds_read_b128 v[80:83], v14 offset:36864
    s_waitcnt lgkmcnt(5)
    v_fma_f32 v96, v96, v121, v120
    v_fma_f32 v97, v97, v121, v120
    v_fma_f32 v98, v98, v121, v120
    v_fma_f32 v99, v99, v121, v120
    v_mfma_f32_32x32x16_bf16 v[48:63], v[88:91], a[120:123], v[48:63]
    ds_read_b128 v[84:87], v14 offset:37888
    v_fma_f32 v100, v100, v121, v120
    v_fma_f32 v101, v101, v121, v120
    v_fma_f32 v102, v102, v121, v120
    v_mfma_f32_32x32x16_bf16 v[48:63], v[92:95], a[124:127], v[48:63]
    ds_read_b128 v[88:91], v14 offset:38912
    s_waitcnt lgkmcnt(5)
    v_fma_f32 v103, v103, v121, v120
    v_mul_f32 v96, v96, v32
    buffer_load_dwordx4 v2, s[4:7], s43 offen offset:3072  lds
    s_waitcnt vmcnt(10)
    v_mfma_f32_32x32x16_bf16 v[48:63], v[108:111], v[116:119], v[48:63]
    s_add_u32 s42, s35, 5316608
    buffer_load_dwordx4 v[108:111], v2, s[4:7], s42 offen
    v_mfma_f32_32x32x16_bf16 v[16:31], v[64:67], a[0:3], 0
    ds_read_b128 v[92:95], v14 offset:39936
    v_mul_f32 v97, v97, v33
    v_mul_f32 v98, v98, v34
    v_mul_f32 v99, v99, v35
    v_mfma_f32_32x32x16_bf16 v[16:31], v[68:71], a[4:7], v[16:31]
    ds_read_b128 v[64:67], v14 offset:40960
    s_waitcnt lgkmcnt(5)
    v_mul_f32 v100, v100, v36
    v_mul_f32 v101, v101, v37
    v_mul_f32 v102, v102, v38
    v_mfma_f32_32x32x16_bf16 v[16:31], v[72:75], a[8:11], v[16:31]
    ds_read_b128 v[68:71], v14 offset:41984
    v_mul_f32 v103, v103, v39
    v_exp_f32 v96, v96
    v_mul_f32 v32, v32, v40
    v_mfma_f32_32x32x16_bf16 v[16:31], v[76:79], a[12:15], v[16:31]
    ds_read_b128 v[72:75], v14 offset:43008
    s_waitcnt lgkmcnt(5)
    v_exp_f32 v97, v97
    v_mul_f32 v33, v33, v41
    s_add_u32 m0, s26, 0
    s_add_u32 s43, s25, 1245184
    s_cmp_ge_u32 s15, 6
    s_cselect_b32 s43, 2147418112, s43
    buffer_load_dwordx4 v2, s[4:7], s43 offen offset:0  lds
    v_mfma_f32_32x32x16_bf16 v[16:31], v[80:83], a[16:19], v[16:31]
    ds_read_b128 v[76:79], v14 offset:44032
    v_exp_f32 v98, v98
    v_mul_f32 v34, v34, v42
    v_exp_f32 v99, v99
    v_mfma_f32_32x32x16_bf16 v[16:31], v[84:87], a[20:23], v[16:31]
    ds_read_b128 v[80:83], v14 offset:45056
    s_waitcnt lgkmcnt(5)
    v_mul_f32 v35, v35, v43
    v_exp_f32 v100, v100
    v_mul_f32 v36, v36, v44
    v_mfma_f32_32x32x16_bf16 v[16:31], v[88:91], a[24:27], v[16:31]
    ds_read_b128 v[84:87], v14 offset:46080
    v_exp_f32 v101, v101
    v_mul_f32 v37, v37, v45
    v_exp_f32 v102, v102
    v_mfma_f32_32x32x16_bf16 v[16:31], v[92:95], a[28:31], v[16:31]
    ds_read_b128 v[88:91], v14 offset:47104
    s_waitcnt lgkmcnt(5)
    v_mul_f32 v38, v38, v46
    v_exp_f32 v103, v103
    buffer_load_dwordx4 v2, s[4:7], s43 offen offset:1024  lds
    v_mfma_f32_32x32x16_bf16 v[16:31], v[64:67], a[32:35], v[16:31]
    ds_read_b128 v[92:95], v14 offset:48128
    v_mul_f32 v39, v39, v47
    v_fma_f32 v96, v96, v122, v122
    v_fma_f32 v97, v97, v122, v122
    v_mfma_f32_32x32x16_bf16 v[16:31], v[68:71], a[36:39], v[16:31]
    ds_read_b128 v[64:67], v14 offset:49152
    s_waitcnt lgkmcnt(5)
    v_fma_f32 v98, v98, v122, v122
    v_fma_f32 v99, v99, v122, v122
    v_fma_f32 v100, v100, v122, v122
    v_mfma_f32_32x32x16_bf16 v[16:31], v[72:75], a[40:43], v[16:31]
    ds_read_b128 v[68:71], v14 offset:50176
    v_fma_f32 v101, v101, v122, v122
    v_fma_f32 v102, v102, v122, v122
    v_fma_f32 v103, v103, v122, v122
    v_mfma_f32_32x32x16_bf16 v[16:31], v[76:79], a[44:47], v[16:31]
    ds_read_b128 v[72:75], v14 offset:51200
    s_waitcnt lgkmcnt(5)
    v_rcp_f32 v96, v96
    v_rcp_f32 v97, v97
    buffer_load_dwordx4 v2, s[4:7], s43 offen offset:2048  lds
    v_mfma_f32_32x32x16_bf16 v[16:31], v[80:83], a[48:51], v[16:31]
    ds_read_b128 v[76:79], v14 offset:52224
    v_mul_f32 v32, v32, v96
    v_rcp_f32 v98, v98
    v_mul_f32 v33, v33, v97
    v_mfma_f32_32x32x16_bf16 v[16:31], v[84:87], a[52:55], v[16:31]
    ds_read_b128 v[80:83], v14 offset:53248
    s_waitcnt lgkmcnt(5)
    v_rcp_f32 v99, v99
    v_mul_f32 v34, v34, v98
    v_rcp_f32 v100, v100
    v_mfma_f32_32x32x16_bf16 v[16:31], v[88:91], a[56:59], v[16:31]
    ds_read_b128 v[84:87], v14 offset:54272
    v_mul_f32 v35, v35, v99
    v_rcp_f32 v101, v101
    v_mul_f32 v36, v36, v100
    v_mfma_f32_32x32x16_bf16 v[16:31], v[92:95], a[60:63], v[16:31]
    ds_read_b128 v[88:91], v14 offset:55296
    s_waitcnt lgkmcnt(5)
    v_rcp_f32 v102, v102
    buffer_load_dwordx4 v2, s[4:7], s43 offen offset:3072  lds
    v_mfma_f32_32x32x16_bf16 v[16:31], v[64:67], a[64:67], v[16:31]
    ds_read_b128 v[92:95], v14 offset:56320
    v_mul_f32 v37, v37, v101
    v_rcp_f32 v103, v103
    v_mul_f32 v38, v38, v102
    v_mfma_f32_32x32x16_bf16 v[16:31], v[68:71], a[68:71], v[16:31]
    ds_read_b128 v[64:67], v14 offset:57344
    s_waitcnt lgkmcnt(5)
    v_cvt_pk_bf16_f32 v104, v32, v33
    v_mul_f32 v39, v39, v103
    v_cvt_pk_bf16_f32 v105, v34, v35
    v_mfma_f32_32x32x16_bf16 v[16:31], v[72:75], a[72:75], v[16:31]
    ds_read_b128 v[68:71], v14 offset:58368
    v_cvt_pk_bf16_f32 v106, v36, v37
    v_cvt_pk_bf16_f32 v107, v38, v39
    s_add_u32 s42, s28, 14618624
    buffer_store_dwordx4 v[104:107], v2, s[4:7], s42 offen
    v_mfma_f32_32x32x16_bf16 v[16:31], v[76:79], a[76:79], v[16:31]
    ds_read_b128 v[72:75], v14 offset:59392
    s_waitcnt lgkmcnt(5)
    v_mul_f32 v96, v48, v48
    v_mul_f32 v97, v49, v49
    s_add_u32 m0, s26, 4096
    s_add_u32 s43, s25, 1249280
    s_cmp_ge_u32 s15, 6
    s_cselect_b32 s43, 2147418112, s43
    buffer_load_dwordx4 v2, s[4:7], s43 offen offset:0  lds
    v_mfma_f32_32x32x16_bf16 v[16:31], v[80:83], a[80:83], v[16:31]
    ds_read_b128 v[76:79], v14 offset:60416
    v_mul_f32 v98, v50, v50
    v_mul_f32 v99, v51, v51
    v_mul_f32 v100, v52, v52
    v_mfma_f32_32x32x16_bf16 v[16:31], v[84:87], a[84:87], v[16:31]
    ds_read_b128 v[80:83], v14 offset:61440
    s_waitcnt lgkmcnt(5)
    v_mul_f32 v101, v53, v53
    v_mul_f32 v102, v54, v54
    v_mul_f32 v103, v55, v55
    v_mfma_f32_32x32x16_bf16 v[16:31], v[88:91], a[88:91], v[16:31]
    ds_read_b128 v[84:87], v14 offset:62464
    v_fma_f32 v96, v96, v121, v120
    v_fma_f32 v97, v97, v121, v120
    v_fma_f32 v98, v98, v121, v120
    v_mfma_f32_32x32x16_bf16 v[16:31], v[92:95], a[92:95], v[16:31]
    ds_read_b128 v[88:91], v14 offset:63488
    s_waitcnt lgkmcnt(5)
    v_fma_f32 v99, v99, v121, v120
    v_fma_f32 v100, v100, v121, v120
    buffer_load_dwordx4 v2, s[4:7], s43 offen offset:1024  lds
    v_mfma_f32_32x32x16_bf16 v[16:31], v[64:67], a[96:99], v[16:31]
    ds_read_b128 v[92:95], v14 offset:64512
    v_fma_f32 v101, v101, v121, v120
    v_fma_f32 v102, v102, v121, v120
    v_fma_f32 v103, v103, v121, v120
    v_mfma_f32_32x32x16_bf16 v[16:31], v[68:71], a[100:103], v[16:31]
    s_waitcnt vmcnt(8)
    s_barrier
    ds_read_b128 v[64:67], v13 offset:0
    s_waitcnt lgkmcnt(5)
    v_mul_f32 v96, v96, v48
    v_mul_f32 v97, v97, v49
    v_mul_f32 v98, v98, v50
    v_mfma_f32_32x32x16_bf16 v[16:31], v[72:75], a[104:107], v[16:31]
    ds_read_b128 v[68:71], v13 offset:1024
    v_mul_f32 v99, v99, v51
    v_mul_f32 v100, v100, v52
    v_mul_f32 v101, v101, v53
    v_mfma_f32_32x32x16_bf16 v[16:31], v[76:79], a[108:111], v[16:31]
    ds_read_b128 v[72:75], v13 offset:2048
    s_waitcnt lgkmcnt(5)
    v_mul_f32 v102, v102, v54
    v_mul_f32 v103, v103, v55
    buffer_load_dwordx4 v2, s[4:7], s43 offen offset:2048  lds
    v_mfma_f32_32x32x16_bf16 v[16:31], v[80:83], a[112:115], v[16:31]
    ds_read_b128 v[76:79], v13 offset:3072
    v_exp_f32 v96, v96
    v_mul_f32 v48, v48, v56
    v_exp_f32 v97, v97
    v_mfma_f32_32x32x16_bf16 v[16:31], v[84:87], a[116:119], v[16:31]
    ds_read_b128 v[80:83], v13 offset:4096
    s_waitcnt lgkmcnt(5)
    v_mul_f32 v49, v49, v57
    v_exp_f32 v98, v98
    v_mul_f32 v50, v50, v58
    v_mfma_f32_32x32x16_bf16 v[16:31], v[88:91], a[120:123], v[16:31]
    ds_read_b128 v[84:87], v13 offset:5120
    v_exp_f32 v99, v99
    v_mul_f32 v51, v51, v59
    v_exp_f32 v100, v100
    v_mfma_f32_32x32x16_bf16 v[16:31], v[92:95], a[124:127], v[16:31]
    ds_read_b128 v[88:91], v13 offset:6144
    s_waitcnt lgkmcnt(5)
    v_mul_f32 v52, v52, v60
    buffer_load_dwordx4 v2, s[4:7], s43 offen offset:3072  lds
    v_mfma_f32_32x32x16_bf16 v[16:31], v[112:115], v[116:119], v[16:31]
    s_add_u32 s42, s35, 5317632
    buffer_load_dwordx4 v[112:115], v2, s[4:7], s42 offen
    v_mfma_f32_32x32x16_bf16 v[32:47], v[64:67], a[0:3], 0
    ds_read_b128 v[92:95], v13 offset:7168
    v_exp_f32 v101, v101
    v_mul_f32 v53, v53, v61
    v_exp_f32 v102, v102
    v_mul_f32 v54, v54, v62
    v_mfma_f32_32x32x16_bf16 v[32:47], v[68:71], a[4:7], v[32:47]
    ds_read_b128 v[64:67], v13 offset:8192
    s_waitcnt lgkmcnt(5)
    v_exp_f32 v103, v103
    v_mul_f32 v55, v55, v63
    v_fma_f32 v96, v96, v122, v122
    v_mfma_f32_32x32x16_bf16 v[32:47], v[72:75], a[8:11], v[32:47]
    ds_read_b128 v[68:71], v13 offset:9216
    v_fma_f32 v97, v97, v122, v122
    v_and_b32 v124, 0xf80, v4
    v_fma_f32 v98, v98, v122, v122
    v_mfma_f32_32x32x16_bf16 v[32:47], v[76:79], a[12:15], v[32:47]
    ds_read_b128 v[72:75], v13 offset:10240
    s_waitcnt lgkmcnt(5)
    v_fma_f32 v99, v99, v122, v122
    v_fma_f32 v100, v100, v122, v122
    v_fma_f32 v101, v101, v122, v122
    v_mfma_f32_32x32x16_bf16 v[32:47], v[80:83], a[16:19], v[32:47]
    ds_read_b128 v[76:79], v13 offset:11264
    v_fma_f32 v102, v102, v122, v122
    v_fma_f32 v103, v103, v122, v122
    v_rcp_f32 v96, v96
    v_mfma_f32_32x32x16_bf16 v[32:47], v[84:87], a[20:23], v[32:47]
    ds_read_b128 v[80:83], v13 offset:12288
    s_waitcnt lgkmcnt(5)
    s_add_u32 s39, s23, s36
    v_rcp_f32 v97, v97
    v_mul_f32 v48, v48, v96
    v_mfma_f32_32x32x16_bf16 v[32:47], v[88:91], a[24:27], v[32:47]
    ds_read_b128 v[84:87], v13 offset:13312
    v_rcp_f32 v98, v98
    v_mul_f32 v49, v49, v97
    v_rcp_f32 v99, v99
    v_mfma_f32_32x32x16_bf16 v[32:47], v[92:95], a[28:31], v[32:47]
    ds_read_b128 v[88:91], v13 offset:14336
    s_waitcnt lgkmcnt(5)
    v_mul_f32 v50, v50, v98
    v_rcp_f32 v100, v100
    s_add_u32 s42, s39, 0
    buffer_load_dword v0, v124, s[4:7], s42 offen
    v_mfma_f32_32x32x16_bf16 v[32:47], v[64:67], a[32:35], v[32:47]
    ds_read_b128 v[92:95], v13 offset:15360
    v_mul_f32 v51, v51, v99
    v_rcp_f32 v101, v101
    v_mul_f32 v52, v52, v100
    v_mfma_f32_32x32x16_bf16 v[32:47], v[68:71], a[36:39], v[32:47]
    ds_read_b128 v[64:67], v13 offset:16384
    s_waitcnt lgkmcnt(5)
    v_rcp_f32 v102, v102
    v_mul_f32 v53, v53, v101
    v_rcp_f32 v103, v103
    v_mfma_f32_32x32x16_bf16 v[32:47], v[72:75], a[40:43], v[32:47]
    ds_read_b128 v[68:71], v13 offset:17408
    v_mul_f32 v54, v54, v102
    s_lshl_b32 s39, s13, 10
    v_cvt_pk_bf16_f32 v104, v48, v49
    v_mfma_f32_32x32x16_bf16 v[32:47], v[76:79], a[44:47], v[32:47]
    ds_read_b128 v[72:75], v13 offset:18432
    s_waitcnt lgkmcnt(5)
    v_mul_f32 v55, v55, v103
    v_cvt_pk_bf16_f32 v105, v50, v51
    v_cvt_pk_bf16_f32 v106, v52, v53
    v_mfma_f32_32x32x16_bf16 v[32:47], v[80:83], a[48:51], v[32:47]
    ds_read_b128 v[76:79], v13 offset:19456
    v_cvt_pk_bf16_f32 v107, v54, v55
    s_add_u32 s42, s28, 14635008
    buffer_store_dwordx4 v[104:107], v2, s[4:7], s42 offen
    v_mul_f32 v96, v16, v16
    v_mfma_f32_32x32x16_bf16 v[32:47], v[84:87], a[52:55], v[32:47]
    ds_read_b128 v[80:83], v13 offset:20480
    s_waitcnt lgkmcnt(5)
    v_and_b32 v124, 0x380, v4
    v_mul_f32 v97, v17, v17
    v_mul_f32 v98, v18, v18
    v_mfma_f32_32x32x16_bf16 v[32:47], v[88:91], a[56:59], v[32:47]
    ds_read_b128 v[84:87], v13 offset:21504
    v_mul_f32 v99, v19, v19
    v_mul_f32 v100, v20, v20
    v_mul_f32 v101, v21, v21
    v_mfma_f32_32x32x16_bf16 v[32:47], v[92:95], a[60:63], v[32:47]
    ds_read_b128 v[88:91], v13 offset:22528
    s_waitcnt lgkmcnt(5)
    v_mul_f32 v102, v22, v22
    v_mul_f32 v103, v23, v23
    s_add_u32 s42, s39, 524288
    buffer_load_dword v0, v124, s[4:7], s42 offen
    v_mfma_f32_32x32x16_bf16 v[32:47], v[64:67], a[64:67], v[32:47]
    ds_read_b128 v[92:95], v13 offset:23552
    v_fma_f32 v96, v96, v121, v120
    v_fma_f32 v97, v97, v121, v120
    v_fma_f32 v98, v98, v121, v120
    v_fma_f32 v99, v99, v121, v120
    v_mfma_f32_32x32x16_bf16 v[32:47], v[68:71], a[68:71], v[32:47]
    ds_read_b128 v[64:67], v13 offset:24576
    s_waitcnt lgkmcnt(5)
    v_fma_f32 v100, v100, v121, v120
    v_fma_f32 v101, v101, v121, v120
    v_fma_f32 v102, v102, v121, v120
    v_mfma_f32_32x32x16_bf16 v[32:47], v[72:75], a[72:75], v[32:47]
    ds_read_b128 v[68:71], v13 offset:25600
    v_fma_f32 v103, v103, v121, v120
    v_and_b32 v124, 0x180, v3
    v_mul_f32 v96, v96, v16
    v_mfma_f32_32x32x16_bf16 v[32:47], v[76:79], a[76:79], v[32:47]
    ds_read_b128 v[72:75], v13 offset:26624
    s_waitcnt lgkmcnt(5)
    v_mul_f32 v97, v97, v17
    v_mul_f32 v98, v98, v18
    v_mul_f32 v99, v99, v19
    v_mfma_f32_32x32x16_bf16 v[32:47], v[80:83], a[80:83], v[32:47]
    ds_read_b128 v[76:79], v13 offset:27648
    v_mul_f32 v100, v100, v20
    v_mul_f32 v101, v101, v21
    v_mul_f32 v102, v102, v22
    v_mfma_f32_32x32x16_bf16 v[32:47], v[84:87], a[84:87], v[32:47]
    ds_read_b128 v[80:83], v13 offset:28672
    s_waitcnt lgkmcnt(5)
    global_load_dword v0, v124, s[92:93]
    v_mul_f32 v103, v103, v23
    v_exp_f32 v96, v96
    v_mfma_f32_32x32x16_bf16 v[32:47], v[88:91], a[88:91], v[32:47]
    ds_read_b128 v[84:87], v13 offset:29696
    v_mul_f32 v16, v16, v24
    v_exp_f32 v97, v97
    v_mul_f32 v17, v17, v25
    v_mfma_f32_32x32x16_bf16 v[32:47], v[92:95], a[92:95], v[32:47]
    ds_read_b128 v[88:91], v13 offset:30720
    s_waitcnt lgkmcnt(5)
    v_exp_f32 v98, v98
    v_mul_f32 v18, v18, v26
    v_min_u32 v125, 4, v1
    v_lshlrev_b32 v125, 17, v125
    v_min_u32 v126, 2176, v4
    v_mfma_f32_32x32x16_bf16 v[32:47], v[64:67], a[96:99], v[32:47]
    ds_read_b128 v[92:95], v13 offset:31744
    v_exp_f32 v99, v99
    v_mul_f32 v19, v19, v27
    v_exp_f32 v100, v100
    v_mfma_f32_32x32x16_bf16 v[32:47], v[68:71], a[100:103], v[32:47]
    s_waitcnt vmcnt(5)
    s_barrier
    ds_read_b128 v[64:67], v2 offset:0
    s_waitcnt lgkmcnt(5)
    v_mul_f32 v20, v20, v28
    v_exp_f32 v101, v101
    v_mul_f32 v21, v21, v29
    v_mfma_f32_32x32x16_bf16 v[32:47], v[72:75], a[104:107], v[32:47]
    ds_read_b128 v[68:71], v2 offset:1024
    v_exp_f32 v102, v102
    s_add_u32 s42, s16, 7499776
    buffer_load_dword v0, v3, s[4:7], s42 offen
    v_mul_f32 v22, v22, v30
    v_mfma_f32_32x32x16_bf16 v[32:47], v[76:79], a[108:111], v[32:47]
    ds_read_b128 v[72:75], v2 offset:2048
    s_waitcnt lgkmcnt(5)
    v_exp_f32 v103, v103
    v_mul_f32 v23, v23, v31
    v_fma_f32 v96, v96, v122, v122
    v_mfma_f32_32x32x16_bf16 v[32:47], v[80:83], a[112:115], v[32:47]
    ds_read_b128 v[76:79], v2 offset:3072
    v_fma_f32 v97, v97, v122, v122
    v_fma_f32 v98, v98, v122, v122
    v_fma_f32 v99, v99, v122, v122
    v_mfma_f32_32x32x16_bf16 v[32:47], v[84:87], a[116:119], v[32:47]
    ds_read_b128 v[80:83], v2 offset:4096
    s_waitcnt lgkmcnt(5)
    s_add_u32 s42, s18, 35876864
    buffer_load_dword v0, v125, s[4:7], s42 offen
    v_fma_f32 v100, v100, v122, v122
    v_fma_f32 v101, v101, v122, v122
    v_mfma_f32_32x32x16_bf16 v[32:47], v[88:91], a[120:123], v[32:47]
    ds_read_b128 v[84:87], v2 offset:5120
    v_fma_f32 v102, v102, v122, v122
    v_fma_f32 v103, v103, v122, v122
    v_rcp_f32 v96, v96
    v_mfma_f32_32x32x16_bf16 v[32:47], v[92:95], a[124:127], v[32:47]
    ds_read_b128 v[88:91], v2 offset:6144
    s_waitcnt lgkmcnt(5)
    v_rcp_f32 v97, v97
    v_mul_f32 v16, v16, v96
    s_add_u32 s42, s32, 29356032
    buffer_load_dword v0, v126, s[4:7], s42 offen
    v_mfma_f32_32x32x16_bf16 v[32:47], v[108:111], v[116:119], v[32:47]
    v_mfma_f32_32x32x16_bf16 v[48:63], v[64:67], a[0:3], 0
    ds_read_b128 v[92:95], v2 offset:7168
    v_rcp_f32 v98, v98
    v_mul_f32 v17, v17, v97
    v_rcp_f32 v99, v99
    v_mul_f32 v18, v18, v98
    v_mfma_f32_32x32x16_bf16 v[48:63], v[68:71], a[4:7], v[48:63]
    ds_read_b128 v[64:67], v2 offset:8192
    s_waitcnt lgkmcnt(5)
    s_add_u32 s38, s24, 3899392
    buffer_load_dwordx4 a[0:3], v2, s[4:7], s38 offen offset:0
    v_rcp_f32 v100, v100
    v_mul_f32 v19, v19, v99
    v_mfma_f32_32x32x16_bf16 v[48:63], v[72:75], a[8:11], v[48:63]
    ds_read_b128 v[68:71], v2 offset:9216
    v_rcp_f32 v101, v101
    v_mul_f32 v20, v20, v100
    buffer_load_dwordx4 a[4:7], v2, s[4:7], s38 offen offset:1024
    v_rcp_f32 v102, v102
    v_mfma_f32_32x32x16_bf16 v[48:63], v[76:79], a[12:15], v[48:63]
    ds_read_b128 v[72:75], v2 offset:10240
    s_waitcnt lgkmcnt(5)
    v_mul_f32 v21, v21, v101
    v_rcp_f32 v103, v103
    v_mul_f32 v22, v22, v102
    v_mfma_f32_32x32x16_bf16 v[48:63], v[80:83], a[16:19], v[48:63]
    ds_read_b128 v[76:79], v2 offset:11264
    buffer_load_dwordx4 a[8:11], v2, s[4:7], s38 offen offset:2048
    v_cvt_pk_bf16_f32 v104, v16, v17
    v_mul_f32 v23, v23, v103
    v_cvt_pk_bf16_f32 v105, v18, v19
    v_mfma_f32_32x32x16_bf16 v[48:63], v[84:87], a[20:23], v[48:63]
    ds_read_b128 v[80:83], v2 offset:12288
    s_waitcnt lgkmcnt(5)
    v_cvt_pk_bf16_f32 v106, v20, v21
    buffer_load_dwordx4 a[12:15], v2, s[4:7], s38 offen offset:3072
    v_cvt_pk_bf16_f32 v107, v22, v23
    v_mfma_f32_32x32x16_bf16 v[48:63], v[88:91], a[24:27], v[48:63]
    ds_read_b128 v[84:87], v2 offset:13312
    s_add_u32 s42, s28, 14651392
    buffer_store_dwordx4 v[104:107], v2, s[4:7], s42 offen
    v_mul_f32 v96, v32, v32
    v_mul_f32 v97, v33, v33
    s_add_u32 s38, s24, 3903488
    buffer_load_dwordx4 a[16:19], v2, s[4:7], s38 offen offset:0
    v_mfma_f32_32x32x16_bf16 v[48:63], v[92:95], a[28:31], v[48:63]
    ds_read_b128 v[88:91], v2 offset:14336
    s_waitcnt lgkmcnt(5)
    v_mul_f32 v98, v34, v34
    v_mul_f32 v99, v35, v35
    v_mul_f32 v100, v36, v36
    v_mfma_f32_32x32x16_bf16 v[48:63], v[64:67], a[32:35], v[48:63]
    ds_read_b128 v[92:95], v2 offset:15360
    v_mul_f32 v101, v37, v37
    buffer_load_dwordx4 a[20:23], v2, s[4:7], s38 offen offset:1024
    v_mul_f32 v102, v38, v38
    v_mfma_f32_32x32x16_bf16 v[48:63], v[68:71], a[36:39], v[48:63]
    ds_read_b128 v[64:67], v2 offset:16384
    s_waitcnt lgkmcnt(5)
    v_mul_f32 v103, v39, v39
    v_fma_f32 v96, v96, v121, v120
    v_fma_f32 v97, v97, v121, v120
    buffer_load_dwordx4 a[24:27], v2, s[4:7], s38 offen offset:2048
    v_mfma_f32_32x32x16_bf16 v[48:63], v[72:75], a[40:43], v[48:63]
    ds_read_b128 v[68:71], v2 offset:17408
    v_fma_f32 v98, v98, v121, v120
    v_fma_f32 v99, v99, v121, v120
    v_fma_f32 v100, v100, v121, v120
    v_mfma_f32_32x32x16_bf16 v[48:63], v[76:79], a[44:47], v[48:63]
    ds_read_b128 v[72:75], v2 offset:18432
    s_waitcnt lgkmcnt(5)
    v_fma_f32 v101, v101, v121, v120
    buffer_load_dwordx4 a[28:31], v2, s[4:7], s38 offen offset:3072
    v_fma_f32 v102, v102, v121, v120
    v_fma_f32 v103, v103, v121, v120
    v_mfma_f32_32x32x16_bf16 v[48:63], v[80:83], a[48:51], v[48:63]
    ds_read_b128 v[76:79], v2 offset:19456
    v_mul_f32 v96, v96, v32
    v_mul_f32 v97, v97, v33
    s_add_u32 s38, s24, 3907584
    buffer_load_dwordx4 a[32:35], v2, s[4:7], s38 offen offset:0
    v_mfma_f32_32x32x16_bf16 v[48:63], v[84:87], a[52:55], v[48:63]
    ds_read_b128 v[80:83], v2 offset:20480
    s_waitcnt lgkmcnt(5)
    v_mul_f32 v98, v98, v34
    v_mul_f32 v99, v99, v35
    v_mul_f32 v100, v100, v36
    v_mul_f32 v101, v101, v37
    v_mfma_f32_32x32x16_bf16 v[48:63], v[88:91], a[56:59], v[48:63]
    ds_read_b128 v[84:87], v2 offset:21504
    buffer_load_dwordx4 a[36:39], v2, s[4:7], s38 offen offset:1024
    v_mul_f32 v102, v102, v38
    v_mul_f32 v103, v103, v39
    v_mfma_f32_32x32x16_bf16 v[48:63], v[92:95], a[60:63], v[48:63]
    ds_read_b128 v[88:91], v2 offset:22528
    s_waitcnt lgkmcnt(5)
    v_exp_f32 v96, v96
    v_mul_f32 v32, v32, v40
    buffer_load_dwordx4 a[40:43], v2, s[4:7], s38 offen offset:2048
    v_mfma_f32_32x32x16_bf16 v[48:63], v[64:67], a[64:67], v[48:63]
    ds_read_b128 v[92:95], v2 offset:23552
    v_exp_f32 v97, v97
    v_mul_f32 v33, v33, v41
    v_exp_f32 v98, v98
    v_mul_f32 v34, v34, v42
    v_mfma_f32_32x32x16_bf16 v[48:63], v[68:71], a[68:71], v[48:63]
    ds_read_b128 v[64:67], v2 offset:24576
    s_waitcnt lgkmcnt(5)
    buffer_load_dwordx4 a[44:47], v2, s[4:7], s38 offen offset:3072
    v_exp_f32 v99, v99
    v_mul_f32 v35, v35, v43
    v_mfma_f32_32x32x16_bf16 v[48:63], v[72:75], a[72:75], v[48:63]
    ds_read_b128 v[68:71], v2 offset:25600
    v_exp_f32 v100, v100
    v_mul_f32 v36, v36, v44
    s_add_u32 s38, s24, 3911680
    buffer_load_dwordx4 a[48:51], v2, s[4:7], s38 offen offset:0
    v_exp_f32 v101, v101
    v_mfma_f32_32x32x16_bf16 v[48:63], v[76:79], a[76:79], v[48:63]
    ds_read_b128 v[72:75], v2 offset:26624
    s_waitcnt lgkmcnt(5)
    v_mul_f32 v37, v37, v45
    v_exp_f32 v102, v102
    s_waitcnt vmcnt(9)
    s_add_u32 s41, s21, 35729408
    v_mov_b32 v15, 1
    buffer_store_dword v15, v8, s[4:7], s41 offen
    v_mfma_f32_32x32x16_bf16 v[48:63], v[80:83], a[80:83], v[48:63]
    ds_read_b128 v[76:79], v2 offset:27648
    v_mul_f32 v38, v38, v46
    buffer_load_dwordx4 a[52:55], v2, s[4:7], s38 offen offset:1024
    v_exp_f32 v103, v103
    v_mul_f32 v39, v39, v47
    v_mfma_f32_32x32x16_bf16 v[48:63], v[84:87], a[84:87], v[48:63]
    ds_read_b128 v[80:83], v2 offset:28672
    s_waitcnt lgkmcnt(5)
    v_fma_f32 v96, v96, v122, v122
    v_fma_f32 v97, v97, v122, v122
    buffer_load_dwordx4 a[56:59], v2, s[4:7], s38 offen offset:2048
    v_mfma_f32_32x32x16_bf16 v[48:63], v[88:91], a[88:91], v[48:63]
    ds_read_b128 v[84:87], v2 offset:29696
    v_fma_f32 v98, v98, v122, v122
    v_fma_f32 v99, v99, v122, v122
    v_fma_f32 v100, v100, v122, v122
    v_fma_f32 v101, v101, v122, v122
    v_mfma_f32_32x32x16_bf16 v[48:63], v[92:95], a[92:95], v[48:63]
    ds_read_b128 v[88:91], v2 offset:30720
    s_waitcnt lgkmcnt(5)
    buffer_load_dwordx4 a[60:63], v2, s[4:7], s38 offen offset:3072
    v_fma_f32 v102, v102, v122, v122
    v_fma_f32 v103, v103, v122, v122
    v_mfma_f32_32x32x16_bf16 v[48:63], v[64:67], a[96:99], v[48:63]
    ds_read_b128 v[92:95], v2 offset:31744
    v_rcp_f32 v96, v96
    v_rcp_f32 v97, v97
    s_add_u32 s38, s24, 3915776
    buffer_load_dwordx4 a[64:67], v2, s[4:7], s38 offen offset:0
    v_mfma_f32_32x32x16_bf16 v[48:63], v[68:71], a[100:103], v[48:63]
    s_waitcnt lgkmcnt(4)
    v_mul_f32 v32, v32, v96
    v_rcp_f32 v98, v98
    v_mul_f32 v33, v33, v97
    v_rcp_f32 v99, v99
    v_mfma_f32_32x32x16_bf16 v[48:63], v[72:75], a[104:107], v[48:63]
    buffer_load_dwordx4 a[68:71], v2, s[4:7], s38 offen offset:1024
    v_mul_f32 v34, v34, v98
    v_rcp_f32 v100, v100
    v_mfma_f32_32x32x16_bf16 v[48:63], v[76:79], a[108:111], v[48:63]
    s_waitcnt lgkmcnt(2)
    v_mul_f32 v35, v35, v99
    v_rcp_f32 v101, v101
    buffer_load_dwordx4 a[72:75], v2, s[4:7], s38 offen offset:2048
    v_mul_f32 v36, v36, v100
    v_mfma_f32_32x32x16_bf16 v[48:63], v[80:83], a[112:115], v[48:63]
    v_rcp_f32 v102, v102
    v_mul_f32 v37, v37, v101
    v_rcp_f32 v103, v103
    v_mfma_f32_32x32x16_bf16 v[48:63], v[84:87], a[116:119], v[48:63]
    s_waitcnt lgkmcnt(0)
    buffer_load_dwordx4 a[76:79], v2, s[4:7], s38 offen offset:3072
    v_mul_f32 v38, v38, v102
    v_cvt_pk_bf16_f32 v104, v32, v33
    v_mul_f32 v39, v39, v103
    v_mfma_f32_32x32x16_bf16 v[48:63], v[88:91], a[120:123], v[48:63]
    v_cvt_pk_bf16_f32 v105, v34, v35
    s_add_u32 s38, s24, 3919872
    buffer_load_dwordx4 a[80:83], v2, s[4:7], s38 offen offset:0
    v_cvt_pk_bf16_f32 v106, v36, v37
    v_mfma_f32_32x32x16_bf16 v[48:63], v[92:95], a[124:127], v[48:63]
    v_cvt_pk_bf16_f32 v107, v38, v39
    s_add_u32 s42, s28, 14667776
    buffer_store_dwordx4 v[104:107], v2, s[4:7], s42 offen
    buffer_load_dwordx4 a[84:87], v2, s[4:7], s38 offen offset:1024
    v_mfma_f32_32x32x16_bf16 v[48:63], v[112:115], v[116:119], v[48:63]
    s_add_u32 s41, s19, 35729408
    buffer_load_dword v123, v3, s[4:7], s41 offen sc1
    s_nop 9
    v_mul_f32 v96, v48, v48
    v_mul_f32 v97, v49, v49
    v_mul_f32 v98, v50, v50
    v_mul_f32 v99, v51, v51
    v_mul_f32 v100, v52, v52
    v_mul_f32 v101, v53, v53
    v_mul_f32 v102, v54, v54
    v_mul_f32 v103, v55, v55
    v_fma_f32 v96, v96, v121, v120
    v_fma_f32 v97, v97, v121, v120
    v_fma_f32 v98, v98, v121, v120
    v_fma_f32 v99, v99, v121, v120
    v_fma_f32 v100, v100, v121, v120
    v_fma_f32 v101, v101, v121, v120
    v_fma_f32 v102, v102, v121, v120
    v_fma_f32 v103, v103, v121, v120
    v_mul_f32 v96, v96, v48
    v_mul_f32 v97, v97, v49
    v_mul_f32 v98, v98, v50
    v_mul_f32 v99, v99, v51
    v_mul_f32 v100, v100, v52
    v_mul_f32 v101, v101, v53
    v_mul_f32 v102, v102, v54
    v_mul_f32 v103, v103, v55
    v_exp_f32 v96, v96
    v_mul_f32 v48, v48, v56
    v_exp_f32 v97, v97
    v_mul_f32 v49, v49, v57
    v_exp_f32 v98, v98
    v_mul_f32 v50, v50, v58
    v_exp_f32 v99, v99
    v_mul_f32 v51, v51, v59
    v_exp_f32 v100, v100
    v_mul_f32 v52, v52, v60
    v_exp_f32 v101, v101
    v_mul_f32 v53, v53, v61
    v_exp_f32 v102, v102
    v_mul_f32 v54, v54, v62
    v_exp_f32 v103, v103
    v_mul_f32 v55, v55, v63
    v_fma_f32 v96, v96, v122, v122
    v_fma_f32 v97, v97, v122, v122
    v_fma_f32 v98, v98, v122, v122
    v_fma_f32 v99, v99, v122, v122
    v_fma_f32 v100, v100, v122, v122
    v_fma_f32 v101, v101, v122, v122
    v_fma_f32 v102, v102, v122, v122
    v_fma_f32 v103, v103, v122, v122
    v_rcp_f32 v96, v96
    v_rcp_f32 v97, v97
    v_mul_f32 v48, v48, v96
    v_rcp_f32 v98, v98
    v_mul_f32 v49, v49, v97
    v_rcp_f32 v99, v99
    v_mul_f32 v50, v50, v98
    v_rcp_f32 v100, v100
    v_mul_f32 v51, v51, v99
    v_rcp_f32 v101, v101
    v_mul_f32 v52, v52, v100
    v_rcp_f32 v102, v102
    v_mul_f32 v53, v53, v101
    v_rcp_f32 v103, v103
    v_mul_f32 v54, v54, v102
    v_cvt_pk_bf16_f32 v104, v48, v49
    v_mul_f32 v55, v55, v103
    v_cvt_pk_bf16_f32 v105, v50, v51
    v_cvt_pk_bf16_f32 v106, v52, v53
    v_cvt_pk_bf16_f32 v107, v54, v55
    s_add_u32 s42, s28, 14684160
    s_cmp_ge_u32 s15, 6
    s_cselect_b32 s42, 2147418112, s42
    buffer_store_dwordx4 v[104:107], v2, s[4:7], s42 offen
    s_waitcnt vmcnt(1)
    v_cmp_gt_u32 vcc, 1, v123
    s_cbranch_vccnz L_main_kernel_aslow_10
L_main_kernel_aback_11:
    s_add_u32 m0, s27, 32768
    s_add_u32 s43, s29, 14602240
    buffer_load_dwordx4 v2, s[4:7], s43 offen offset:0 sc1 lds
    buffer_load_dwordx4 v2, s[4:7], s43 offen offset:1024 sc1 lds
    buffer_load_dwordx4 v2, s[4:7], s43 offen offset:2048 sc1 lds
    buffer_load_dwordx4 v2, s[4:7], s43 offen offset:3072 sc1 lds
    s_waitcnt vmcnt(4)
    s_add_u32 s41, s21, 35729408
    v_mov_b32 v15, 2
    buffer_store_dword v15, v8, s[4:7], s41 offen
    v_add_u32 v13, 32768, v2
    v_add_u32 v14, 98304, v2
    s_add_u32 m0, s27, 49152
    s_add_u32 s43, s29, 14618624
    buffer_load_dwordx4 v2, s[4:7], s43 offen offset:0 sc1 lds
    buffer_load_dwordx4 v2, s[4:7], s43 offen offset:1024 sc1 lds
    buffer_load_dwordx4 v2, s[4:7], s43 offen offset:2048 sc1 lds
    buffer_load_dwordx4 v2, s[4:7], s43 offen offset:3072 sc1 lds
    s_waitcnt vmcnt(5)
    s_barrier
    ds_read_b128 v[32:35], v13 offset:0
    ds_read_b128 v[36:39], v13 offset:1024
    ds_read_b128 v[40:43], v13 offset:2048
    ds_read_b128 v[44:47], v13 offset:3072
    ds_read_b128 v[48:51], v13 offset:4096
    ds_read_b128 v[52:55], v13 offset:5120
    ds_read_b128 v[56:59], v13 offset:6144
    s_waitcnt lgkmcnt(5)
    v_mfma_f32_32x32x16_bf16 v[16:31], a[0:3], v[32:35], 0
    ds_read_b128 v[60:63], v13 offset:7168
    s_add_u32 m0, s27, 65536
    s_add_u32 s43, s29, 14635008
    buffer_load_dwordx4 v2, s[4:7], s43 offen offset:0 sc1 lds
    v_mfma_f32_32x32x16_bf16 v[16:31], a[4:7], v[36:39], v[16:31]
    ds_read_b128 v[32:35], v13 offset:8192
    s_waitcnt lgkmcnt(5)
    buffer_load_dwordx4 v2, s[4:7], s43 offen offset:1024 sc1 lds
    v_mfma_f32_32x32x16_bf16 v[16:31], a[8:11], v[40:43], v[16:31]
    ds_read_b128 v[36:39], v13 offset:9216
    v_mfma_f32_32x32x16_bf16 v[16:31], a[12:15], v[44:47], v[16:31]
    ds_read_b128 v[40:43], v13 offset:10240
    s_waitcnt lgkmcnt(5)
    buffer_load_dwordx4 v2, s[4:7], s43 offen offset:2048 sc1 lds
    v_mfma_f32_32x32x16_bf16 v[16:31], a[16:19], v[48:51], v[16:31]
    ds_read_b128 v[44:47], v13 offset:11264
    buffer_load_dwordx4 v2, s[4:7], s43 offen offset:3072 sc1 lds
    v_mfma_f32_32x32x16_bf16 v[16:31], a[20:23], v[52:55], v[16:31]
    ds_read_b128 v[48:51], v13 offset:12288
    s_waitcnt lgkmcnt(5)
    v_mfma_f32_32x32x16_bf16 v[16:31], a[24:27], v[56:59], v[16:31]
    ds_read_b128 v[52:55], v13 offset:13312
    s_add_u32 m0, s27, 81920
    s_add_u32 s43, s29, 14651392
    buffer_load_dwordx4 v2, s[4:7], s43 offen offset:0 sc1 lds
    v_mfma_f32_32x32x16_bf16 v[16:31], a[28:31], v[60:63], v[16:31]
    ds_read_b128 v[56:59], v13 offset:14336
    s_waitcnt lgkmcnt(5)
    buffer_load_dwordx4 v2, s[4:7], s43 offen offset:1024 sc1 lds
    v_mfma_f32_32x32x16_bf16 v[16:31], a[32:35], v[32:35], v[16:31]
    ds_read_b128 v[60:63], v13 offset:15360
    v_mfma_f32_32x32x16_bf16 v[16:31], a[36:39], v[36:39], v[16:31]
    s_waitcnt vmcnt(6)
    s_barrier
    ds_read_b128 v[32:35], v13 offset:16384
    s_waitcnt lgkmcnt(5)
    buffer_load_dwordx4 v2, s[4:7], s43 offen offset:2048 sc1 lds
    v_mfma_f32_32x32x16_bf16 v[16:31], a[40:43], v[40:43], v[16:31]
    ds_read_b128 v[36:39], v13 offset:17408
    buffer_load_dwordx4 v2, s[4:7], s43 offen offset:3072 sc1 lds
    v_mfma_f32_32x32x16_bf16 v[16:31], a[44:47], v[44:47], v[16:31]
    ds_read_b128 v[40:43], v13 offset:18432
    s_waitcnt lgkmcnt(5)
    v_mfma_f32_32x32x16_bf16 v[16:31], a[48:51], v[48:51], v[16:31]
    ds_read_b128 v[44:47], v13 offset:19456
    s_add_u32 s42, s16, 5402624
    buffer_load_dwordx4 v[64:67], v2, s[4:7], s42 offen sc1
    buffer_load_dwordx4 v[68:71], v2, s[4:7], s42 offen offset:1024 sc1
    v_mfma_f32_32x32x16_bf16 v[16:31], a[52:55], v[52:55], v[16:31]
    ds_read_b128 v[48:51], v13 offset:20480
    s_waitcnt lgkmcnt(5)
    v_mfma_f32_32x32x16_bf16 v[16:31], a[56:59], v[56:59], v[16:31]
    ds_read_b128 v[52:55], v13 offset:21504
    s_add_u32 s39, s100, 524288
    buffer_load_dwordx4 v[80:83], v2, s[4:7], s39 offen offset:0
    v_mfma_f32_32x32x16_bf16 v[16:31], a[60:63], v[60:63], v[16:31]
    ds_read_b128 v[56:59], v13 offset:22528
    s_waitcnt lgkmcnt(5)
    v_mfma_f32_32x32x16_bf16 v[16:31], a[64:67], v[32:35], v[16:31]
    ds_read_b128 v[60:63], v13 offset:23552
    buffer_load_dwordx4 v[84:87], v2, s[4:7], s39 offen offset:1024
    v_mfma_f32_32x32x16_bf16 v[16:31], a[68:71], v[36:39], v[16:31]
    ds_read_b128 v[32:35], v13 offset:24576
    s_waitcnt lgkmcnt(5)
    v_mfma_f32_32x32x16_bf16 v[16:31], a[72:75], v[40:43], v[16:31]
    ds_read_b128 v[36:39], v13 offset:25600
    v_mfma_f32_32x32x16_bf16 v[16:31], a[76:79], v[44:47], v[16:31]
    ds_read_b128 v[40:43], v13 offset:26624
    s_waitcnt lgkmcnt(5)
    buffer_load_dwordx4 v[88:91], v2, s[4:7], s39 offen offset:2048
    v_mfma_f32_32x32x16_bf16 v[16:31], a[80:83], v[48:51], v[16:31]
    ds_read_b128 v[44:47], v13 offset:27648
    v_mfma_f32_32x32x16_bf16 v[16:31], a[84:87], v[52:55], v[16:31]
    ds_read_b128 v[48:51], v13 offset:28672
    s_waitcnt lgkmcnt(5)
    buffer_load_dwordx4 v[92:95], v2, s[4:7], s39 offen offset:3072
    v_mfma_f32_32x32x16_bf16 v[16:31], a[128:131], v[56:59], v[16:31]
    ds_read_b128 v[52:55], v13 offset:29696
    v_mfma_f32_32x32x16_bf16 v[16:31], a[132:135], v[60:63], v[16:31]
    ds_read_b128 v[56:59], v13 offset:30720
    s_waitcnt lgkmcnt(5)
    v_mfma_f32_32x32x16_bf16 v[16:31], a[136:139], v[32:35], v[16:31]
    ds_read_b128 v[60:63], v13 offset:31744
    s_add_u32 s41, s19, 35729408
    buffer_load_dword v79, v3, s[4:7], s41 offen sc1
    v_mfma_f32_32x32x16_bf16 v[16:31], a[140:143], v[36:39], v[16:31]
    s_waitcnt vmcnt(7)
    s_barrier
    ds_read_b128 v[32:35], v13 offset:32768
    s_waitcnt lgkmcnt(5)
    s_add_u32 s38, s23, 0
    buffer_load_dwordx4 a[0:3], v2, s[4:7], s38 offen offset:0
    v_mfma_f32_32x32x16_bf16 v[16:31], a[144:147], v[40:43], v[16:31]
    ds_read_b128 v[36:39], v13 offset:33792
    v_mfma_f32_32x32x16_bf16 v[16:31], a[148:151], v[44:47], v[16:31]
    ds_read_b128 v[40:43], v13 offset:34816
    s_waitcnt lgkmcnt(5)
    buffer_load_dwordx4 a[4:7], v2, s[4:7], s38 offen offset:1024
    v_mfma_f32_32x32x16_bf16 v[16:31], a[152:155], v[48:51], v[16:31]
    ds_read_b128 v[44:47], v13 offset:35840
    v_mfma_f32_32x32x16_bf16 v[16:31], a[156:159], v[52:55], v[16:31]
    ds_read_b128 v[48:51], v13 offset:36864
    s_waitcnt lgkmcnt(5)
    buffer_load_dwordx4 a[8:11], v2, s[4:7], s38 offen offset:2048
    v_mfma_f32_32x32x16_bf16 v[16:31], a[160:163], v[56:59], v[16:31]
    ds_read_b128 v[52:55], v13 offset:37888
    v_mfma_f32_32x32x16_bf16 v[16:31], a[164:167], v[60:63], v[16:31]
    ds_read_b128 v[56:59], v13 offset:38912
    s_waitcnt lgkmcnt(5)
    buffer_load_dwordx4 a[12:15], v2, s[4:7], s38 offen offset:3072
    v_mfma_f32_32x32x16_bf16 v[16:31], a[168:171], v[32:35], v[16:31]
    ds_read_b128 v[60:63], v13 offset:39936
    v_mfma_f32_32x32x16_bf16 v[16:31], a[172:175], v[36:39], v[16:31]
    ds_read_b128 v[32:35], v13 offset:40960
    s_waitcnt lgkmcnt(5)
    v_mfma_f32_32x32x16_bf16 v[16:31], a[176:179], v[40:43], v[16:31]
    ds_read_b128 v[36:39], v13 offset:41984
    s_waitcnt vmcnt(4)
    v_cmp_gt_u32 vcc, 2, v79
    s_cbranch_vccnz L_main_kernel_aslow_12
L_main_kernel_aback_13:
    v_mfma_f32_32x32x16_bf16 v[16:31], a[180:183], v[44:47], v[16:31]
    ds_read_b128 v[40:43], v13 offset:43008
    s_waitcnt lgkmcnt(5)
    s_add_u32 m0, s27, 98304
    s_add_u32 s43, s29, 14667776
    buffer_load_dwordx4 v2, s[4:7], s43 offen offset:0 sc1 lds
    v_mfma_f32_32x32x16_bf16 v[16:31], a[184:187], v[48:51], v[16:31]
    ds_read_b128 v[44:47], v13 offset:44032
    buffer_load_dwordx4 v2, s[4:7], s43 offen offset:1024 sc1 lds
    v_mfma_f32_32x32x16_bf16 v[16:31], a[188:191], v[52:55], v[16:31]
    ds_read_b128 v[48:51], v13 offset:45056
    s_waitcnt lgkmcnt(5)
    v_mfma_f32_32x32x16_bf16 v[16:31], a[192:195], v[56:59], v[16:31]
    ds_read_b128 v[52:55], v13 offset:46080
    buffer_load_dwordx4 v2, s[4:7], s43 offen offset:2048 sc1 lds
    v_mfma_f32_32x32x16_bf16 v[16:31], a[196:199], v[60:63], v[16:31]
    ds_read_b128 v[56:59], v13 offset:47104
    s_waitcnt lgkmcnt(5)
    buffer_load_dwordx4 v2, s[4:7], s43 offen offset:3072 sc1 lds
    v_mfma_f32_32x32x16_bf16 v[16:31], a[200:203], v[32:35], v[16:31]
    ds_read_b128 v[60:63], v13 offset:48128
    s_add_u32 m0, s27, 114688
    s_add_u32 s43, s29, 14684160
    s_cmp_ge_u32 s3, 2
    s_cselect_b32 s43, 2147418112, s43
    buffer_load_dwordx4 v2, s[4:7], s43 offen offset:0 sc1 lds
    v_mfma_f32_32x32x16_bf16 v[16:31], a[204:207], v[36:39], v[16:31]
    ds_read_b128 v[32:35], v13 offset:49152
    s_waitcnt lgkmcnt(5)
    v_mfma_f32_32x32x16_bf16 v[16:31], a[208:211], v[40:43], v[16:31]
    ds_read_b128 v[36:39], v13 offset:50176
    buffer_load_dwordx4 v2, s[4:7], s43 offen offset:1024 sc1 lds
    v_mfma_f32_32x32x16_bf16 v[16:31], a[212:215], v[44:47], v[16:31]
    ds_read_b128 v[40:43], v13 offset:51200
    s_waitcnt lgkmcnt(5)
    buffer_load_dwordx4 v2, s[4:7], s43 offen offset:2048 sc1 lds
    v_mfma_f32_32x32x16_bf16 v[16:31], a[216:219], v[48:51], v[16:31]
    ds_read_b128 v[44:47], v13 offset:52224
    buffer_load_dwordx4 v2, s[4:7], s43 offen offset:3072 sc1 lds
    v_mfma_f32_32x32x16_bf16 v[16:31], a[220:223], v[52:55], v[16:31]
    ds_read_b128 v[48:51], v13 offset:53248
    s_waitcnt lgkmcnt(5)
    v_mfma_f32_32x32x16_bf16 v[16:31], a[224:227], v[56:59], v[16:31]
    ds_read_b128 v[52:55], v13 offset:54272
    s_add_u32 s38, s23, 4096
    buffer_load_dwordx4 a[16:19], v2, s[4:7], s38 offen offset:0
    v_mfma_f32_32x32x16_bf16 v[16:31], a[228:231], v[60:63], v[16:31]
    ds_read_b128 v[56:59], v13 offset:55296
    s_waitcnt lgkmcnt(5)
    buffer_load_dwordx4 a[20:23], v2, s[4:7], s38 offen offset:1024
    v_mfma_f32_32x32x16_bf16 v[16:31], a[232:235], v[32:35], v[16:31]
    ds_read_b128 v[60:63], v13 offset:56320
    v_lshlrev_b32 v112, 16, v64
    v_mfma_f32_32x32x16_bf16 v[16:31], a[236:239], v[36:39], v[16:31]
    ds_read_b128 v[32:35], v13 offset:57344
    s_waitcnt lgkmcnt(5)
    v_and_b32 v113, 0xffff0000, v64
    buffer_load_dwordx4 a[24:27], v2, s[4:7], s38 offen offset:2048
    v_mfma_f32_32x32x16_bf16 v[16:31], a[240:243], v[40:43], v[16:31]
    ds_read_b128 v[36:39], v13 offset:58368
    v_lshlrev_b32 v114, 16, v65
    v_mfma_f32_32x32x16_bf16 v[16:31], a[244:247], v[44:47], v[16:31]
    ds_read_b128 v[40:43], v13 offset:59392
    s_waitcnt lgkmcnt(5)
    v_and_b32 v115, 0xffff0000, v65
    buffer_load_dwordx4 a[28:31], v2, s[4:7], s38 offen offset:3072
    v_mfma_f32_32x32x16_bf16 v[16:31], a[248:251], v[48:51], v[16:31]
    ds_read_b128 v[44:47], v13 offset:60416
    v_lshlrev_b32 v116, 16, v66
    v_and_b32 v117, 0xffff0000, v66
    v_mfma_f32_32x32x16_bf16 v[16:31], a[252:255], v[52:55], v[16:31]
    ds_read_b128 v[48:51], v13 offset:61440
    s_waitcnt lgkmcnt(5)
    v_lshlrev_b32 v118, 16, v67
    s_add_u32 s38, s23, 8192
    buffer_load_dwordx4 a[32:35], v2, s[4:7], s38 offen offset:0
    v_mfma_f32_32x32x16_bf16 v[16:31], v[128:131], v[56:59], v[16:31]
    ds_read_b128 v[52:55], v13 offset:62464
    v_and_b32 v119, 0xffff0000, v67
    v_mfma_f32_32x32x16_bf16 v[16:31], v[132:135], v[60:63], v[16:31]
    ds_read_b128 v[56:59], v13 offset:63488
    s_waitcnt lgkmcnt(5)
    v_lshlrev_b32 v120, 16, v68
    buffer_load_dwordx4 a[36:39], v2, s[4:7], s38 offen offset:1024
    v_mfma_f32_32x32x16_bf16 v[16:31], v[136:139], v[32:35], v[16:31]
    ds_read_b128 v[60:63], v13 offset:64512
    v_and_b32 v121, 0xffff0000, v68
    buffer_load_dwordx4 a[40:43], v2, s[4:7], s38 offen offset:2048
    v_mfma_f32_32x32x16_bf16 v[16:31], v[140:143], v[36:39], v[16:31]
    s_waitcnt vmcnt(7)
    s_barrier
    ds_read_b128 v[32:35], v14 offset:0
    s_waitcnt lgkmcnt(5)
    v_lshlrev_b32 v122, 16, v69
    v_and_b32 v123, 0xffff0000, v69
    v_mfma_f32_32x32x16_bf16 v[16:31], v[144:147], v[40:43], v[16:31]
    ds_read_b128 v[36:39], v14 offset:1024
    v_lshlrev_b32 v124, 16, v70
    buffer_load_dwordx4 a[44:47], v2, s[4:7], s38 offen offset:3072
    v_mfma_f32_32x32x16_bf16 v[16:31], v[148:151], v[44:47], v[16:31]
    ds_read_b128 v[40:43], v14 offset:2048
    s_waitcnt lgkmcnt(5)
    v_and_b32 v125, 0xffff0000, v70
    v_mfma_f32_32x32x16_bf16 v[16:31], v[152:155], v[48:51], v[16:31]
    ds_read_b128 v[44:47], v14 offset:3072
    v_lshlrev_b32 v126, 16, v71
    s_add_u32 s38, s23, 12288
    buffer_load_dwordx4 a[48:51], v2, s[4:7], s38 offen offset:0
    v_mfma_f32_32x32x16_bf16 v[16:31], v[156:159], v[52:55], v[16:31]
    ds_read_b128 v[48:51], v14 offset:4096
    s_waitcnt lgkmcnt(5)
    v_and_b32 v127, 0xffff0000, v71
    v_mfma_f32_32x32x16_bf16 v[16:31], v[160:163], v[56:59], v[16:31]
    ds_read_b128 v[52:55], v14 offset:5120
    buffer_load_dwordx4 a[52:55], v2, s[4:7], s38 offen offset:1024
    v_mfma_f32_32x32x16_bf16 v[16:31], v[164:167], v[60:63], v[16:31]
    ds_read_b128 v[56:59], v14 offset:6144
    s_waitcnt lgkmcnt(5)
    v_mfma_f32_32x32x16_bf16 v[16:31], v[168:171], v[32:35], v[16:31]
    ds_read_b128 v[60:63], v14 offset:7168
    buffer_load_dwordx4 a[56:59], v2, s[4:7], s38 offen offset:2048
    v_mfma_f32_32x32x16_bf16 v[16:31], v[172:175], v[36:39], v[16:31]
    ds_read_b128 v[32:35], v14 offset:8192
    s_waitcnt lgkmcnt(5)
    buffer_load_dwordx4 a[60:63], v2, s[4:7], s38 offen offset:3072
    v_mfma_f32_32x32x16_bf16 v[16:31], v[176:179], v[40:43], v[16:31]
    ds_read_b128 v[36:39], v14 offset:9216
    v_mfma_f32_32x32x16_bf16 v[16:31], v[180:183], v[44:47], v[16:31]
    ds_read_b128 v[40:43], v14 offset:10240
    s_waitcnt lgkmcnt(5)
    s_add_u32 s38, s23, 16384
    buffer_load_dwordx4 a[64:67], v2, s[4:7], s38 offen offset:0
    v_mfma_f32_32x32x16_bf16 v[16:31], v[184:187], v[48:51], v[16:31]
    ds_read_b128 v[44:47], v14 offset:11264
    v_mfma_f32_32x32x16_bf16 v[16:31], v[188:191], v[52:55], v[16:31]
    ds_read_b128 v[48:51], v14 offset:12288
    s_waitcnt lgkmcnt(5)
    buffer_load_dwordx4 a[68:71], v2, s[4:7], s38 offen offset:1024
    v_mfma_f32_32x32x16_bf16 v[16:31], v[192:195], v[56:59], v[16:31]
    ds_read_b128 v[52:55], v14 offset:13312
    v_mfma_f32_32x32x16_bf16 v[16:31], v[196:199], v[60:63], v[16:31]
    ds_read_b128 v[56:59], v14 offset:14336
    s_waitcnt lgkmcnt(5)
    buffer_load_dwordx4 a[72:75], v2, s[4:7], s38 offen offset:2048
    v_mfma_f32_32x32x16_bf16 v[16:31], v[200:203], v[32:35], v[16:31]
    ds_read_b128 v[60:63], v14 offset:15360
    v_mfma_f32_32x32x16_bf16 v[16:31], v[204:207], v[36:39], v[16:31]
    ds_read_b128 v[32:35], v14 offset:16384
    s_waitcnt lgkmcnt(5)
    buffer_load_dwordx4 a[76:79], v2, s[4:7], s38 offen offset:3072
    v_mfma_f32_32x32x16_bf16 v[16:31], v[208:211], v[40:43], v[16:31]
    ds_read_b128 v[36:39], v14 offset:17408
    s_add_u32 s38, s23, 20480
    buffer_load_dwordx4 a[80:83], v2, s[4:7], s38 offen offset:0
    v_mfma_f32_32x32x16_bf16 v[16:31], v[212:215], v[44:47], v[16:31]
    ds_read_b128 v[40:43], v14 offset:18432
    s_waitcnt lgkmcnt(5)
    v_mfma_f32_32x32x16_bf16 v[16:31], v[216:219], v[48:51], v[16:31]
    ds_read_b128 v[44:47], v14 offset:19456
    buffer_load_dwordx4 a[84:87], v2, s[4:7], s38 offen offset:1024
    v_mfma_f32_32x32x16_bf16 v[16:31], v[220:223], v[52:55], v[16:31]
    ds_read_b128 v[48:51], v14 offset:20480
    s_waitcnt lgkmcnt(5)
    v_mfma_f32_32x32x16_bf16 v[16:31], v[224:227], v[56:59], v[16:31]
    ds_read_b128 v[52:55], v14 offset:21504
    buffer_load_dwordx4 a[88:91], v2, s[4:7], s38 offen offset:2048
    v_mfma_f32_32x32x16_bf16 v[16:31], v[228:231], v[60:63], v[16:31]
    s_waitcnt lgkmcnt(4)
    v_mfma_f32_32x32x16_bf16 v[16:31], v[232:235], v[32:35], v[16:31]
    buffer_load_dwordx4 a[92:95], v2, s[4:7], s38 offen offset:3072
    v_mfma_f32_32x32x16_bf16 v[16:31], v[236:239], v[36:39], v[16:31]
    s_waitcnt lgkmcnt(2)
    v_mfma_f32_32x32x16_bf16 v[16:31], v[240:243], v[40:43], v[16:31]
    v_mfma_f32_32x32x16_bf16 v[16:31], v[244:247], v[44:47], v[16:31]
    s_waitcnt lgkmcnt(0)
    v_mfma_f32_32x32x16_bf16 v[16:31], v[248:251], v[48:51], v[16:31]
    v_mfma_f32_32x32x16_bf16 v[16:31], v[252:255], v[52:55], v[16:31]
    v_and_b32 v12, 0xffff, v6
    s_add_u32 s42, s16, 5402624
    s_nop 9
    v_add_f32 v16, v16, v112
    v_add_f32 v17, v17, v113
    v_add_f32 v18, v18, v114
    v_add_f32 v19, v19, v115
    v_add_f32 v20, v20, v116
    v_add_f32 v21, v21, v117
    v_add_f32 v22, v22, v118
    v_add_f32 v23, v23, v119
    v_add_f32 v24, v24, v120
    v_add_f32 v25, v25, v121
    v_add_f32 v26, v26, v122
    v_add_f32 v27, v27, v123
    v_add_f32 v28, v28, v124
    v_add_f32 v29, v29, v125
    v_add_f32 v30, v30, v126
    v_add_f32 v31, v31, v127
    v_cvt_pk_bf16_f32 v48, v16, v17
    v_cvt_pk_bf16_f32 v49, v18, v19
    v_cvt_pk_bf16_f32 v50, v20, v21
    v_cvt_pk_bf16_f32 v51, v22, v23
    buffer_store_dwordx4 v[48:51], v2, s[4:7], s42 offen offset:0
    v_cvt_pk_bf16_f32 v52, v24, v25
    v_cvt_pk_bf16_f32 v53, v26, v27
    v_cvt_pk_bf16_f32 v54, v28, v29
    v_cvt_pk_bf16_f32 v55, v30, v31
    buffer_store_dwordx4 v[52:55], v2, s[4:7], s42 offen offset:1024
    v_pk_mul_f32 v[58:59], v[16:17], v[16:17]
    v_pk_add_f32 v[56:57], v[16:17], v[18:19]
    v_pk_fma_f32 v[58:59], v[18:19], v[18:19], v[58:59]
    v_pk_fma_f32 v[58:59], v[20:21], v[20:21], v[58:59]
    v_pk_add_f32 v[56:57], v[56:57], v[20:21]
    v_pk_fma_f32 v[58:59], v[22:23], v[22:23], v[58:59]
    v_pk_add_f32 v[56:57], v[56:57], v[22:23]
    v_pk_fma_f32 v[58:59], v[24:25], v[24:25], v[58:59]
    v_pk_add_f32 v[56:57], v[56:57], v[24:25]
    v_pk_fma_f32 v[58:59], v[26:27], v[26:27], v[58:59]
    v_pk_add_f32 v[56:57], v[56:57], v[26:27]
    v_pk_fma_f32 v[58:59], v[28:29], v[28:29], v[58:59]
    v_pk_add_f32 v[56:57], v[56:57], v[28:29]
    v_pk_fma_f32 v[58:59], v[30:31], v[30:31], v[58:59]
    v_pk_add_f32 v[56:57], v[56:57], v[30:31]
    v_add_f32 v56, v56, v57
    v_add_f32 v57, v58, v59
    v_mov_b32 v58, v56
    v_mov_b32 v59, v57
    s_add_u32 s42, s30, 13791232
    s_nop 0
    v_permlane32_swap_b32 v56, v58
    v_permlane32_swap_b32 v57, v59
    s_nop 0
    v_add_f32 v56, v56, v58
    v_add_f32 v57, v57, v59
    buffer_store_dwordx2 v[56:57], v12, s[4:7], s42 offen
    s_waitcnt vmcnt(0)
    s_add_u32 s41, s18, 35876864
    v_mov_b32 v15, 1
    buffer_store_dword v15, v8, s[4:7], s41 offen
    s_add_u32 s38, s23, 24576
    buffer_load_dwordx4 a[96:99], v2, s[4:7], s38 offen offset:0
    buffer_load_dwordx4 a[100:103], v2, s[4:7], s38 offen offset:1024
    buffer_load_dwordx4 a[104:107], v2, s[4:7], s38 offen offset:2048
    buffer_load_dwordx4 a[108:111], v2, s[4:7], s38 offen offset:3072
    s_add_u32 s38, s23, 28672
    buffer_load_dwordx4 a[112:115], v2, s[4:7], s38 offen offset:0
    buffer_load_dwordx4 a[116:119], v2, s[4:7], s38 offen offset:1024
    buffer_load_dwordx4 a[120:123], v2, s[4:7], s38 offen offset:2048
    buffer_load_dwordx4 a[124:127], v2, s[4:7], s38 offen offset:3072
    s_lshl_b32 s42, s14, 7
    s_add_u32 s42, s42, 5308416
    buffer_load_dwordx4 v[64:67], v7, s[4:7], s42 offen offset:0
    buffer_load_dwordx4 v[68:71], v7, s[4:7], s42 offen offset:16
    buffer_load_dwordx4 v[72:75], v7, s[4:7], s42 offen offset:32
    buffer_load_dwordx4 v[76:79], v7, s[4:7], s42 offen offset:48
    v_lshrrev_b32 v12, 4, v1
    v_lshlrev_b32 v13, 4, v12
    s_and_b32 s42, s13, 1
    s_lshl_b32 s42, s42, 6
    s_add_u32 s42, s42, 5310464
    buffer_load_dwordx4 v[100:103], v13, s[4:7], s42 offen
    s_lshr_b32 s43, s13, 1
    s_and_b32 s43, s43, 1
    s_lshl_b32 s42, s43, 4
    v_and_b32 v13, 15, v1
    v_add_u32 v106, s42, v13
    v_and_b32 v14, 1, v12
    v_lshrrev_b32 v15, 1, v12
    v_lshl_add_u32 v104, v14, 5, v106
    v_lshlrev_b32 v104, 4, v104
    v_lshl_add_u32 v104, v15, 10, v104
    v_add_u32 v104, s26, v104
    s_bitcmp1_b32 s13, 0
    s_cbranch_scc1 L_main_kernel_isv_14
    v_lshl_add_u32 v105, v15, 5, v106
    v_lshlrev_b32 v105, 4, v105
    v_lshl_add_u32 v105, v14, 3, v105
    s_mov_b32 s40, 2
    s_branch L_main_kernel_isk_15
L_main_kernel_isv_14:
    v_lshrrev_b32 v105, 3, v13
    v_lshlrev_b32 v105, 4, v105
    v_lshl_add_u32 v105, v14, 3, v105
    v_lshl_add_u32 v105, v15, 2, v105
    v_lshlrev_b32 v105, 4, v105
    v_and_b32 v13, 7, v13
    v_lshl_add_u32 v105, v13, 1, v105
    s_lshl_b32 s42, s43, 9
    s_add_u32 s42, s42, 1024
    v_add_u32 v105, s42, v105
    s_mov_b32 s40, 16
L_main_kernel_isk_15:
    v_lshlrev_b32 v106, 2, v106
    s_mov_b32 s37, s40
    s_add_u32 s41, s19, 35876864
    s_mov_b32 s40, 0
L_main_kernel_poll_16:
    buffer_load_dword v15, v3, s[4:7], s41 offen sc1
    s_add_u32 s40, s40, 1
    s_waitcnt vmcnt(0)
    v_cmp_gt_u32 vcc, 1, v15
    s_cbranch_vccz L_main_kernel_polld_17
    s_cmp_lt_u32 s40, 262144
    s_cbranch_scc1 L_main_kernel_poll_16
L_main_kernel_polld_17:
    s_add_u32 s43, s17, s26
    s_add_u32 m0, s26, 0
    s_add_u32 s42, s43, 5402624
    buffer_load_dwordx4 v2, s[4:7], s42 offen offset:0 sc1 lds
    buffer_load_dwordx4 v2, s[4:7], s42 offen offset:1024 sc1 lds
    buffer_load_dwordx4 v2, s[4:7], s42 offen offset:2048 sc1 lds
    buffer_load_dwordx4 v2, s[4:7], s42 offen offset:3072 sc1 lds
    s_add_u32 m0, s26, 4096
    s_add_u32 s42, s43, 5406720
    buffer_load_dwordx4 v2, s[4:7], s42 offen offset:0 sc1 lds
    buffer_load_dwordx4 v2, s[4:7], s42 offen offset:1024 sc1 lds
    buffer_load_dwordx4 v2, s[4:7], s42 offen offset:2048 sc1 lds
    buffer_load_dwordx4 v2, s[4:7], s42 offen offset:3072 sc1 lds
    s_waitcnt vmcnt(0)
    ds_read_b128 v[32:35], v104 offset:0
    ds_read_b128 v[36:39], v104 offset:2048
    ds_read_b128 v[40:43], v104 offset:4096
    ds_read_b128 v[44:47], v104 offset:6144
    s_add_u32 s42, s33, 13791232
    buffer_load_dwordx2 v[112:113], v6, s[4:7], s42 offen sc1
    s_add_u32 s42, s33, 13807616
    buffer_load_dwordx2 v[114:115], v6, s[4:7], s42 offen sc1
    s_add_u32 s42, s33, 13824000
    buffer_load_dwordx2 v[116:117], v6, s[4:7], s42 offen sc1
    s_add_u32 s42, s33, 13840384
    buffer_load_dwordx2 v[118:119], v6, s[4:7], s42 offen sc1
    s_add_u32 s42, s33, 13856768
    buffer_load_dwordx2 v[120:121], v6, s[4:7], s42 offen sc1
    s_add_u32 s42, s33, 13873152
    buffer_load_dwordx2 v[122:123], v6, s[4:7], s42 offen sc1
    s_add_u32 s42, s33, 13889536
    buffer_load_dwordx2 v[124:125], v6, s[4:7], s42 offen sc1
    s_add_u32 s42, s33, 13905920
    buffer_load_dwordx2 v[126:127], v6, s[4:7], s42 offen sc1
    s_waitcnt lgkmcnt(3)
    v_mfma_f32_16x16x32_bf16 v[96:99], v[80:83], v[32:35], 0
    s_waitcnt lgkmcnt(2)
    v_mfma_f32_16x16x32_bf16 v[96:99], v[84:87], v[36:39], v[96:99]
    s_waitcnt lgkmcnt(1)
    v_mfma_f32_16x16x32_bf16 v[96:99], v[88:91], v[40:43], v[96:99]
    s_waitcnt lgkmcnt(0)
    v_mfma_f32_16x16x32_bf16 v[96:99], v[92:95], v[44:47], v[96:99]
    s_lshl_b32 s42, s3, 10
    v_add_u32 v13, s42, v2
    s_nop 5
    ds_write_b128 v13, v[96:99] offset:32768
    s_waitcnt lgkmcnt(0)
    s_barrier
    ds_read_b128 v[32:35], v2 offset:0
    ds_read_b128 v[36:39], v2 offset:1024
    ds_read_b128 v[40:43], v2 offset:2048
    ds_read_b128 v[44:47], v2 offset:3072
    ds_read_b128 v[48:51], v2 offset:4096
    ds_read_b128 v[52:55], v2 offset:5120
    ds_read_b128 v[56:59], v2 offset:6144
    s_waitcnt lgkmcnt(5)
    v_mfma_f32_32x32x16_bf16 v[16:31], a[0:3], v[32:35], 0
    ds_read_b128 v[60:63], v2 offset:7168
    ds_read_b128 v[80:83], v2 offset:32768
    v_mfma_f32_32x32x16_bf16 v[16:31], a[4:7], v[36:39], v[16:31]
    ds_read_b128 v[32:35], v2 offset:8192
    s_waitcnt lgkmcnt(5)
    ds_read_b128 v[84:87], v2 offset:33792
    v_mfma_f32_32x32x16_bf16 v[16:31], a[8:11], v[40:43], v[16:31]
    ds_read_b128 v[36:39], v2 offset:9216
    ds_read_b128 v[88:91], v2 offset:34816
    v_mfma_f32_32x32x16_bf16 v[16:31], a[12:15], v[44:47], v[16:31]
    ds_read_b128 v[40:43], v2 offset:10240
    s_waitcnt lgkmcnt(5)
    ds_read_b128 v[92:95], v2 offset:35840
    v_mfma_f32_32x32x16_bf16 v[16:31], a[16:19], v[48:51], v[16:31]
    ds_read_b128 v[44:47], v2 offset:11264
    v_mfma_f32_32x32x16_bf16 v[16:31], a[20:23], v[52:55], v[16:31]
    ds_read_b128 v[48:51], v2 offset:12288
    s_waitcnt lgkmcnt(5)
    s_waitcnt vmcnt(0)
    v_add_f32 v112, v112, v114
    v_add_f32 v113, v113, v115
    v_add_f32 v112, v112, v116
    v_mfma_f32_32x32x16_bf16 v[16:31], a[24:27], v[56:59], v[16:31]
    ds_read_b128 v[52:55], v2 offset:13312
    v_add_f32 v113, v113, v117
    v_add_f32 v112, v112, v118
    v_add_f32 v113, v113, v119
    v_mfma_f32_32x32x16_bf16 v[16:31], a[28:31], v[60:63], v[16:31]
    ds_read_b128 v[56:59], v2 offset:14336
    s_waitcnt lgkmcnt(5)
    v_add_f32 v112, v112, v120
    v_add_f32 v113, v113, v121
    v_add_f32 v112, v112, v122
    v_mfma_f32_32x32x16_bf16 v[16:31], a[32:35], v[32:35], v[16:31]
    ds_read_b128 v[60:63], v2 offset:15360
    v_add_f32 v113, v113, v123
    v_add_f32 v112, v112, v124
    v_add_f32 v113, v113, v125
    v_mfma_f32_32x32x16_bf16 v[16:31], a[36:39], v[36:39], v[16:31]
    ds_read_b128 v[32:35], v2 offset:16384
    s_waitcnt lgkmcnt(5)
    v_add_f32 v112, v112, v126
    v_add_f32 v113, v113, v127
    v_mov_b32 v114, v112
    v_mov_b32 v115, v113
    s_nop 1
    v_permlane32_swap_b32 v112, v114
    v_permlane32_swap_b32 v113, v115
    s_nop 1
    v_add_f32 v112, v112, v114
    v_add_f32 v113, v113, v115
    v_mfma_f32_32x32x16_bf16 v[16:31], a[40:43], v[40:43], v[16:31]
    ds_read_b128 v[36:39], v2 offset:17408
    v_mul_f32 v10, 0x3b000000, v112
    v_mul_f32 v12, 0x3b000000, v113
    v_fma_f32 v12, -v10, v10, v12
    v_max_f32 v12, 0, v12
    v_add_f32 v12, 0x3727c5ac, v12
    v_rsq_f32 v11, v12
    s_nop 0
    ds_bpermute_b32 v107, v106, v10
    ds_bpermute_b32 v108, v106, v11
    v_mfma_f32_32x32x16_bf16 v[16:31], a[44:47], v[44:47], v[16:31]
    ds_read_b128 v[40:43], v2 offset:18432
    s_waitcnt lgkmcnt(5)
    v_mul_f32 v12, 0x3eb8aa3b, v11
    v_add_f32 v80, v80, v84
    v_add_f32 v88, v88, v92
    v_mfma_f32_32x32x16_bf16 v[16:31], a[48:51], v[48:51], v[16:31]
    ds_read_b128 v[44:47], v2 offset:19456
    v_add_f32 v81, v81, v85
    v_add_f32 v89, v89, v93
    v_add_f32 v82, v82, v86
    v_add_f32 v90, v90, v94
    v_mfma_f32_32x32x16_bf16 v[16:31], a[52:55], v[52:55], v[16:31]
    ds_read_b128 v[48:51], v2 offset:20480
    s_waitcnt lgkmcnt(5)
    v_add_f32 v83, v83, v87
    v_add_f32 v91, v91, v95
    v_add_f32 v80, v80, v88
    v_mfma_f32_32x32x16_bf16 v[16:31], a[56:59], v[56:59], v[16:31]
    ds_read_b128 v[52:55], v2 offset:21504
    v_add_f32 v81, v81, v89
    v_add_f32 v82, v82, v90
    v_add_f32 v83, v83, v91
    v_mfma_f32_32x32x16_bf16 v[16:31], a[60:63], v[60:63], v[16:31]
    ds_read_b128 v[56:59], v2 offset:22528
    s_waitcnt lgkmcnt(5)
    s_waitcnt lgkmcnt(0)
    v_fma_f32 v80, -v107, v100, v80
    v_fma_f32 v81, -v107, v101, v81
    v_mfma_f32_32x32x16_bf16 v[16:31], a[64:67], v[32:35], v[16:31]
    ds_read_b128 v[60:63], v2 offset:23552
    v_fma_f32 v82, -v107, v102, v82
    v_fma_f32 v83, -v107, v103, v83
    v_mul_f32 v80, v108, v80
    v_mfma_f32_32x32x16_bf16 v[16:31], a[68:71], v[36:39], v[16:31]
    ds_read_b128 v[32:35], v2 offset:24576
    s_waitcnt lgkmcnt(5)
    v_mul_f32 v81, v108, v81
    v_mul_f32 v82, v108, v82
    v_mul_f32 v83, v108, v83
    v_mfma_f32_32x32x16_bf16 v[16:31], a[72:75], v[40:43], v[16:31]
    ds_read_b128 v[36:39], v2 offset:25600
    v_cvt_pk_bf16_f32 v84, v80, v81
    v_cvt_pk_bf16_f32 v85, v82, v83
    s_add_u32 s42, s32, 29356032
    s_add_u32 s43, s32, 29216768
    s_cmp_eq_u32 s3, 0
    s_cselect_b32 s42, s42, 2147418112
    s_cmp_eq_u32 s3, 1
    s_cselect_b32 s43, s43, 2147418112
    buffer_store_short v84, v105, s[4:7], s43 offen sc1
    buffer_store_short v84, v105, s[4:7], s42 offen
    s_add_u32 s42, s42, s37
    s_add_u32 s43, s43, s37
    v_mfma_f32_32x32x16_bf16 v[16:31], a[76:79], v[44:47], v[16:31]
    ds_read_b128 v[40:43], v2 offset:26624
    s_waitcnt lgkmcnt(5)
    buffer_store_short_d16_hi v84, v105, s[4:7], s43 offen sc1
    buffer_store_short_d16_hi v84, v105, s[4:7], s42 offen
    s_add_u32 s42, s42, s37
    s_add_u32 s43, s43, s37
    buffer_store_short v85, v105, s[4:7], s43 offen sc1
    buffer_store_short v85, v105, s[4:7], s42 offen
    s_add_u32 s42, s42, s37
    s_add_u32 s43, s43, s37
    buffer_store_short_d16_hi v85, v105, s[4:7], s43 offen sc1
    buffer_store_short_d16_hi v85, v105, s[4:7], s42 offen
    v_mfma_f32_32x32x16_bf16 v[16:31], a[80:83], v[48:51], v[16:31]
    ds_read_b128 v[44:47], v2 offset:27648
    v_mfma_f32_32x32x16_bf16 v[16:31], a[84:87], v[52:55], v[16:31]
    ds_read_b128 v[48:51], v2 offset:28672
    s_waitcnt lgkmcnt(5)
    v_mfma_f32_32x32x16_bf16 v[16:31], a[88:91], v[56:59], v[16:31]
    ds_read_b128 v[52:55], v2 offset:29696
    v_mfma_f32_32x32x16_bf16 v[16:31], a[92:95], v[60:63], v[16:31]
    ds_read_b128 v[56:59], v2 offset:30720
    s_waitcnt lgkmcnt(5)
    v_mfma_f32_32x32x16_bf16 v[16:31], a[96:99], v[32:35], v[16:31]
    ds_read_b128 v[60:63], v2 offset:31744
    v_mfma_f32_32x32x16_bf16 v[16:31], a[100:103], v[36:39], v[16:31]
    s_waitcnt lgkmcnt(4)
    v_mfma_f32_32x32x16_bf16 v[16:31], a[104:107], v[40:43], v[16:31]
    v_mfma_f32_32x32x16_bf16 v[16:31], a[108:111], v[44:47], v[16:31]
    s_waitcnt lgkmcnt(2)
    v_mfma_f32_32x32x16_bf16 v[16:31], a[112:115], v[48:51], v[16:31]
    v_mfma_f32_32x32x16_bf16 v[16:31], a[116:119], v[52:55], v[16:31]
    s_waitcnt lgkmcnt(0)
    v_mfma_f32_32x32x16_bf16 v[16:31], a[120:123], v[56:59], v[16:31]
    v_mfma_f32_32x32x16_bf16 v[16:31], a[124:127], v[60:63], v[16:31]
    s_add_u32 s42, s16, 7499776
    s_nop 10
    v_fma_f32 v16, -v10, v64, v16
    v_mul_f32 v16, v12, v16
    v_fma_f32 v17, -v10, v65, v17
    v_mul_f32 v17, v12, v17
    v_fma_f32 v18, -v10, v66, v18
    v_mul_f32 v18, v12, v18
    v_fma_f32 v19, -v10, v67, v19
    v_mul_f32 v19, v12, v19
    v_fma_f32 v20, -v10, v68, v20
    v_mul_f32 v20, v12, v20
    v_fma_f32 v21, -v10, v69, v21
    v_mul_f32 v21, v12, v21
    v_fma_f32 v22, -v10, v70, v22
    v_mul_f32 v22, v12, v22
    v_fma_f32 v23, -v10, v71, v23
    v_mul_f32 v23, v12, v23
    v_cvt_pk_bf16_f32 v48, v16, v17
    v_cvt_pk_bf16_f32 v49, v18, v19
    v_cvt_pk_bf16_f32 v50, v20, v21
    v_cvt_pk_bf16_f32 v51, v22, v23
    buffer_store_dwordx4 v[48:51], v2, s[4:7], s42 offen offset:0
    v_fma_f32 v24, -v10, v72, v24
    v_mul_f32 v24, v12, v24
    v_fma_f32 v25, -v10, v73, v25
    v_mul_f32 v25, v12, v25
    v_fma_f32 v26, -v10, v74, v26
    v_mul_f32 v26, v12, v26
    v_fma_f32 v27, -v10, v75, v27
    v_mul_f32 v27, v12, v27
    v_fma_f32 v28, -v10, v76, v28
    v_mul_f32 v28, v12, v28
    v_fma_f32 v29, -v10, v77, v29
    v_mul_f32 v29, v12, v29
    v_fma_f32 v30, -v10, v78, v30
    v_mul_f32 v30, v12, v30
    v_fma_f32 v31, -v10, v79, v31
    v_mul_f32 v31, v12, v31
    v_cvt_pk_bf16_f32 v52, v24, v25
    v_cvt_pk_bf16_f32 v53, v26, v27
    v_cvt_pk_bf16_f32 v54, v28, v29
    v_cvt_pk_bf16_f32 v55, v30, v31
    buffer_store_dwordx4 v[52:55], v2, s[4:7], s42 offen offset:1024
    s_waitcnt vmcnt(0)
    s_add_u32 s41, s18, 36007936
    v_mov_b32 v15, 1
    buffer_store_dword v15, v8, s[4:7], s41 offen
    s_lshl_b32 s43, s12, 7
    s_add_u32 s43, s43, 36532224
    s_cmp_eq_u32 s3, 1
    s_cselect_b32 s43, s43, 2147418112
    s_mov_b64 exec, 1
    buffer_atomic_add v15, v8, s[4:7], s43 offen sc1
    s_mov_b64 exec, -1
    v_lshrrev_b32 v121, 3, v1
    v_lshlrev_b32 v121, 9, v121
    v_and_b32 v14, 0x70, v2
    v_lshlrev_b32 v13, 1, v1
    v_and_b32 v13, 0x60, v13
    v_xor_b32 v14, v14, v13
    v_add_u32 v121, v121, v14
    v_mov_b32 v112, 0xdddddddd
    v_add_u32 v113, 24576, v2
    v_and_b32 v14, 15, v1
    v_lshlrev_b32 v14, 4, v14
    v_lshrrev_b32 v13, 5, v1
    v_lshl_add_u32 v14, v13, 8, v14
    v_add_u32 v114, 25600, v14
    v_add_u32 v115, 26112, v14
    v_and_b32 v14, 27, v1
    v_cmp_eq_u32 vcc, 16, v14
    v_mov_b32 v14, 26640
    v_mov_b32 v13, 26624
    v_cndmask_b32 v14, v14, v13, vcc
    v_and_b32 v13, 16, v1
    v_cmp_ne_u32 vcc, 0, v13
    s_nop 1
    v_cndmask_b32 v114, v114, v14, vcc
    v_cndmask_b32 v115, v115, v14, vcc
    v_mov_b32 v24, 0
    v_mov_b32 v25, 0
    v_mov_b32 v26, 0
    v_mov_b32 v27, 0
    v_mov_b32 v28, 0
    v_mov_b32 v29, 0
    v_mov_b32 v30, 0
    v_mov_b32 v31, 0
    v_mov_b32 v32, 0
    v_mov_b32 v33, 0
    v_mov_b32 v34, 0
    v_mov_b32 v35, 0
    v_mov_b32 v36, 0
    v_mov_b32 v37, 0
    v_mov_b32 v38, 0
    v_mov_b32 v39, 0
    v_mov_b32 v40, 0
    v_mov_b32 v41, 0
    v_mov_b32 v42, 0
    v_mov_b32 v43, 0
    v_mov_b32 v44, 0
    v_mov_b32 v45, 0
    v_mov_b32 v46, 0
    v_mov_b32 v47, 0
    v_mov_b32 v48, 0
    v_mov_b32 v49, 0
    v_mov_b32 v50, 0
    v_mov_b32 v51, 0
    v_mov_b32 v52, 0
    v_mov_b32 v53, 0
    v_mov_b32 v54, 0
    v_mov_b32 v55, 0
    v_min_u32 v118, 4, v1
    v_lshlrev_b32 v118, 17, v118
    v_min_u32 v119, 2176, v4
    v_and_b32 v120, 0x380, v3
    v_and_b32 v117, 0x80, v3
    v_and_b32 v122, 0xf80, v4
    v_lshlrev_b32 v123, 2, v1
    v_and_b32 v124, 0x180, v3
    s_mul_i32 s37, s12, 17408
    s_add_u32 s39, s37, s27
    s_mov_b32 s41, 35876864
    s_mov_b32 s40, 0
L_main_kernel_poll_18:
    buffer_load_dword v15, v9, s[4:7], s41 offen sc1
    s_add_u32 s40, s40, 1
    s_waitcnt vmcnt(0)
    v_cmp_gt_u32 vcc, 1, v15
    s_cbranch_vccz L_main_kernel_polld_19
    s_cmp_lt_u32 s40, 262144
    s_cbranch_scc1 L_main_kernel_poll_18
L_main_kernel_polld_19:
    s_add_u32 m0, s101, 0
    s_add_u32 s42, s31, 7499776
    buffer_load_dwordx4 v121, s[4:7], s42 offen sc1 lds
    s_add_u32 m0, s101, 1024
    s_add_u32 s42, s31, 7503872
    buffer_load_dwordx4 v121, s[4:7], s42 offen sc1 lds
    s_add_u32 m0, s27, 24576
    s_add_u32 s43, s39, 29356032
    buffer_load_dwordx4 v2, s[4:7], s43 offen offset:0 sc1 lds
    buffer_load_dwordx4 v2, s[4:7], s43 offen offset:1024 sc1 lds
    buffer_load_dwordx4 v2, s[4:7], s43 offen offset:2048 sc1 lds
    buffer_load_dwordx4 v2, s[4:7], s43 offen offset:3072 sc1 lds
    s_mov_b32 m0, 40960
    s_add_u32 s43, s37, 29372416
    buffer_load_dwordx4 v2, s[4:7], s43 offen offset:0 sc1 lds
    s_waitcnt vmcnt(0)
    s_barrier
    ds_read_b128 v[16:19], v5
    ds_read_b128 v[20:23], v5 offset:16
    ds_read_b128 v[56:59], v113 offset:0
    ds_read_b128 v[64:67], v114 offset:0
    ds_read_b128 v[68:71], v115 offset:0
    s_waitcnt lgkmcnt(2)
    v_mfma_f32_32x32x16_bf16 v[80:95], v[56:59], v[16:19], 0
    s_nop 11
    s_waitcnt lgkmcnt(0)
    v_exp_f32 v80, v80
    v_exp_f32 v81, v81
    v_exp_f32 v82, v82
    v_exp_f32 v83, v83
    v_exp_f32 v84, v84
    v_mfma_f32_32x32x16_bf16 v[96:111], v[56:59], v[20:23], 0
    ds_read_b128 v[60:63], v113 offset:2080
    ds_read_b128 v[72:75], v114 offset:2080
    ds_read_b128 v[76:79], v115 offset:2080
    v_exp_f32 v85, v85
    v_exp_f32 v86, v86
    v_exp_f32 v87, v87
    v_exp_f32 v88, v88
    v_exp_f32 v89, v89
    v_smfmac_f32_32x32x32_bf16 v[24:39], v[64:67], v[80:87], v112
    v_exp_f32 v90, v90
    v_exp_f32 v91, v91
    v_exp_f32 v92, v92
    v_exp_f32 v93, v93
    v_exp_f32 v94, v94
    v_exp_f32 v95, v95
    v_exp_f32 v96, v96
    v_exp_f32 v97, v97
    v_smfmac_f32_32x32x32_bf16 v[24:39], v[68:71], v[88:95], v112
    s_waitcnt lgkmcnt(0)
    s_mov_b32 s41, 36532224
    buffer_load_dword v116, v120, s[4:7], s41 offen sc1
    v_exp_f32 v98, v98
    v_exp_f32 v99, v99
    v_exp_f32 v100, v100
    v_mfma_f32_32x32x16_bf16 v[80:95], v[60:63], v[16:19], 0
    v_exp_f32 v101, v101
    v_exp_f32 v102, v102
    v_exp_f32 v103, v103
    v_exp_f32 v104, v104
    v_exp_f32 v105, v105
    v_smfmac_f32_32x32x32_bf16 v[40:55], v[64:67], v[96:103], v112
    v_exp_f32 v106, v106
    v_exp_f32 v107, v107
    v_exp_f32 v108, v108
    v_exp_f32 v109, v109
    v_exp_f32 v110, v110
    v_exp_f32 v111, v111
    v_exp_f32 v80, v80
    v_exp_f32 v81, v81
    v_smfmac_f32_32x32x32_bf16 v[40:55], v[68:71], v[104:111], v112
    v_exp_f32 v82, v82
    v_exp_f32 v83, v83
    v_exp_f32 v84, v84
    v_mfma_f32_32x32x16_bf16 v[96:111], v[60:63], v[20:23], 0
    ds_read_b128 v[56:59], v113 offset:4160
    ds_read_b128 v[64:67], v114 offset:4160
    ds_read_b128 v[68:71], v115 offset:4160
    v_exp_f32 v85, v85
    v_exp_f32 v86, v86
    v_exp_f32 v87, v87
    v_exp_f32 v88, v88
    v_exp_f32 v89, v89
    v_smfmac_f32_32x32x32_bf16 v[24:39], v[72:75], v[80:87], v112
    v_exp_f32 v90, v90
    v_exp_f32 v91, v91
    v_exp_f32 v92, v92
    v_exp_f32 v93, v93
    v_exp_f32 v94, v94
    v_exp_f32 v95, v95
    v_exp_f32 v96, v96
    v_exp_f32 v97, v97
    v_smfmac_f32_32x32x32_bf16 v[24:39], v[76:79], v[88:95], v112
    s_waitcnt lgkmcnt(0)
    v_exp_f32 v98, v98
    v_exp_f32 v99, v99
    v_exp_f32 v100, v100
    v_mfma_f32_32x32x16_bf16 v[80:95], v[56:59], v[16:19], 0
    v_exp_f32 v101, v101
    v_exp_f32 v102, v102
    v_exp_f32 v103, v103
    v_exp_f32 v104, v104
    v_exp_f32 v105, v105
    v_smfmac_f32_32x32x32_bf16 v[40:55], v[72:75], v[96:103], v112
    v_exp_f32 v106, v106
    v_exp_f32 v107, v107
    v_exp_f32 v108, v108
    v_exp_f32 v109, v109
    v_exp_f32 v110, v110
    v_exp_f32 v111, v111
    v_exp_f32 v80, v80
    v_exp_f32 v81, v81
    v_smfmac_f32_32x32x32_bf16 v[40:55], v[76:79], v[104:111], v112
    v_exp_f32 v82, v82
    v_exp_f32 v83, v83
    v_exp_f32 v84, v84
    v_mfma_f32_32x32x16_bf16 v[96:111], v[56:59], v[20:23], 0
    ds_read_b128 v[60:63], v113 offset:6240
    ds_read_b128 v[72:75], v114 offset:6240
    ds_read_b128 v[76:79], v115 offset:6240
    v_exp_f32 v85, v85
    v_exp_f32 v86, v86
    v_exp_f32 v87, v87
    v_exp_f32 v88, v88
    v_exp_f32 v89, v89
    v_smfmac_f32_32x32x32_bf16 v[24:39], v[64:67], v[80:87], v112
    v_exp_f32 v90, v90
    v_exp_f32 v91, v91
    v_exp_f32 v92, v92
    v_exp_f32 v93, v93
    v_exp_f32 v94, v94
    v_exp_f32 v95, v95
    v_exp_f32 v96, v96
    v_exp_f32 v97, v97
    v_smfmac_f32_32x32x32_bf16 v[24:39], v[68:71], v[88:95], v112
    s_waitcnt lgkmcnt(0)
    s_waitcnt vmcnt(0)
    v_cmp_gt_u32 vcc, 32, v116
    s_cbranch_vccnz L_main_kernel_aslow_20
L_main_kernel_aback_21:
    v_exp_f32 v98, v98
    v_exp_f32 v99, v99
    v_exp_f32 v100, v100
    v_mfma_f32_32x32x16_bf16 v[80:95], v[60:63], v[16:19], 0
    s_add_u32 s37, s37, 17408
    v_exp_f32 v101, v101
    v_exp_f32 v102, v102
    v_exp_f32 v103, v103
    v_exp_f32 v104, v104
    v_exp_f32 v105, v105
    v_smfmac_f32_32x32x32_bf16 v[40:55], v[64:67], v[96:103], v112
    s_cmp_ge_u32 s37, 139264
    s_cselect_b32 s37, 0, s37
    v_exp_f32 v106, v106
    v_exp_f32 v107, v107
    v_exp_f32 v108, v108
    v_exp_f32 v109, v109
    v_exp_f32 v110, v110
    v_exp_f32 v111, v111
    v_exp_f32 v80, v80
    v_exp_f32 v81, v81
    v_smfmac_f32_32x32x32_bf16 v[40:55], v[68:71], v[104:111], v112
    s_add_u32 s39, s37, s27
    s_add_u32 m0, s27, 41984
    v_exp_f32 v82, v82
    v_exp_f32 v83, v83
    v_exp_f32 v84, v84
    v_mfma_f32_32x32x16_bf16 v[96:111], v[60:63], v[20:23], 0
    ds_read_b128 v[56:59], v113 offset:8320
    ds_read_b128 v[64:67], v114 offset:8320
    ds_read_b128 v[68:71], v115 offset:8320
    v_exp_f32 v85, v85
    v_exp_f32 v86, v86
    v_exp_f32 v87, v87
    v_exp_f32 v88, v88
    v_exp_f32 v89, v89
    v_smfmac_f32_32x32x32_bf16 v[24:39], v[72:75], v[80:87], v112
    s_add_u32 s43, s39, 29216768
    buffer_load_dwordx4 v2, s[4:7], s43 offen offset:0 sc1 lds
    v_exp_f32 v90, v90
    v_exp_f32 v91, v91
    v_exp_f32 v92, v92
    v_exp_f32 v93, v93
    v_exp_f32 v94, v94
    v_exp_f32 v95, v95
    v_exp_f32 v96, v96
    v_exp_f32 v97, v97
    v_smfmac_f32_32x32x32_bf16 v[24:39], v[76:79], v[88:95], v112
    s_waitcnt lgkmcnt(0)
    buffer_load_dwordx4 v2, s[4:7], s43 offen offset:1024 sc1 lds
    v_exp_f32 v98, v98
    v_exp_f32 v99, v99
    v_exp_f32 v100, v100
    v_mfma_f32_32x32x16_bf16 v[80:95], v[56:59], v[16:19], 0
    v_exp_f32 v101, v101
    v_exp_f32 v102, v102
    v_exp_f32 v103, v103
    v_exp_f32 v104, v104
    v_exp_f32 v105, v105
    v_smfmac_f32_32x32x32_bf16 v[40:55], v[72:75], v[96:103], v112
    buffer_load_dwordx4 v2, s[4:7], s43 offen offset:2048 sc1 lds
    v_exp_f32 v106, v106
    v_exp_f32 v107, v107
    v_exp_f32 v108, v108
    v_exp_f32 v109, v109
    v_exp_f32 v110, v110
    v_exp_f32 v111, v111
    v_exp_f32 v80, v80
    v_exp_f32 v81, v81
    v_smfmac_f32_32x32x32_bf16 v[40:55], v[76:79], v[104:111], v112
    buffer_load_dwordx4 v2, s[4:7], s43 offen offset:3072 sc1 lds
    v_exp_f32 v82, v82
    v_exp_f32 v83, v83
    v_exp_f32 v84, v84
    v_mfma_f32_32x32x16_bf16 v[96:111], v[56:59], v[20:23], 0
    ds_read_b128 v[60:63], v113 offset:10400
    ds_read_b128 v[72:75], v114 offset:10400
    ds_read_b128 v[76:79], v115 offset:10400
    v_exp_f32 v85, v85
    v_exp_f32 v86, v86
    v_exp_f32 v87, v87
    v_exp_f32 v88, v88
    v_exp_f32 v89, v89
    v_smfmac_f32_32x32x32_bf16 v[24:39], v[64:67], v[80:87], v112
    s_mov_b32 m0, 58368
    s_add_u32 s43, s37, 29233152
    v_exp_f32 v90, v90
    v_exp_f32 v91, v91
    v_exp_f32 v92, v92
    v_exp_f32 v93, v93
    v_exp_f32 v94, v94
    v_exp_f32 v95, v95
    v_exp_f32 v96, v96
    v_exp_f32 v97, v97
    v_smfmac_f32_32x32x32_bf16 v[24:39], v[68:71], v[88:95], v112
    s_waitcnt lgkmcnt(0)
    buffer_load_dwordx4 v2, s[4:7], s43 offen offset:0 sc1 lds
    v_exp_f32 v98, v98
    v_exp_f32 v99, v99
    v_exp_f32 v100, v100
    v_mfma_f32_32x32x16_bf16 v[80:95], v[60:63], v[16:19], 0
    s_add_u32 s37, s37, 17408
    v_exp_f32 v101, v101
    v_exp_f32 v102, v102
    v_exp_f32 v103, v103
    v_exp_f32 v104, v104
    v_exp_f32 v105, v105
    v_smfmac_f32_32x32x32_bf16 v[40:55], v[64:67], v[96:103], v112
    s_cmp_ge_u32 s37, 139264
    s_cselect_b32 s37, 0, s37
    v_exp_f32 v106, v106
    v_exp_f32 v107, v107
    v_exp_f32 v108, v108
    v_exp_f32 v109, v109
    v_exp_f32 v110, v110
    v_exp_f32 v111, v111
    v_exp_f32 v80, v80
    v_exp_f32 v81, v81
    v_smfmac_f32_32x32x32_bf16 v[40:55], v[68:71], v[104:111], v112
    s_add_u32 s39, s37, s27
    s_add_u32 m0, s27, 59392
    v_exp_f32 v82, v82
    v_exp_f32 v83, v83
    v_exp_f32 v84, v84
    v_mfma_f32_32x32x16_bf16 v[96:111], v[60:63], v[20:23], 0
    ds_read_b128 v[56:59], v113 offset:12480
    ds_read_b128 v[64:67], v114 offset:12480
    ds_read_b128 v[68:71], v115 offset:12480
    v_exp_f32 v85, v85
    v_exp_f32 v86, v86
    v_exp_f32 v87, v87
    v_exp_f32 v88, v88
    v_exp_f32 v89, v89
    v_smfmac_f32_32x32x32_bf16 v[24:39], v[72:75], v[80:87], v112
    s_add_u32 s43, s39, 29216768
    buffer_load_dwordx4 v2, s[4:7], s43 offen offset:0 sc1 lds
    v_exp_f32 v90, v90
    v_exp_f32 v91, v91
    v_exp_f32 v92, v92
    v_exp_f32 v93, v93
    v_exp_f32 v94, v94
    v_exp_f32 v95, v95
    v_exp_f32 v96, v96
    v_exp_f32 v97, v97
    v_smfmac_f32_32x32x32_bf16 v[24:39], v[76:79], v[88:95], v112
    s_waitcnt lgkmcnt(0)
    buffer_load_dwordx4 v2, s[4:7], s43 offen offset:1024 sc1 lds
    v_exp_f32 v98, v98
    v_exp_f32 v99, v99
    v_exp_f32 v100, v100
    v_mfma_f32_32x32x16_bf16 v[80:95], v[56:59], v[16:19], 0
    v_exp_f32 v101, v101
    v_exp_f32 v102, v102
    v_exp_f32 v103, v103
    v_exp_f32 v104, v104
    v_exp_f32 v105, v105
    v_smfmac_f32_32x32x32_bf16 v[40:55], v[72:75], v[96:103], v112
    buffer_load_dwordx4 v2, s[4:7], s43 offen offset:2048 sc1 lds
    v_exp_f32 v106, v106
    v_exp_f32 v107, v107
    v_exp_f32 v108, v108
    v_exp_f32 v109, v109
    v_exp_f32 v110, v110
    v_exp_f32 v111, v111
    v_exp_f32 v80, v80
    v_exp_f32 v81, v81
    v_smfmac_f32_32x32x32_bf16 v[40:55], v[76:79], v[104:111], v112
    buffer_load_dwordx4 v2, s[4:7], s43 offen offset:3072 sc1 lds
    v_exp_f32 v82, v82
    v_exp_f32 v83, v83
    v_exp_f32 v84, v84
    v_mfma_f32_32x32x16_bf16 v[96:111], v[56:59], v[20:23], 0
    ds_read_b128 v[60:63], v113 offset:14560
    ds_read_b128 v[72:75], v114 offset:14560
    ds_read_b128 v[76:79], v115 offset:14560
    v_exp_f32 v85, v85
    v_exp_f32 v86, v86
    v_exp_f32 v87, v87
    v_exp_f32 v88, v88
    v_exp_f32 v89, v89
    v_smfmac_f32_32x32x32_bf16 v[24:39], v[64:67], v[80:87], v112
    s_mov_b32 m0, 75776
    s_add_u32 s43, s37, 29233152
    v_exp_f32 v90, v90
    v_exp_f32 v91, v91
    v_exp_f32 v92, v92
    v_exp_f32 v93, v93
    v_exp_f32 v94, v94
    v_exp_f32 v95, v95
    v_exp_f32 v96, v96
    v_exp_f32 v97, v97
    v_smfmac_f32_32x32x32_bf16 v[24:39], v[68:71], v[88:95], v112
    s_waitcnt lgkmcnt(0)
    buffer_load_dwordx4 v2, s[4:7], s43 offen offset:0 sc1 lds
    v_exp_f32 v98, v98
    v_exp_f32 v99, v99
    v_exp_f32 v100, v100
    v_mfma_f32_32x32x16_bf16 v[80:95], v[60:63], v[16:19], 0
    s_add_u32 s37, s37, 17408
    v_exp_f32 v101, v101
    v_exp_f32 v102, v102
    v_exp_f32 v103, v103
    v_exp_f32 v104, v104
    v_exp_f32 v105, v105
    v_smfmac_f32_32x32x32_bf16 v[40:55], v[64:67], v[96:103], v112
    s_cmp_ge_u32 s37, 139264
    s_cselect_b32 s37, 0, s37
    v_exp_f32 v106, v106
    v_exp_f32 v107, v107
    v_exp_f32 v108, v108
    v_exp_f32 v109, v109
    v_exp_f32 v110, v110
    v_exp_f32 v111, v111
    v_exp_f32 v80, v80
    v_exp_f32 v81, v81
    v_smfmac_f32_32x32x32_bf16 v[40:55], v[68:71], v[104:111], v112
    s_waitcnt vmcnt(5)
    s_barrier
    v_exp_f32 v82, v82
    v_exp_f32 v83, v83
    v_exp_f32 v84, v84
    v_mfma_f32_32x32x16_bf16 v[96:111], v[60:63], v[20:23], 0
    ds_read_b128 v[56:59], v113 offset:17408
    ds_read_b128 v[64:67], v114 offset:17408
    ds_read_b128 v[68:71], v115 offset:17408
    v_exp_f32 v85, v85
    v_exp_f32 v86, v86
    v_exp_f32 v87, v87
    v_exp_f32 v88, v88
    v_exp_f32 v89, v89
    v_smfmac_f32_32x32x32_bf16 v[24:39], v[72:75], v[80:87], v112
    s_add_u32 s39, s37, s27
    s_add_u32 m0, s27, 76800
    v_exp_f32 v90, v90
    v_exp_f32 v91, v91
    v_exp_f32 v92, v92
    v_exp_f32 v93, v93
    v_exp_f32 v94, v94
    v_exp_f32 v95, v95
    v_exp_f32 v96, v96
    v_exp_f32 v97, v97
    v_smfmac_f32_32x32x32_bf16 v[24:39], v[76:79], v[88:95], v112
    s_waitcnt lgkmcnt(0)
    s_add_u32 s43, s39, 29216768
    v_exp_f32 v98, v98
    v_exp_f32 v99, v99
    v_exp_f32 v100, v100
    v_mfma_f32_32x32x16_bf16 v[80:95], v[56:59], v[16:19], 0
    v_exp_f32 v101, v101
    v_exp_f32 v102, v102
    v_exp_f32 v103, v103
    v_exp_f32 v104, v104
    v_exp_f32 v105, v105
    v_smfmac_f32_32x32x32_bf16 v[40:55], v[72:75], v[96:103], v112
    buffer_load_dwordx4 v2, s[4:7], s43 offen offset:0 sc1 lds
    v_exp_f32 v106, v106
    v_exp_f32 v107, v107
    v_exp_f32 v108, v108
    v_exp_f32 v109, v109
    v_exp_f32 v110, v110
    v_exp_f32 v111, v111
    v_exp_f32 v80, v80
    v_exp_f32 v81, v81
    v_smfmac_f32_32x32x32_bf16 v[40:55], v[76:79], v[104:111], v112
    buffer_load_dwordx4 v2, s[4:7], s43 offen offset:1024 sc1 lds
    v_exp_f32 v82, v82
    v_exp_f32 v83, v83
    v_exp_f32 v84, v84
    v_mfma_f32_32x32x16_bf16 v[96:111], v[56:59], v[20:23], 0
    ds_read_b128 v[60:63], v113 offset:19488
    ds_read_b128 v[72:75], v114 offset:19488
    ds_read_b128 v[76:79], v115 offset:19488
    v_exp_f32 v85, v85
    v_exp_f32 v86, v86
    v_exp_f32 v87, v87
    v_exp_f32 v88, v88
    v_exp_f32 v89, v89
    v_smfmac_f32_32x32x32_bf16 v[24:39], v[64:67], v[80:87], v112
    buffer_load_dwordx4 v2, s[4:7], s43 offen offset:2048 sc1 lds
    v_exp_f32 v90, v90
    v_exp_f32 v91, v91
    v_exp_f32 v92, v92
    v_exp_f32 v93, v93
    v_exp_f32 v94, v94
    v_exp_f32 v95, v95
    v_exp_f32 v96, v96
    v_exp_f32 v97, v97
    v_smfmac_f32_32x32x32_bf16 v[24:39], v[68:71], v[88:95], v112
    s_waitcnt lgkmcnt(0)
    buffer_load_dwordx4 v2, s[4:7], s43 offen offset:3072 sc1 lds
    v_exp_f32 v98, v98
    v_exp_f32 v99, v99
    v_exp_f32 v100, v100
    v_mfma_f32_32x32x16_bf16 v[80:95], v[60:63], v[16:19], 0
    s_mov_b32 m0, 93184
    v_exp_f32 v101, v101
    v_exp_f32 v102, v102
    v_exp_f32 v103, v103
    v_exp_f32 v104, v104
    v_exp_f32 v105, v105
    v_smfmac_f32_32x32x32_bf16 v[40:55], v[64:67], v[96:103], v112
    s_add_u32 s43, s37, 29233152
    buffer_load_dwordx4 v2, s[4:7], s43 offen offset:0 sc1 lds
    v_exp_f32 v106, v106
    v_exp_f32 v107, v107
    v_exp_f32 v108, v108
    v_exp_f32 v109, v109
    v_exp_f32 v110, v110
    v_exp_f32 v111, v111
    v_exp_f32 v80, v80
    v_exp_f32 v81, v81
    v_smfmac_f32_32x32x32_bf16 v[40:55], v[68:71], v[104:111], v112
    s_add_u32 s37, s37, 17408
    v_exp_f32 v82, v82
    v_exp_f32 v83, v83
    v_exp_f32 v84, v84
    v_mfma_f32_32x32x16_bf16 v[96:111], v[60:63], v[20:23], 0
    ds_read_b128 v[56:59], v113 offset:21568
    ds_read_b128 v[64:67], v114 offset:21568
    ds_read_b128 v[68:71], v115 offset:21568
    v_exp_f32 v85, v85
    v_exp_f32 v86, v86
    v_exp_f32 v87, v87
    v_exp_f32 v88, v88
    v_exp_f32 v89, v89
    v_smfmac_f32_32x32x32_bf16 v[24:39], v[72:75], v[80:87], v112
    s_cmp_ge_u32 s37, 139264
    s_cselect_b32 s37, 0, s37
    v_exp_f32 v90, v90
    v_exp_f32 v91, v91
    v_exp_f32 v92, v92
    v_exp_f32 v93, v93
    v_exp_f32 v94, v94
    v_exp_f32 v95, v95
    v_exp_f32 v96, v96
    v_exp_f32 v97, v97
    v_smfmac_f32_32x32x32_bf16 v[24:39], v[76:79], v[88:95], v112
    s_waitcnt lgkmcnt(0)
    s_add_u32 s39, s37, s27
    v_exp_f32 v98, v98
    v_exp_f32 v99, v99
    v_exp_f32 v100, v100
    v_mfma_f32_32x32x16_bf16 v[80:95], v[56:59], v[16:19], 0
    s_add_u32 m0, s27, 94208
    v_exp_f32 v101, v101
    v_exp_f32 v102, v102
    v_exp_f32 v103, v103
    v_exp_f32 v104, v104
    v_exp_f32 v105, v105
    v_smfmac_f32_32x32x32_bf16 v[40:55], v[72:75], v[96:103], v112
    s_add_u32 s43, s39, 29216768
    buffer_load_dwordx4 v2, s[4:7], s43 offen offset:0 sc1 lds
    v_exp_f32 v106, v106
    v_exp_f32 v107, v107
    v_exp_f32 v108, v108
    v_exp_f32 v109, v109
    v_exp_f32 v110, v110
    v_exp_f32 v111, v111
    v_exp_f32 v80, v80
    v_exp_f32 v81, v81
    v_smfmac_f32_32x32x32_bf16 v[40:55], v[76:79], v[104:111], v112
    buffer_load_dwordx4 v2, s[4:7], s43 offen offset:1024 sc1 lds
    v_exp_f32 v82, v82
    v_exp_f32 v83, v83
    v_exp_f32 v84, v84
    v_mfma_f32_32x32x16_bf16 v[96:111], v[56:59], v[20:23], 0
    ds_read_b128 v[60:63], v113 offset:23648
    ds_read_b128 v[72:75], v114 offset:23648
    ds_read_b128 v[76:79], v115 offset:23648
    v_exp_f32 v85, v85
    v_exp_f32 v86, v86
    v_exp_f32 v87, v87
    v_exp_f32 v88, v88
    v_exp_f32 v89, v89
    v_smfmac_f32_32x32x32_bf16 v[24:39], v[64:67], v[80:87], v112
    buffer_load_dwordx4 v2, s[4:7], s43 offen offset:2048 sc1 lds
    v_exp_f32 v90, v90
    v_exp_f32 v91, v91
    v_exp_f32 v92, v92
    v_exp_f32 v93, v93
    v_exp_f32 v94, v94
    v_exp_f32 v95, v95
    v_exp_f32 v96, v96
    v_exp_f32 v97, v97
    v_smfmac_f32_32x32x32_bf16 v[24:39], v[68:71], v[88:95], v112
    s_waitcnt lgkmcnt(0)
    buffer_load_dwordx4 v2, s[4:7], s43 offen offset:3072 sc1 lds
    v_exp_f32 v98, v98
    v_exp_f32 v99, v99
    v_exp_f32 v100, v100
    v_mfma_f32_32x32x16_bf16 v[80:95], v[60:63], v[16:19], 0
    s_mov_b32 m0, 110592
    v_exp_f32 v101, v101
    v_exp_f32 v102, v102
    v_exp_f32 v103, v103
    v_exp_f32 v104, v104
    v_exp_f32 v105, v105
    v_smfmac_f32_32x32x32_bf16 v[40:55], v[64:67], v[96:103], v112
    s_add_u32 s43, s37, 29233152
    buffer_load_dwordx4 v2, s[4:7], s43 offen offset:0 sc1 lds
    v_exp_f32 v106, v106
    v_exp_f32 v107, v107
    v_exp_f32 v108, v108
    v_exp_f32 v109, v109
    v_exp_f32 v110, v110
    v_exp_f32 v111, v111
    v_exp_f32 v80, v80
    v_exp_f32 v81, v81
    v_smfmac_f32_32x32x32_bf16 v[40:55], v[68:71], v[104:111], v112
    s_add_u32 s37, s37, 17408
    v_exp_f32 v82, v82
    v_exp_f32 v83, v83
    v_exp_f32 v84, v84
    v_mfma_f32_32x32x16_bf16 v[96:111], v[60:63], v[20:23], 0
    ds_read_b128 v[56:59], v113 offset:25728
    ds_read_b128 v[64:67], v114 offset:25728
    ds_read_b128 v[68:71], v115 offset:25728
    v_exp_f32 v85, v85
    v_exp_f32 v86, v86
    v_exp_f32 v87, v87
    v_exp_f32 v88, v88
    v_exp_f32 v89, v89
    v_smfmac_f32_32x32x32_bf16 v[24:39], v[72:75], v[80:87], v112
    s_cmp_ge_u32 s37, 139264
    s_cselect_b32 s37, 0, s37
    v_exp_f32 v90, v90
    v_exp_f32 v91, v91
    v_exp_f32 v92, v92
    v_exp_f32 v93, v93
    v_exp_f32 v94, v94
    v_exp_f32 v95, v95
    v_exp_f32 v96, v96
    v_exp_f32 v97, v97
    v_smfmac_f32_32x32x32_bf16 v[24:39], v[76:79], v[88:95], v112
    s_waitcnt lgkmcnt(0)
    s_add_u32 s39, s37, s27
    v_exp_f32 v98, v98
    v_exp_f32 v99, v99
    v_exp_f32 v100, v100
    v_mfma_f32_32x32x16_bf16 v[80:95], v[56:59], v[16:19], 0
    s_add_u32 m0, s27, 111616
    v_exp_f32 v101, v101
    v_exp_f32 v102, v102
    v_exp_f32 v103, v103
    v_exp_f32 v104, v104
    v_exp_f32 v105, v105
    v_smfmac_f32_32x32x32_bf16 v[40:55], v[72:75], v[96:103], v112
    s_add_u32 s43, s39, 29216768
    buffer_load_dwordx4 v2, s[4:7], s43 offen offset:0 sc1 lds
    v_exp_f32 v106, v106
    v_exp_f32 v107, v107
    v_exp_f32 v108, v108
    v_exp_f32 v109, v109
    v_exp_f32 v110, v110
    v_exp_f32 v111, v111
    v_exp_f32 v80, v80
    v_exp_f32 v81, v81
    v_smfmac_f32_32x32x32_bf16 v[40:55], v[76:79], v[104:111], v112
    buffer_load_dwordx4 v2, s[4:7], s43 offen offset:1024 sc1 lds
    v_exp_f32 v82, v82
    v_exp_f32 v83, v83
    v_exp_f32 v84, v84
    v_mfma_f32_32x32x16_bf16 v[96:111], v[56:59], v[20:23], 0
    ds_read_b128 v[60:63], v113 offset:27808
    ds_read_b128 v[72:75], v114 offset:27808
    ds_read_b128 v[76:79], v115 offset:27808
    v_exp_f32 v85, v85
    v_exp_f32 v86, v86
    v_exp_f32 v87, v87
    v_exp_f32 v88, v88
    v_exp_f32 v89, v89
    v_smfmac_f32_32x32x32_bf16 v[24:39], v[64:67], v[80:87], v112
    buffer_load_dwordx4 v2, s[4:7], s43 offen offset:2048 sc1 lds
    v_exp_f32 v90, v90
    v_exp_f32 v91, v91
    v_exp_f32 v92, v92
    v_exp_f32 v93, v93
    v_exp_f32 v94, v94
    v_exp_f32 v95, v95
    v_exp_f32 v96, v96
    v_exp_f32 v97, v97
    v_smfmac_f32_32x32x32_bf16 v[24:39], v[68:71], v[88:95], v112
    s_waitcnt lgkmcnt(0)
    buffer_load_dwordx4 v2, s[4:7], s43 offen offset:3072 sc1 lds
    v_exp_f32 v98, v98
    v_exp_f32 v99, v99
    v_exp_f32 v100, v100
    v_mfma_f32_32x32x16_bf16 v[80:95], v[60:63], v[16:19], 0
    s_mov_b32 m0, 128000
    v_exp_f32 v101, v101
    v_exp_f32 v102, v102
    v_exp_f32 v103, v103
    v_exp_f32 v104, v104
    v_exp_f32 v105, v105
    v_smfmac_f32_32x32x32_bf16 v[40:55], v[64:67], v[96:103], v112
    s_add_u32 s43, s37, 29233152
    buffer_load_dwordx4 v2, s[4:7], s43 offen offset:0 sc1 lds
    v_exp_f32 v106, v106
    v_exp_f32 v107, v107
    v_exp_f32 v108, v108
    v_exp_f32 v109, v109
    v_exp_f32 v110, v110
    v_exp_f32 v111, v111
    v_exp_f32 v80, v80
    v_exp_f32 v81, v81
    v_smfmac_f32_32x32x32_bf16 v[40:55], v[68:71], v[104:111], v112
    s_add_u32 s37, s37, 17408
    v_exp_f32 v82, v82
    v_exp_f32 v83, v83
    v_exp_f32 v84, v84
    v_mfma_f32_32x32x16_bf16 v[96:111], v[60:63], v[20:23], 0
    ds_read_b128 v[56:59], v113 offset:29888
    ds_read_b128 v[64:67], v114 offset:29888
    ds_read_b128 v[68:71], v115 offset:29888
    v_exp_f32 v85, v85
    v_exp_f32 v86, v86
    v_exp_f32 v87, v87
    v_exp_f32 v88, v88
    v_exp_f32 v89, v89
    v_smfmac_f32_32x32x32_bf16 v[24:39], v[72:75], v[80:87], v112
    s_cmp_ge_u32 s37, 139264
    s_cselect_b32 s37, 0, s37
    v_exp_f32 v90, v90
    v_exp_f32 v91, v91
    v_exp_f32 v92, v92
    v_exp_f32 v93, v93
    v_exp_f32 v94, v94
    v_exp_f32 v95, v95
    v_exp_f32 v96, v96
    v_exp_f32 v97, v97
    v_smfmac_f32_32x32x32_bf16 v[24:39], v[76:79], v[88:95], v112
    s_waitcnt lgkmcnt(0)
    s_add_u32 s39, s37, s27
    v_exp_f32 v98, v98
    v_exp_f32 v99, v99
    v_exp_f32 v100, v100
    v_mfma_f32_32x32x16_bf16 v[80:95], v[56:59], v[16:19], 0
    s_add_u32 m0, s27, 129024
    v_exp_f32 v101, v101
    v_exp_f32 v102, v102
    v_exp_f32 v103, v103
    v_exp_f32 v104, v104
    v_exp_f32 v105, v105
    v_smfmac_f32_32x32x32_bf16 v[40:55], v[72:75], v[96:103], v112
    s_add_u32 s43, s39, 29216768
    buffer_load_dwordx4 v2, s[4:7], s43 offen offset:0 sc1 lds
    v_exp_f32 v106, v106
    v_exp_f32 v107, v107
    v_exp_f32 v108, v108
    v_exp_f32 v109, v109
    v_exp_f32 v110, v110
    v_exp_f32 v111, v111
    v_exp_f32 v80, v80
    v_exp_f32 v81, v81
    v_smfmac_f32_32x32x32_bf16 v[40:55], v[76:79], v[104:111], v112
    buffer_load_dwordx4 v2, s[4:7], s43 offen offset:1024 sc1 lds
    v_exp_f32 v82, v82
    v_exp_f32 v83, v83
    v_exp_f32 v84, v84
    v_mfma_f32_32x32x16_bf16 v[96:111], v[56:59], v[20:23], 0
    ds_read_b128 v[60:63], v113 offset:31968
    ds_read_b128 v[72:75], v114 offset:31968
    ds_read_b128 v[76:79], v115 offset:31968
    v_exp_f32 v85, v85
    v_exp_f32 v86, v86
    v_exp_f32 v87, v87
    v_exp_f32 v88, v88
    v_exp_f32 v89, v89
    v_smfmac_f32_32x32x32_bf16 v[24:39], v[64:67], v[80:87], v112
    buffer_load_dwordx4 v2, s[4:7], s43 offen offset:2048 sc1 lds
    v_exp_f32 v90, v90
    v_exp_f32 v91, v91
    v_exp_f32 v92, v92
    v_exp_f32 v93, v93
    v_exp_f32 v94, v94
    v_exp_f32 v95, v95
    v_exp_f32 v96, v96
    v_exp_f32 v97, v97
    v_smfmac_f32_32x32x32_bf16 v[24:39], v[68:71], v[88:95], v112
    s_waitcnt lgkmcnt(0)
    buffer_load_dwordx4 v2, s[4:7], s43 offen offset:3072 sc1 lds
    v_exp_f32 v98, v98
    v_exp_f32 v99, v99
    v_exp_f32 v100, v100
    v_mfma_f32_32x32x16_bf16 v[80:95], v[60:63], v[16:19], 0
    s_mov_b32 m0, 145408
    v_exp_f32 v101, v101
    v_exp_f32 v102, v102
    v_exp_f32 v103, v103
    v_exp_f32 v104, v104
    v_exp_f32 v105, v105
    v_smfmac_f32_32x32x32_bf16 v[40:55], v[64:67], v[96:103], v112
    s_add_u32 s43, s37, 29233152
    buffer_load_dwordx4 v2, s[4:7], s43 offen offset:0 sc1 lds
    v_exp_f32 v106, v106
    v_exp_f32 v107, v107
    v_exp_f32 v108, v108
    v_exp_f32 v109, v109
    v_exp_f32 v110, v110
    v_exp_f32 v111, v111
    v_exp_f32 v80, v80
    v_exp_f32 v81, v81
    v_smfmac_f32_32x32x32_bf16 v[40:55], v[68:71], v[104:111], v112
    s_waitcnt vmcnt(10)
    s_barrier
    v_exp_f32 v82, v82
    v_exp_f32 v83, v83
    v_exp_f32 v84, v84
    v_mfma_f32_32x32x16_bf16 v[96:111], v[60:63], v[20:23], 0
    ds_read_b128 v[56:59], v113 offset:34816
    ds_read_b128 v[64:67], v114 offset:34816
    ds_read_b128 v[68:71], v115 offset:34816
    v_exp_f32 v85, v85
    v_exp_f32 v86, v86
    v_exp_f32 v87, v87
    v_exp_f32 v88, v88
    v_exp_f32 v89, v89
    v_smfmac_f32_32x32x32_bf16 v[24:39], v[72:75], v[80:87], v112
    s_add_u32 s37, s37, 17408
    v_exp_f32 v90, v90
    v_exp_f32 v91, v91
    v_exp_f32 v92, v92
    v_exp_f32 v93, v93
    v_exp_f32 v94, v94
    v_exp_f32 v95, v95
    v_exp_f32 v96, v96
    v_exp_f32 v97, v97
    v_smfmac_f32_32x32x32_bf16 v[24:39], v[76:79], v[88:95], v112
    s_waitcnt lgkmcnt(0)
    v_exp_f32 v98, v98
    v_exp_f32 v99, v99
    v_exp_f32 v100, v100
    v_mfma_f32_32x32x16_bf16 v[80:95], v[56:59], v[16:19], 0
    v_exp_f32 v101, v101
    v_exp_f32 v102, v102
    v_exp_f32 v103, v103
    v_exp_f32 v104, v104
    v_exp_f32 v105, v105
    v_smfmac_f32_32x32x32_bf16 v[40:55], v[72:75], v[96:103], v112
    s_cmp_ge_u32 s37, 139264
    s_cselect_b32 s37, 0, s37
    v_exp_f32 v106, v106
    v_exp_f32 v107, v107
    v_exp_f32 v108, v108
    v_exp_f32 v109, v109
    v_exp_f32 v110, v110
    v_exp_f32 v111, v111
    v_exp_f32 v80, v80
    v_exp_f32 v81, v81
    v_smfmac_f32_32x32x32_bf16 v[40:55], v[76:79], v[104:111], v112
    s_add_u32 s39, s37, s27
    s_add_u32 m0, s27, 146432
    v_exp_f32 v82, v82
    v_exp_f32 v83, v83
    v_exp_f32 v84, v84
    v_mfma_f32_32x32x16_bf16 v[96:111], v[56:59], v[20:23], 0
    ds_read_b128 v[60:63], v113 offset:36896
    ds_read_b128 v[72:75], v114 offset:36896
    ds_read_b128 v[76:79], v115 offset:36896
    v_exp_f32 v85, v85
    v_exp_f32 v86, v86
    v_exp_f32 v87, v87
    v_exp_f32 v88, v88
    v_exp_f32 v89, v89
    v_smfmac_f32_32x32x32_bf16 v[24:39], v[64:67], v[80:87], v112
    s_add_u32 s43, s39, 29216768
    buffer_load_dwordx4 v2, s[4:7], s43 offen offset:0 sc1 lds
    v_exp_f32 v90, v90
    v_exp_f32 v91, v91
    v_exp_f32 v92, v92
    v_exp_f32 v93, v93
    v_exp_f32 v94, v94
    v_exp_f32 v95, v95
    v_exp_f32 v96, v96
    v_exp_f32 v97, v97
    v_smfmac_f32_32x32x32_bf16 v[24:39], v[68:71], v[88:95], v112
    s_waitcnt lgkmcnt(0)
    buffer_load_dwordx4 v2, s[4:7], s43 offen offset:1024 sc1 lds
    v_exp_f32 v98, v98
    v_exp_f32 v99, v99
    v_exp_f32 v100, v100
    v_mfma_f32_32x32x16_bf16 v[80:95], v[60:63], v[16:19], 0
    v_exp_f32 v101, v101
    v_exp_f32 v102, v102
    v_exp_f32 v103, v103
    v_exp_f32 v104, v104
    v_exp_f32 v105, v105
    v_smfmac_f32_32x32x32_bf16 v[40:55], v[64:67], v[96:103], v112
    buffer_load_dwordx4 v2, s[4:7], s43 offen offset:2048 sc1 lds
    v_exp_f32 v106, v106
    v_exp_f32 v107, v107
    v_exp_f32 v108, v108
    v_exp_f32 v109, v109
    v_exp_f32 v110, v110
    v_exp_f32 v111, v111
    v_exp_f32 v80, v80
    v_exp_f32 v81, v81
    v_smfmac_f32_32x32x32_bf16 v[40:55], v[68:71], v[104:111], v112
    buffer_load_dwordx4 v2, s[4:7], s43 offen offset:3072 sc1 lds
    v_exp_f32 v82, v82
    v_exp_f32 v83, v83
    v_exp_f32 v84, v84
    v_mfma_f32_32x32x16_bf16 v[96:111], v[60:63], v[20:23], 0
    ds_read_b128 v[56:59], v113 offset:38976
    ds_read_b128 v[64:67], v114 offset:38976
    ds_read_b128 v[68:71], v115 offset:38976
    v_exp_f32 v85, v85
    v_exp_f32 v86, v86
    v_exp_f32 v87, v87
    v_exp_f32 v88, v88
    v_exp_f32 v89, v89
    v_smfmac_f32_32x32x32_bf16 v[24:39], v[72:75], v[80:87], v112
    s_mov_b32 m0, 162816
    s_add_u32 s43, s37, 29233152
    v_exp_f32 v90, v90
    v_exp_f32 v91, v91
    v_exp_f32 v92, v92
    v_exp_f32 v93, v93
    v_exp_f32 v94, v94
    v_exp_f32 v95, v95
    v_exp_f32 v96, v96
    v_exp_f32 v97, v97
    v_smfmac_f32_32x32x32_bf16 v[24:39], v[76:79], v[88:95], v112
    s_waitcnt lgkmcnt(0)
    buffer_load_dwordx4 v2, s[4:7], s43 offen offset:0 sc1 lds
    v_exp_f32 v98, v98
    v_exp_f32 v99, v99
    v_exp_f32 v100, v100
    v_mfma_f32_32x32x16_bf16 v[80:95], v[56:59], v[16:19], 0
    s_add_u32 m0, s26, 0
    v_exp_f32 v101, v101
    v_exp_f32 v102, v102
    v_exp_f32 v103, v103
    v_exp_f32 v104, v104
    v_exp_f32 v105, v105
    v_smfmac_f32_32x32x32_bf16 v[40:55], v[72:75], v[96:103], v112
    s_add_u32 s43, s25, 1081344
    buffer_load_dwordx4 v2, s[4:7], s43 offen offset:0  lds
    v_exp_f32 v106, v106
    v_exp_f32 v107, v107
    v_exp_f32 v108, v108
    v_exp_f32 v109, v109
    v_exp_f32 v110, v110
    v_exp_f32 v111, v111
    v_exp_f32 v80, v80
    v_exp_f32 v81, v81
    v_smfmac_f32_32x32x32_bf16 v[40:55], v[76:79], v[104:111], v112
    buffer_load_dwordx4 v2, s[4:7], s43 offen offset:1024  lds
    v_exp_f32 v82, v82
    v_exp_f32 v83, v83
    v_exp_f32 v84, v84
    v_mfma_f32_32x32x16_bf16 v[96:111], v[56:59], v[20:23], 0
    ds_read_b128 v[60:63], v113 offset:41056
    ds_read_b128 v[72:75], v114 offset:41056
    ds_read_b128 v[76:79], v115 offset:41056
    v_exp_f32 v85, v85
    v_exp_f32 v86, v86
    v_exp_f32 v87, v87
    v_exp_f32 v88, v88
    v_exp_f32 v89, v89
    v_smfmac_f32_32x32x32_bf16 v[24:39], v[64:67], v[80:87], v112
    buffer_load_dwordx4 v2, s[4:7], s43 offen offset:2048  lds
    v_exp_f32 v90, v90
    v_exp_f32 v91, v91
    v_exp_f32 v92, v92
    v_exp_f32 v93, v93
    v_exp_f32 v94, v94
    v_exp_f32 v95, v95
    v_exp_f32 v96, v96
    v_exp_f32 v97, v97
    v_smfmac_f32_32x32x32_bf16 v[24:39], v[68:71], v[88:95], v112
    s_waitcnt lgkmcnt(0)
    buffer_load_dwordx4 v2, s[4:7], s43 offen offset:3072  lds
    v_exp_f32 v98, v98
    v_exp_f32 v99, v99
    v_exp_f32 v100, v100
    v_mfma_f32_32x32x16_bf16 v[80:95], v[60:63], v[16:19], 0
    s_add_u32 m0, s26, 4096
    v_exp_f32 v101, v101
    v_exp_f32 v102, v102
    v_exp_f32 v103, v103
    v_exp_f32 v104, v104
    v_exp_f32 v105, v105
    v_smfmac_f32_32x32x32_bf16 v[40:55], v[64:67], v[96:103], v112
    s_add_u32 s43, s25, 1085440
    buffer_load_dwordx4 v2, s[4:7], s43 offen offset:0  lds
    v_exp_f32 v106, v106
    v_exp_f32 v107, v107
    v_exp_f32 v108, v108
    v_exp_f32 v109, v109
    v_exp_f32 v110, v110
    v_exp_f32 v111, v111
    v_exp_f32 v80, v80
    v_exp_f32 v81, v81
    v_smfmac_f32_32x32x32_bf16 v[40:55], v[68:71], v[104:111], v112
    buffer_load_dwordx4 v2, s[4:7], s43 offen offset:1024  lds
    v_exp_f32 v82, v82
    v_exp_f32 v83, v83
    v_exp_f32 v84, v84
    v_mfma_f32_32x32x16_bf16 v[96:111], v[60:63], v[20:23], 0
    ds_read_b128 v[56:59], v113 offset:43136
    ds_read_b128 v[64:67], v114 offset:43136
    ds_read_b128 v[68:71], v115 offset:43136
    v_exp_f32 v85, v85
    v_exp_f32 v86, v86
    v_exp_f32 v87, v87
    v_exp_f32 v88, v88
    v_exp_f32 v89, v89
    v_smfmac_f32_32x32x32_bf16 v[24:39], v[72:75], v[80:87], v112
    buffer_load_dwordx4 v2, s[4:7], s43 offen offset:2048  lds
    v_exp_f32 v90, v90
    v_exp_f32 v91, v91
    v_exp_f32 v92, v92
    v_exp_f32 v93, v93
    v_exp_f32 v94, v94
    v_exp_f32 v95, v95
    v_exp_f32 v96, v96
    v_exp_f32 v97, v97
    v_smfmac_f32_32x32x32_bf16 v[24:39], v[76:79], v[88:95], v112
    s_waitcnt lgkmcnt(0)
    buffer_load_dwordx4 v2, s[4:7], s43 offen offset:3072  lds
    v_exp_f32 v98, v98
    v_exp_f32 v99, v99
    v_exp_f32 v100, v100
    v_mfma_f32_32x32x16_bf16 v[80:95], v[56:59], v[16:19], 0
    s_add_u32 s38, s23, 557056
    v_exp_f32 v101, v101
    v_exp_f32 v102, v102
    v_exp_f32 v103, v103
    v_exp_f32 v104, v104
    v_exp_f32 v105, v105
    v_smfmac_f32_32x32x32_bf16 v[40:55], v[72:75], v[96:103], v112
    buffer_load_dwordx4 a[0:3], v2, s[4:7], s38 offen offset:0
    v_exp_f32 v106, v106
    v_exp_f32 v107, v107
    v_exp_f32 v108, v108
    v_exp_f32 v109, v109
    v_exp_f32 v110, v110
    v_exp_f32 v111, v111
    v_exp_f32 v80, v80
    v_exp_f32 v81, v81
    v_smfmac_f32_32x32x32_bf16 v[40:55], v[76:79], v[104:111], v112
    buffer_load_dwordx4 a[4:7], v2, s[4:7], s38 offen offset:1024
    v_exp_f32 v82, v82
    v_exp_f32 v83, v83
    v_exp_f32 v84, v84
    v_mfma_f32_32x32x16_bf16 v[96:111], v[56:59], v[20:23], 0
    ds_read_b128 v[60:63], v113 offset:45216
    ds_read_b128 v[72:75], v114 offset:45216
    ds_read_b128 v[76:79], v115 offset:45216
    v_exp_f32 v85, v85
    v_exp_f32 v86, v86
    v_exp_f32 v87, v87
    v_exp_f32 v88, v88
    v_exp_f32 v89, v89
    v_smfmac_f32_32x32x32_bf16 v[24:39], v[64:67], v[80:87], v112
    buffer_load_dwordx4 a[8:11], v2, s[4:7], s38 offen offset:2048
    v_exp_f32 v90, v90
    v_exp_f32 v91, v91
    v_exp_f32 v92, v92
    v_exp_f32 v93, v93
    v_exp_f32 v94, v94
    v_exp_f32 v95, v95
    v_exp_f32 v96, v96
    v_exp_f32 v97, v97
    v_smfmac_f32_32x32x32_bf16 v[24:39], v[68:71], v[88:95], v112
    s_waitcnt lgkmcnt(0)
    buffer_load_dwordx4 a[12:15], v2, s[4:7], s38 offen offset:3072
    v_exp_f32 v98, v98
    v_exp_f32 v99, v99
    v_exp_f32 v100, v100
    v_mfma_f32_32x32x16_bf16 v[80:95], v[60:63], v[16:19], 0
    s_add_u32 s38, s23, 561152
    v_exp_f32 v101, v101
    v_exp_f32 v102, v102
    v_exp_f32 v103, v103
    v_exp_f32 v104, v104
    v_exp_f32 v105, v105
    v_smfmac_f32_32x32x32_bf16 v[40:55], v[64:67], v[96:103], v112
    buffer_load_dwordx4 a[16:19], v2, s[4:7], s38 offen offset:0
    v_exp_f32 v106, v106
    v_exp_f32 v107, v107
    v_exp_f32 v108, v108
    v_exp_f32 v109, v109
    v_exp_f32 v110, v110
    v_exp_f32 v111, v111
    v_exp_f32 v80, v80
    v_exp_f32 v81, v81
    v_smfmac_f32_32x32x32_bf16 v[40:55], v[68:71], v[104:111], v112
    buffer_load_dwordx4 a[20:23], v2, s[4:7], s38 offen offset:1024
    v_exp_f32 v82, v82
    v_exp_f32 v83, v83
    v_exp_f32 v84, v84
    v_mfma_f32_32x32x16_bf16 v[96:111], v[60:63], v[20:23], 0
    ds_read_b128 v[56:59], v113 offset:47296
    ds_read_b128 v[64:67], v114 offset:47296
    ds_read_b128 v[68:71], v115 offset:47296
    v_exp_f32 v85, v85
    v_exp_f32 v86, v86
    v_exp_f32 v87, v87
    v_exp_f32 v88, v88
    v_exp_f32 v89, v89
    v_smfmac_f32_32x32x32_bf16 v[24:39], v[72:75], v[80:87], v112
    buffer_load_dwordx4 a[24:27], v2, s[4:7], s38 offen offset:2048
    v_exp_f32 v90, v90
    v_exp_f32 v91, v91
    v_exp_f32 v92, v92
    v_exp_f32 v93, v93
    v_exp_f32 v94, v94
    v_exp_f32 v95, v95
    v_exp_f32 v96, v96
    v_exp_f32 v97, v97
    v_smfmac_f32_32x32x32_bf16 v[24:39], v[76:79], v[88:95], v112
    s_waitcnt lgkmcnt(0)
    buffer_load_dwordx4 a[28:31], v2, s[4:7], s38 offen offset:3072
    v_exp_f32 v98, v98
    v_exp_f32 v99, v99
    v_exp_f32 v100, v100
    v_mfma_f32_32x32x16_bf16 v[80:95], v[56:59], v[16:19], 0
    v_exp_f32 v101, v101
    v_exp_f32 v102, v102
    v_exp_f32 v103, v103
    v_exp_f32 v104, v104
    v_exp_f32 v105, v105
    v_smfmac_f32_32x32x32_bf16 v[40:55], v[72:75], v[96:103], v112
    v_exp_f32 v106, v106
    v_exp_f32 v107, v107
    v_exp_f32 v108, v108
    v_exp_f32 v109, v109
    v_exp_f32 v110, v110
    v_exp_f32 v111, v111
    v_exp_f32 v80, v80
    v_exp_f32 v81, v81
    v_smfmac_f32_32x32x32_bf16 v[40:55], v[76:79], v[104:111], v112
    s_add_u32 s38, s23, 565248
    buffer_load_dwordx4 a[32:35], v2, s[4:7], s38 offen offset:0
    v_exp_f32 v82, v82
    v_exp_f32 v83, v83
    v_exp_f32 v84, v84
    v_mfma_f32_32x32x16_bf16 v[96:111], v[56:59], v[20:23], 0
    ds_read_b128 v[60:63], v113 offset:49376
    ds_read_b128 v[72:75], v114 offset:49376
    ds_read_b128 v[76:79], v115 offset:49376
    v_exp_f32 v85, v85
    v_exp_f32 v86, v86
    v_exp_f32 v87, v87
    v_exp_f32 v88, v88
    v_exp_f32 v89, v89
    v_smfmac_f32_32x32x32_bf16 v[24:39], v[64:67], v[80:87], v112
    v_exp_f32 v90, v90
    v_exp_f32 v91, v91
    v_exp_f32 v92, v92
    v_exp_f32 v93, v93
    v_exp_f32 v94, v94
    v_exp_f32 v95, v95
    v_exp_f32 v96, v96
    v_exp_f32 v97, v97
    v_smfmac_f32_32x32x32_bf16 v[24:39], v[68:71], v[88:95], v112
    s_waitcnt lgkmcnt(0)
    buffer_load_dwordx4 a[36:39], v2, s[4:7], s38 offen offset:1024
    v_exp_f32 v98, v98
    v_exp_f32 v99, v99
    v_exp_f32 v100, v100
    v_mfma_f32_32x32x16_bf16 v[80:95], v[60:63], v[16:19], 0
    v_exp_f32 v101, v101
    v_exp_f32 v102, v102
    v_exp_f32 v103, v103
    v_exp_f32 v104, v104
    v_exp_f32 v105, v105
    v_smfmac_f32_32x32x32_bf16 v[40:55], v[64:67], v[96:103], v112
    v_exp_f32 v106, v106
    v_exp_f32 v107, v107
    v_exp_f32 v108, v108
    v_exp_f32 v109, v109
    v_exp_f32 v110, v110
    v_exp_f32 v111, v111
    v_exp_f32 v80, v80
    v_exp_f32 v81, v81
    v_smfmac_f32_32x32x32_bf16 v[40:55], v[68:71], v[104:111], v112
    buffer_load_dwordx4 a[40:43], v2, s[4:7], s38 offen offset:2048
    v_exp_f32 v82, v82
    v_exp_f32 v83, v83
    v_exp_f32 v84, v84
    v_mfma_f32_32x32x16_bf16 v[96:111], v[60:63], v[20:23], 0
    ds_read_b128 v[56:59], v113 offset:52224
    ds_read_b128 v[64:67], v114 offset:52224
    ds_read_b128 v[68:71], v115 offset:52224
    v_exp_f32 v85, v85
    v_exp_f32 v86, v86
    v_exp_f32 v87, v87
    v_exp_f32 v88, v88
    v_exp_f32 v89, v89
    v_smfmac_f32_32x32x32_bf16 v[24:39], v[72:75], v[80:87], v112
    v_exp_f32 v90, v90
    v_exp_f32 v91, v91
    v_exp_f32 v92, v92
    v_exp_f32 v93, v93
    v_exp_f32 v94, v94
    v_exp_f32 v95, v95
    v_exp_f32 v96, v96
    v_exp_f32 v97, v97
    v_smfmac_f32_32x32x32_bf16 v[24:39], v[76:79], v[88:95], v112
    s_waitcnt lgkmcnt(0)
    buffer_load_dwordx4 a[44:47], v2, s[4:7], s38 offen offset:3072
    v_exp_f32 v98, v98
    v_exp_f32 v99, v99
    v_exp_f32 v100, v100
    v_mfma_f32_32x32x16_bf16 v[80:95], v[56:59], v[16:19], 0
    v_exp_f32 v101, v101
    v_exp_f32 v102, v102
    v_exp_f32 v103, v103
    v_exp_f32 v104, v104
    v_exp_f32 v105, v105
    v_smfmac_f32_32x32x32_bf16 v[40:55], v[72:75], v[96:103], v112
    v_exp_f32 v106, v106
    v_exp_f32 v107, v107
    v_exp_f32 v108, v108
    v_exp_f32 v109, v109
    v_exp_f32 v110, v110
    v_exp_f32 v111, v111
    v_exp_f32 v80, v80
    v_exp_f32 v81, v81
    v_smfmac_f32_32x32x32_bf16 v[40:55], v[76:79], v[104:111], v112
    s_add_u32 s38, s23, 569344
    buffer_load_dwordx4 a[48:51], v2, s[4:7], s38 offen offset:0
    v_exp_f32 v82, v82
    v_exp_f32 v83, v83
    v_exp_f32 v84, v84
    v_mfma_f32_32x32x16_bf16 v[96:111], v[56:59], v[20:23], 0
    ds_read_b128 v[60:63], v113 offset:54304
    ds_read_b128 v[72:75], v114 offset:54304
    ds_read_b128 v[76:79], v115 offset:54304
    v_exp_f32 v85, v85
    v_exp_f32 v86, v86
    v_exp_f32 v87, v87
    v_exp_f32 v88, v88
    v_exp_f32 v89, v89
    v_smfmac_f32_32x32x32_bf16 v[24:39], v[64:67], v[80:87], v112
    v_exp_f32 v90, v90
    v_exp_f32 v91, v91
    v_exp_f32 v92, v92
    v_exp_f32 v93, v93
    v_exp_f32 v94, v94
    v_exp_f32 v95, v95
    v_exp_f32 v96, v96
    v_exp_f32 v97, v97
    v_smfmac_f32_32x32x32_bf16 v[24:39], v[68:71], v[88:95], v112
    s_waitcnt lgkmcnt(0)
    buffer_load_dwordx4 a[52:55], v2, s[4:7], s38 offen offset:1024
    v_exp_f32 v98, v98
    v_exp_f32 v99, v99
    v_exp_f32 v100, v100
    v_mfma_f32_32x32x16_bf16 v[80:95], v[60:63], v[16:19], 0
    v_exp_f32 v101, v101
    v_exp_f32 v102, v102
    v_exp_f32 v103, v103
    v_exp_f32 v104, v104
    v_exp_f32 v105, v105
    v_smfmac_f32_32x32x32_bf16 v[40:55], v[64:67], v[96:103], v112
    v_exp_f32 v106, v106
    v_exp_f32 v107, v107
    v_exp_f32 v108, v108
    v_exp_f32 v109, v109
    v_exp_f32 v110, v110
    v_exp_f32 v111, v111
    v_exp_f32 v80, v80
    v_exp_f32 v81, v81
    v_smfmac_f32_32x32x32_bf16 v[40:55], v[68:71], v[104:111], v112
    buffer_load_dwordx4 a[56:59], v2, s[4:7], s38 offen offset:2048
    v_exp_f32 v82, v82
    v_exp_f32 v83, v83
    v_exp_f32 v84, v84
    v_mfma_f32_32x32x16_bf16 v[96:111], v[60:63], v[20:23], 0
    ds_read_b128 v[56:59], v113 offset:56384
    ds_read_b128 v[64:67], v114 offset:56384
    ds_read_b128 v[68:71], v115 offset:56384
    v_exp_f32 v85, v85
    v_exp_f32 v86, v86
    v_exp_f32 v87, v87
    v_exp_f32 v88, v88
    v_exp_f32 v89, v89
    v_smfmac_f32_32x32x32_bf16 v[24:39], v[72:75], v[80:87], v112
    v_exp_f32 v90, v90
    v_exp_f32 v91, v91
    v_exp_f32 v92, v92
    v_exp_f32 v93, v93
    v_exp_f32 v94, v94
    v_exp_f32 v95, v95
    v_exp_f32 v96, v96
    v_exp_f32 v97, v97
    v_smfmac_f32_32x32x32_bf16 v[24:39], v[76:79], v[88:95], v112
    s_waitcnt lgkmcnt(0)
    buffer_load_dwordx4 a[60:63], v2, s[4:7], s38 offen offset:3072
    v_exp_f32 v98, v98
    v_exp_f32 v99, v99
    v_exp_f32 v100, v100
    v_mfma_f32_32x32x16_bf16 v[80:95], v[56:59], v[16:19], 0
    v_exp_f32 v101, v101
    v_exp_f32 v102, v102
    v_exp_f32 v103, v103
    v_exp_f32 v104, v104
    v_exp_f32 v105, v105
    v_smfmac_f32_32x32x32_bf16 v[40:55], v[72:75], v[96:103], v112
    v_exp_f32 v106, v106
    v_exp_f32 v107, v107
    v_exp_f32 v108, v108
    v_exp_f32 v109, v109
    v_exp_f32 v110, v110
    v_exp_f32 v111, v111
    v_exp_f32 v80, v80
    v_exp_f32 v81, v81
    v_smfmac_f32_32x32x32_bf16 v[40:55], v[76:79], v[104:111], v112
    s_add_u32 s38, s23, 573440
    buffer_load_dwordx4 a[64:67], v2, s[4:7], s38 offen offset:0
    v_exp_f32 v82, v82
    v_exp_f32 v83, v83
    v_exp_f32 v84, v84
    v_mfma_f32_32x32x16_bf16 v[96:111], v[56:59], v[20:23], 0
    ds_read_b128 v[60:63], v113 offset:58464
    ds_read_b128 v[72:75], v114 offset:58464
    ds_read_b128 v[76:79], v115 offset:58464
    v_exp_f32 v85, v85
    v_exp_f32 v86, v86
    v_exp_f32 v87, v87
    v_exp_f32 v88, v88
    v_exp_f32 v89, v89
    v_smfmac_f32_32x32x32_bf16 v[24:39], v[64:67], v[80:87], v112
    v_exp_f32 v90, v90
    v_exp_f32 v91, v91
    v_exp_f32 v92, v92
    v_exp_f32 v93, v93
    v_exp_f32 v94, v94
    v_exp_f32 v95, v95
    v_exp_f32 v96, v96
    v_exp_f32 v97, v97
    v_smfmac_f32_32x32x32_bf16 v[24:39], v[68:71], v[88:95], v112
    s_waitcnt lgkmcnt(0)
    buffer_load_dwordx4 a[68:71], v2, s[4:7], s38 offen offset:1024
    v_exp_f32 v98, v98
    v_exp_f32 v99, v99
    v_exp_f32 v100, v100
    v_mfma_f32_32x32x16_bf16 v[80:95], v[60:63], v[16:19], 0
    v_exp_f32 v101, v101
    v_exp_f32 v102, v102
    v_exp_f32 v103, v103
    v_exp_f32 v104, v104
    v_exp_f32 v105, v105
    v_smfmac_f32_32x32x32_bf16 v[40:55], v[64:67], v[96:103], v112
    v_exp_f32 v106, v106
    v_exp_f32 v107, v107
    v_exp_f32 v108, v108
    v_exp_f32 v109, v109
    v_exp_f32 v110, v110
    v_exp_f32 v111, v111
    v_exp_f32 v80, v80
    v_exp_f32 v81, v81
    v_smfmac_f32_32x32x32_bf16 v[40:55], v[68:71], v[104:111], v112
    buffer_load_dwordx4 a[72:75], v2, s[4:7], s38 offen offset:2048
    v_exp_f32 v82, v82
    v_exp_f32 v83, v83
    v_exp_f32 v84, v84
    v_mfma_f32_32x32x16_bf16 v[96:111], v[60:63], v[20:23], 0
    ds_read_b128 v[56:59], v113 offset:60544
    ds_read_b128 v[64:67], v114 offset:60544
    ds_read_b128 v[68:71], v115 offset:60544
    v_exp_f32 v85, v85
    v_exp_f32 v86, v86
    v_exp_f32 v87, v87
    v_exp_f32 v88, v88
    v_exp_f32 v89, v89
    v_smfmac_f32_32x32x32_bf16 v[24:39], v[72:75], v[80:87], v112
    v_exp_f32 v90, v90
    v_exp_f32 v91, v91
    v_exp_f32 v92, v92
    v_exp_f32 v93, v93
    v_exp_f32 v94, v94
    v_exp_f32 v95, v95
    v_exp_f32 v96, v96
    v_exp_f32 v97, v97
    v_smfmac_f32_32x32x32_bf16 v[24:39], v[76:79], v[88:95], v112
    s_waitcnt lgkmcnt(0)
    buffer_load_dwordx4 a[76:79], v2, s[4:7], s38 offen offset:3072
    v_exp_f32 v98, v98
    v_exp_f32 v99, v99
    v_exp_f32 v100, v100
    v_mfma_f32_32x32x16_bf16 v[80:95], v[56:59], v[16:19], 0
    v_exp_f32 v101, v101
    v_exp_f32 v102, v102
    v_exp_f32 v103, v103
    v_exp_f32 v104, v104
    v_exp_f32 v105, v105
    v_smfmac_f32_32x32x32_bf16 v[40:55], v[72:75], v[96:103], v112
    v_exp_f32 v106, v106
    v_exp_f32 v107, v107
    v_exp_f32 v108, v108
    v_exp_f32 v109, v109
    v_exp_f32 v110, v110
    v_exp_f32 v111, v111
    v_exp_f32 v80, v80
    v_exp_f32 v81, v81
    v_smfmac_f32_32x32x32_bf16 v[40:55], v[76:79], v[104:111], v112
    s_add_u32 s38, s23, 577536
    buffer_load_dwordx4 a[80:83], v2, s[4:7], s38 offen offset:0
    v_exp_f32 v82, v82
    v_exp_f32 v83, v83
    v_exp_f32 v84, v84
    v_mfma_f32_32x32x16_bf16 v[96:111], v[56:59], v[20:23], 0
    ds_read_b128 v[60:63], v113 offset:62624
    ds_read_b128 v[72:75], v114 offset:62624
    ds_read_b128 v[76:79], v115 offset:62624
    v_exp_f32 v85, v85
    v_exp_f32 v86, v86
    v_exp_f32 v87, v87
    v_exp_f32 v88, v88
    v_exp_f32 v89, v89
    v_smfmac_f32_32x32x32_bf16 v[24:39], v[64:67], v[80:87], v112
    v_exp_f32 v90, v90
    v_exp_f32 v91, v91
    v_exp_f32 v92, v92
    v_exp_f32 v93, v93
    v_exp_f32 v94, v94
    v_exp_f32 v95, v95
    v_exp_f32 v96, v96
    v_exp_f32 v97, v97
    v_smfmac_f32_32x32x32_bf16 v[24:39], v[68:71], v[88:95], v112
    s_waitcnt lgkmcnt(0)
    buffer_load_dwordx4 a[84:87], v2, s[4:7], s38 offen offset:1024
    v_exp_f32 v98, v98
    v_exp_f32 v99, v99
    v_exp_f32 v100, v100
    v_mfma_f32_32x32x16_bf16 v[80:95], v[60:63], v[16:19], 0
    v_exp_f32 v101, v101
    v_exp_f32 v102, v102
    v_exp_f32 v103, v103
    v_exp_f32 v104, v104
    v_exp_f32 v105, v105
    v_smfmac_f32_32x32x32_bf16 v[40:55], v[64:67], v[96:103], v112
    v_exp_f32 v106, v106
    v_exp_f32 v107, v107
    v_exp_f32 v108, v108
    v_exp_f32 v109, v109
    v_exp_f32 v110, v110
    v_exp_f32 v111, v111
    v_exp_f32 v80, v80
    v_exp_f32 v81, v81
    v_smfmac_f32_32x32x32_bf16 v[40:55], v[68:71], v[104:111], v112
    buffer_load_dwordx4 a[88:91], v2, s[4:7], s38 offen offset:2048
    v_exp_f32 v82, v82
    v_exp_f32 v83, v83
    v_exp_f32 v84, v84
    v_mfma_f32_32x32x16_bf16 v[96:111], v[60:63], v[20:23], 0
    ds_read_b128 v[56:59], v113 offset:64704
    ds_read_b128 v[64:67], v114 offset:64704
    ds_read_b128 v[68:71], v115 offset:64704
    v_exp_f32 v85, v85
    v_exp_f32 v86, v86
    v_exp_f32 v87, v87
    v_exp_f32 v88, v88
    v_exp_f32 v89, v89
    v_smfmac_f32_32x32x32_bf16 v[24:39], v[72:75], v[80:87], v112
    v_exp_f32 v90, v90
    v_exp_f32 v91, v91
    v_exp_f32 v92, v92
    v_exp_f32 v93, v93
    v_exp_f32 v94, v94
    v_exp_f32 v95, v95
    v_exp_f32 v96, v96
    v_exp_f32 v97, v97
    v_smfmac_f32_32x32x32_bf16 v[24:39], v[76:79], v[88:95], v112
    s_waitcnt lgkmcnt(0)
    buffer_load_dwordx4 a[92:95], v2, s[4:7], s38 offen offset:3072
    v_exp_f32 v98, v98
    v_exp_f32 v99, v99
    v_exp_f32 v100, v100
    v_mfma_f32_32x32x16_bf16 v[80:95], v[56:59], v[16:19], 0
    v_exp_f32 v101, v101
    v_exp_f32 v102, v102
    v_exp_f32 v103, v103
    v_exp_f32 v104, v104
    v_exp_f32 v105, v105
    v_smfmac_f32_32x32x32_bf16 v[40:55], v[72:75], v[96:103], v112
    v_exp_f32 v106, v106
    v_exp_f32 v107, v107
    v_exp_f32 v108, v108
    v_exp_f32 v109, v109
    v_exp_f32 v110, v110
    v_exp_f32 v111, v111
    v_exp_f32 v80, v80
    v_exp_f32 v81, v81
    v_smfmac_f32_32x32x32_bf16 v[40:55], v[76:79], v[104:111], v112
    s_add_u32 s38, s23, 581632
    buffer_load_dwordx4 a[96:99], v2, s[4:7], s38 offen offset:0
    v_exp_f32 v82, v82
    v_exp_f32 v83, v83
    v_exp_f32 v84, v84
    v_mfma_f32_32x32x16_bf16 v[96:111], v[56:59], v[20:23], 0
    v_add_u32 v113, 66784, v113
    v_add_u32 v114, 66784, v114
    v_add_u32 v115, 66784, v115
    ds_read_b128 v[60:63], v113 offset:0
    ds_read_b128 v[72:75], v114 offset:0
    ds_read_b128 v[76:79], v115 offset:0
    v_exp_f32 v85, v85
    v_exp_f32 v86, v86
    v_exp_f32 v87, v87
    v_exp_f32 v88, v88
    v_exp_f32 v89, v89
    v_smfmac_f32_32x32x32_bf16 v[24:39], v[64:67], v[80:87], v112
    v_exp_f32 v90, v90
    v_exp_f32 v91, v91
    v_exp_f32 v92, v92
    v_exp_f32 v93, v93
    v_exp_f32 v94, v94
    v_exp_f32 v95, v95
    v_exp_f32 v96, v96
    v_exp_f32 v97, v97
    v_smfmac_f32_32x32x32_bf16 v[24:39], v[68:71], v[88:95], v112
    s_waitcnt lgkmcnt(0)
    buffer_load_dwordx4 a[100:103], v2, s[4:7], s38 offen offset:1024
    v_exp_f32 v98, v98
    v_exp_f32 v99, v99
    v_exp_f32 v100, v100
    v_mfma_f32_32x32x16_bf16 v[80:95], v[60:63], v[16:19], 0
    v_exp_f32 v101, v101
    v_exp_f32 v102, v102
    v_exp_f32 v103, v103
    v_exp_f32 v104, v104
    v_exp_f32 v105, v105
    v_smfmac_f32_32x32x32_bf16 v[40:55], v[64:67], v[96:103], v112
    v_exp_f32 v106, v106
    v_exp_f32 v107, v107
    v_exp_f32 v108, v108
    v_exp_f32 v109, v109
    v_exp_f32 v110, v110
    v_exp_f32 v111, v111
    v_exp_f32 v80, v80
    v_exp_f32 v81, v81
    v_smfmac_f32_32x32x32_bf16 v[40:55], v[68:71], v[104:111], v112
    buffer_load_dwordx4 a[104:107], v2, s[4:7], s38 offen offset:2048
    v_exp_f32 v82, v82
    v_exp_f32 v83, v83
    v_exp_f32 v84, v84
    v_mfma_f32_32x32x16_bf16 v[96:111], v[60:63], v[20:23], 0
    ds_read_b128 v[56:59], v113 offset:2848
    ds_read_b128 v[64:67], v114 offset:2848
    ds_read_b128 v[68:71], v115 offset:2848
    v_exp_f32 v85, v85
    v_exp_f32 v86, v86
    v_exp_f32 v87, v87
    v_exp_f32 v88, v88
    v_exp_f32 v89, v89
    v_smfmac_f32_32x32x32_bf16 v[24:39], v[72:75], v[80:87], v112
    v_exp_f32 v90, v90
    v_exp_f32 v91, v91
    v_exp_f32 v92, v92
    v_exp_f32 v93, v93
    v_exp_f32 v94, v94
    v_exp_f32 v95, v95
    v_exp_f32 v96, v96
    v_exp_f32 v97, v97
    v_smfmac_f32_32x32x32_bf16 v[24:39], v[76:79], v[88:95], v112
    s_waitcnt lgkmcnt(0)
    buffer_load_dwordx4 a[108:111], v2, s[4:7], s38 offen offset:3072
    v_exp_f32 v98, v98
    v_exp_f32 v99, v99
    v_exp_f32 v100, v100
    v_mfma_f32_32x32x16_bf16 v[80:95], v[56:59], v[16:19], 0
    v_exp_f32 v101, v101
    v_exp_f32 v102, v102
    v_exp_f32 v103, v103
    v_exp_f32 v104, v104
    v_exp_f32 v105, v105
    v_smfmac_f32_32x32x32_bf16 v[40:55], v[72:75], v[96:103], v112
    v_exp_f32 v106, v106
    v_exp_f32 v107, v107
    v_exp_f32 v108, v108
    v_exp_f32 v109, v109
    v_exp_f32 v110, v110
    v_exp_f32 v111, v111
    v_exp_f32 v80, v80
    v_exp_f32 v81, v81
    v_smfmac_f32_32x32x32_bf16 v[40:55], v[76:79], v[104:111], v112
    s_add_u32 s38, s23, 585728
    buffer_load_dwordx4 a[112:115], v2, s[4:7], s38 offen offset:0
    v_exp_f32 v82, v82
    v_exp_f32 v83, v83
    v_exp_f32 v84, v84
    v_mfma_f32_32x32x16_bf16 v[96:111], v[56:59], v[20:23], 0
    ds_read_b128 v[60:63], v113 offset:4928
    ds_read_b128 v[72:75], v114 offset:4928
    ds_read_b128 v[76:79], v115 offset:4928
    v_exp_f32 v85, v85
    v_exp_f32 v86, v86
    v_exp_f32 v87, v87
    v_exp_f32 v88, v88
    v_exp_f32 v89, v89
    v_smfmac_f32_32x32x32_bf16 v[24:39], v[64:67], v[80:87], v112
    v_exp_f32 v90, v90
    v_exp_f32 v91, v91
    v_exp_f32 v92, v92
    v_exp_f32 v93, v93
    v_exp_f32 v94, v94
    v_exp_f32 v95, v95
    v_exp_f32 v96, v96
    v_exp_f32 v97, v97
    v_smfmac_f32_32x32x32_bf16 v[24:39], v[68:71], v[88:95], v112
    s_waitcnt lgkmcnt(0)
    buffer_load_dwordx4 a[116:119], v2, s[4:7], s38 offen offset:1024
    v_exp_f32 v98, v98
    v_exp_f32 v99, v99
    v_exp_f32 v100, v100
    v_mfma_f32_32x32x16_bf16 v[80:95], v[60:63], v[16:19], 0
    v_exp_f32 v101, v101
    v_exp_f32 v102, v102
    v_exp_f32 v103, v103
    v_exp_f32 v104, v104
    v_exp_f32 v105, v105
    v_smfmac_f32_32x32x32_bf16 v[40:55], v[64:67], v[96:103], v112
    v_exp_f32 v106, v106
    v_exp_f32 v107, v107
    v_exp_f32 v108, v108
    v_exp_f32 v109, v109
    v_exp_f32 v110, v110
    v_exp_f32 v111, v111
    v_exp_f32 v80, v80
    v_exp_f32 v81, v81
    v_smfmac_f32_32x32x32_bf16 v[40:55], v[68:71], v[104:111], v112
    buffer_load_dwordx4 a[120:123], v2, s[4:7], s38 offen offset:2048
    v_exp_f32 v82, v82
    v_exp_f32 v83, v83
    v_exp_f32 v84, v84
    v_mfma_f32_32x32x16_bf16 v[96:111], v[60:63], v[20:23], 0
    ds_read_b128 v[56:59], v113 offset:7008
    ds_read_b128 v[64:67], v114 offset:7008
    ds_read_b128 v[68:71], v115 offset:7008
    v_exp_f32 v85, v85
    v_exp_f32 v86, v86
    v_exp_f32 v87, v87
    v_exp_f32 v88, v88
    v_exp_f32 v89, v89
    v_smfmac_f32_32x32x32_bf16 v[24:39], v[72:75], v[80:87], v112
    v_exp_f32 v90, v90
    v_exp_f32 v91, v91
    v_exp_f32 v92, v92
    v_exp_f32 v93, v93
    v_exp_f32 v94, v94
    v_exp_f32 v95, v95
    v_exp_f32 v96, v96
    v_exp_f32 v97, v97
    v_smfmac_f32_32x32x32_bf16 v[24:39], v[76:79], v[88:95], v112
    s_waitcnt lgkmcnt(0)
    buffer_load_dwordx4 a[124:127], v2, s[4:7], s38 offen offset:3072
    v_exp_f32 v98, v98
    v_exp_f32 v99, v99
    v_exp_f32 v100, v100
    v_mfma_f32_32x32x16_bf16 v[80:95], v[56:59], v[16:19], 0
    v_exp_f32 v101, v101
    v_exp_f32 v102, v102
    v_exp_f32 v103, v103
    v_exp_f32 v104, v104
    v_exp_f32 v105, v105
    v_smfmac_f32_32x32x32_bf16 v[40:55], v[72:75], v[96:103], v112
    global_load_dword v0, v124, s[92:93]
    v_exp_f32 v106, v106
    v_exp_f32 v107, v107
    v_exp_f32 v108, v108
    v_exp_f32 v109, v109
    v_exp_f32 v110, v110
    v_exp_f32 v111, v111
    v_exp_f32 v80, v80
    v_exp_f32 v81, v81
    v_smfmac_f32_32x32x32_bf16 v[40:55], v[76:79], v[104:111], v112
    s_waitcnt vmcnt(41)
    s_barrier
    v_exp_f32 v82, v82
    v_exp_f32 v83, v83
    v_exp_f32 v84, v84
    v_mfma_f32_32x32x16_bf16 v[96:111], v[56:59], v[20:23], 0
    ds_read_b128 v[60:63], v113 offset:9088
    ds_read_b128 v[72:75], v114 offset:9088
    ds_read_b128 v[76:79], v115 offset:9088
    v_exp_f32 v85, v85
    v_exp_f32 v86, v86
    v_exp_f32 v87, v87
    v_exp_f32 v88, v88
    v_exp_f32 v89, v89
    v_smfmac_f32_32x32x32_bf16 v[24:39], v[64:67], v[80:87], v112
    v_exp_f32 v90, v90
    v_exp_f32 v91, v91
    v_exp_f32 v92, v92
    v_exp_f32 v93, v93
    v_exp_f32 v94, v94
    v_exp_f32 v95, v95
    v_exp_f32 v96, v96
    v_exp_f32 v97, v97
    v_smfmac_f32_32x32x32_bf16 v[24:39], v[68:71], v[88:95], v112
    s_waitcnt lgkmcnt(0)
    s_add_u32 m0, s26, 32768
    v_exp_f32 v98, v98
    v_exp_f32 v99, v99
    v_exp_f32 v100, v100
    v_mfma_f32_32x32x16_bf16 v[80:95], v[60:63], v[16:19], 0
    s_add_u32 s43, s25, 1114112
    v_exp_f32 v101, v101
    v_exp_f32 v102, v102
    v_exp_f32 v103, v103
    v_exp_f32 v104, v104
    v_exp_f32 v105, v105
    v_smfmac_f32_32x32x32_bf16 v[40:55], v[64:67], v[96:103], v112
    buffer_load_dwordx4 v2, s[4:7], s43 offen offset:0  lds
    v_exp_f32 v106, v106
    v_exp_f32 v107, v107
    v_exp_f32 v108, v108
    v_exp_f32 v109, v109
    v_exp_f32 v110, v110
    v_exp_f32 v111, v111
    v_exp_f32 v80, v80
    v_exp_f32 v81, v81
    v_smfmac_f32_32x32x32_bf16 v[40:55], v[68:71], v[104:111], v112
    buffer_load_dwordx4 v2, s[4:7], s43 offen offset:1024  lds
    v_exp_f32 v82, v82
    v_exp_f32 v83, v83
    v_exp_f32 v84, v84
    v_mfma_f32_32x32x16_bf16 v[96:111], v[60:63], v[20:23], 0
    ds_read_b128 v[56:59], v113 offset:11168
    ds_read_b128 v[64:67], v114 offset:11168
    ds_read_b128 v[68:71], v115 offset:11168
    v_exp_f32 v85, v85
    v_exp_f32 v86, v86
    v_exp_f32 v87, v87
    v_exp_f32 v88, v88
    v_exp_f32 v89, v89
    v_smfmac_f32_32x32x32_bf16 v[24:39], v[72:75], v[80:87], v112
    buffer_load_dwordx4 v2, s[4:7], s43 offen offset:2048  lds
    v_exp_f32 v90, v90
    v_exp_f32 v91, v91
    v_exp_f32 v92, v92
    v_exp_f32 v93, v93
    v_exp_f32 v94, v94
    v_exp_f32 v95, v95
    v_exp_f32 v96, v96
    v_exp_f32 v97, v97
    v_smfmac_f32_32x32x32_bf16 v[24:39], v[76:79], v[88:95], v112
    s_waitcnt lgkmcnt(0)
    buffer_load_dwordx4 v2, s[4:7], s43 offen offset:3072  lds
    v_exp_f32 v98, v98
    v_exp_f32 v99, v99
    v_exp_f32 v100, v100
    v_mfma_f32_32x32x16_bf16 v[80:95], v[56:59], v[16:19], 0
    s_add_u32 m0, s26, 36864
    v_exp_f32 v101, v101
    v_exp_f32 v102, v102
    v_exp_f32 v103, v103
    v_exp_f32 v104, v104
    v_exp_f32 v105, v105
    v_smfmac_f32_32x32x32_bf16 v[40:55], v[72:75], v[96:103], v112
    s_add_u32 s43, s25, 1118208
    buffer_load_dwordx4 v2, s[4:7], s43 offen offset:0  lds
    v_exp_f32 v106, v106
    v_exp_f32 v107, v107
    v_exp_f32 v108, v108
    v_exp_f32 v109, v109
    v_exp_f32 v110, v110
    v_exp_f32 v111, v111
    v_exp_f32 v80, v80
    v_exp_f32 v81, v81
    v_smfmac_f32_32x32x32_bf16 v[40:55], v[76:79], v[104:111], v112
    buffer_load_dwordx4 v2, s[4:7], s43 offen offset:1024  lds
    v_exp_f32 v82, v82
    v_exp_f32 v83, v83
    v_exp_f32 v84, v84
    v_mfma_f32_32x32x16_bf16 v[96:111], v[56:59], v[20:23], 0
    ds_read_b128 v[60:63], v113 offset:13248
    ds_read_b128 v[72:75], v114 offset:13248
    ds_read_b128 v[76:79], v115 offset:13248
    v_exp_f32 v85, v85
    v_exp_f32 v86, v86
    v_exp_f32 v87, v87
    v_exp_f32 v88, v88
    v_exp_f32 v89, v89
    v_smfmac_f32_32x32x32_bf16 v[24:39], v[64:67], v[80:87], v112
    buffer_load_dwordx4 v2, s[4:7], s43 offen offset:2048  lds
    v_exp_f32 v90, v90
    v_exp_f32 v91, v91
    v_exp_f32 v92, v92
    v_exp_f32 v93, v93
    v_exp_f32 v94, v94
    v_exp_f32 v95, v95
    v_exp_f32 v96, v96
    v_exp_f32 v97, v97
    v_smfmac_f32_32x32x32_bf16 v[24:39], v[68:71], v[88:95], v112
    s_waitcnt lgkmcnt(0)
    buffer_load_dwordx4 v2, s[4:7], s43 offen offset:3072  lds
    v_exp_f32 v98, v98
    v_exp_f32 v99, v99
    v_exp_f32 v100, v100
    v_mfma_f32_32x32x16_bf16 v[80:95], v[60:63], v[16:19], 0
    s_add_u32 m0, s26, 65536
    v_exp_f32 v101, v101
    v_exp_f32 v102, v102
    v_exp_f32 v103, v103
    v_exp_f32 v104, v104
    v_exp_f32 v105, v105
    v_smfmac_f32_32x32x32_bf16 v[40:55], v[64:67], v[96:103], v112
    s_add_u32 s43, s25, 1146880
    buffer_load_dwordx4 v2, s[4:7], s43 offen offset:0  lds
    v_exp_f32 v106, v106
    v_exp_f32 v107, v107
    v_exp_f32 v108, v108
    v_exp_f32 v109, v109
    v_exp_f32 v110, v110
    v_exp_f32 v111, v111
    v_exp_f32 v80, v80
    v_exp_f32 v81, v81
    v_smfmac_f32_32x32x32_bf16 v[40:55], v[68:71], v[104:111], v112
    buffer_load_dwordx4 v2, s[4:7], s43 offen offset:1024  lds
    v_exp_f32 v82, v82
    v_exp_f32 v83, v83
    v_exp_f32 v84, v84
    v_mfma_f32_32x32x16_bf16 v[96:111], v[60:63], v[20:23], 0
    ds_read_b128 v[56:59], v113 offset:15328
    ds_read_b128 v[64:67], v114 offset:15328
    ds_read_b128 v[68:71], v115 offset:15328
    v_exp_f32 v85, v85
    v_exp_f32 v86, v86
    v_exp_f32 v87, v87
    v_exp_f32 v88, v88
    v_exp_f32 v89, v89
    v_smfmac_f32_32x32x32_bf16 v[24:39], v[72:75], v[80:87], v112
    buffer_load_dwordx4 v2, s[4:7], s43 offen offset:2048  lds
    v_exp_f32 v90, v90
    v_exp_f32 v91, v91
    v_exp_f32 v92, v92
    v_exp_f32 v93, v93
    v_exp_f32 v94, v94
    v_exp_f32 v95, v95
    v_exp_f32 v96, v96
    v_exp_f32 v97, v97
    v_smfmac_f32_32x32x32_bf16 v[24:39], v[76:79], v[88:95], v112
    s_waitcnt lgkmcnt(0)
    buffer_load_dwordx4 v2, s[4:7], s43 offen offset:3072  lds
    v_exp_f32 v98, v98
    v_exp_f32 v99, v99
    v_exp_f32 v100, v100
    v_mfma_f32_32x32x16_bf16 v[80:95], v[56:59], v[16:19], 0
    s_add_u32 m0, s26, 69632
    v_exp_f32 v101, v101
    v_exp_f32 v102, v102
    v_exp_f32 v103, v103
    v_exp_f32 v104, v104
    v_exp_f32 v105, v105
    v_smfmac_f32_32x32x32_bf16 v[40:55], v[72:75], v[96:103], v112
    s_add_u32 s43, s25, 1150976
    buffer_load_dwordx4 v2, s[4:7], s43 offen offset:0  lds
    v_exp_f32 v106, v106
    v_exp_f32 v107, v107
    v_exp_f32 v108, v108
    v_exp_f32 v109, v109
    v_exp_f32 v110, v110
    v_exp_f32 v111, v111
    v_exp_f32 v80, v80
    v_exp_f32 v81, v81
    v_smfmac_f32_32x32x32_bf16 v[40:55], v[76:79], v[104:111], v112
    buffer_load_dwordx4 v2, s[4:7], s43 offen offset:1024  lds
    v_exp_f32 v82, v82
    v_exp_f32 v83, v83
    v_exp_f32 v84, v84
    v_mfma_f32_32x32x16_bf16 v[96:111], v[56:59], v[20:23], 0
    ds_read_b128 v[60:63], v113 offset:17408
    ds_read_b128 v[72:75], v114 offset:17408
    ds_read_b128 v[76:79], v115 offset:17408
    v_exp_f32 v85, v85
    v_exp_f32 v86, v86
    v_exp_f32 v87, v87
    v_exp_f32 v88, v88
    v_exp_f32 v89, v89
    v_smfmac_f32_32x32x32_bf16 v[24:39], v[64:67], v[80:87], v112
    buffer_load_dwordx4 v2, s[4:7], s43 offen offset:2048  lds
    v_exp_f32 v90, v90
    v_exp_f32 v91, v91
    v_exp_f32 v92, v92
    v_exp_f32 v93, v93
    v_exp_f32 v94, v94
    v_exp_f32 v95, v95
    v_exp_f32 v96, v96
    v_exp_f32 v97, v97
    v_smfmac_f32_32x32x32_bf16 v[24:39], v[68:71], v[88:95], v112
    s_waitcnt lgkmcnt(0)
    buffer_load_dwordx4 v2, s[4:7], s43 offen offset:3072  lds
    v_exp_f32 v98, v98
    v_exp_f32 v99, v99
    v_exp_f32 v100, v100
    v_mfma_f32_32x32x16_bf16 v[80:95], v[60:63], v[16:19], 0
    v_exp_f32 v101, v101
    v_exp_f32 v102, v102
    v_exp_f32 v103, v103
    v_exp_f32 v104, v104
    v_exp_f32 v105, v105
    v_smfmac_f32_32x32x32_bf16 v[40:55], v[64:67], v[96:103], v112
    v_exp_f32 v106, v106
    v_exp_f32 v107, v107
    v_exp_f32 v108, v108
    v_exp_f32 v109, v109
    v_exp_f32 v110, v110
    v_exp_f32 v111, v111
    v_exp_f32 v80, v80
    v_exp_f32 v81, v81
    v_smfmac_f32_32x32x32_bf16 v[40:55], v[68:71], v[104:111], v112
    v_exp_f32 v82, v82
    v_exp_f32 v83, v83
    v_exp_f32 v84, v84
    v_mfma_f32_32x32x16_bf16 v[96:111], v[60:63], v[20:23], 0
    ds_read_b128 v[56:59], v113 offset:20256
    ds_read_b128 v[64:67], v114 offset:20256
    ds_read_b128 v[68:71], v115 offset:20256
    v_exp_f32 v85, v85
    v_exp_f32 v86, v86
    v_exp_f32 v87, v87
    v_exp_f32 v88, v88
    v_exp_f32 v89, v89
    v_smfmac_f32_32x32x32_bf16 v[24:39], v[72:75], v[80:87], v112
    v_exp_f32 v90, v90
    v_exp_f32 v91, v91
    v_exp_f32 v92, v92
    v_exp_f32 v93, v93
    v_exp_f32 v94, v94
    v_exp_f32 v95, v95
    v_exp_f32 v96, v96
    v_exp_f32 v97, v97
    v_smfmac_f32_32x32x32_bf16 v[24:39], v[76:79], v[88:95], v112
    s_waitcnt lgkmcnt(0)
    v_exp_f32 v98, v98
    v_exp_f32 v99, v99
    v_exp_f32 v100, v100
    v_mfma_f32_32x32x16_bf16 v[80:95], v[56:59], v[16:19], 0
    v_exp_f32 v101, v101
    v_exp_f32 v102, v102
    v_exp_f32 v103, v103
    v_exp_f32 v104, v104
    v_exp_f32 v105, v105
    v_smfmac_f32_32x32x32_bf16 v[40:55], v[72:75], v[96:103], v112
    v_exp_f32 v106, v106
    v_exp_f32 v107, v107
    v_exp_f32 v108, v108
    v_exp_f32 v109, v109
    v_exp_f32 v110, v110
    v_exp_f32 v111, v111
    v_exp_f32 v80, v80
    v_exp_f32 v81, v81
    v_smfmac_f32_32x32x32_bf16 v[40:55], v[76:79], v[104:111], v112
    v_exp_f32 v82, v82
    v_exp_f32 v83, v83
    v_exp_f32 v84, v84
    v_mfma_f32_32x32x16_bf16 v[96:111], v[56:59], v[20:23], 0
    ds_read_b128 v[60:63], v113 offset:22336
    ds_read_b128 v[72:75], v114 offset:22336
    ds_read_b128 v[76:79], v115 offset:22336
    v_exp_f32 v85, v85
    v_exp_f32 v86, v86
    v_exp_f32 v87, v87
    v_exp_f32 v88, v88
    v_exp_f32 v89, v89
    v_smfmac_f32_32x32x32_bf16 v[24:39], v[64:67], v[80:87], v112
    v_exp_f32 v90, v90
    v_exp_f32 v91, v91
    v_exp_f32 v92, v92
    v_exp_f32 v93, v93
    v_exp_f32 v94, v94
    v_exp_f32 v95, v95
    v_exp_f32 v96, v96
    v_exp_f32 v97, v97
    v_smfmac_f32_32x32x32_bf16 v[24:39], v[68:71], v[88:95], v112
    s_waitcnt lgkmcnt(0)
    v_exp_f32 v98, v98
    v_exp_f32 v99, v99
    v_exp_f32 v100, v100
    v_mfma_f32_32x32x16_bf16 v[80:95], v[60:63], v[16:19], 0
    v_exp_f32 v101, v101
    v_exp_f32 v102, v102
    v_exp_f32 v103, v103
    v_exp_f32 v104, v104
    v_exp_f32 v105, v105
    v_smfmac_f32_32x32x32_bf16 v[40:55], v[64:67], v[96:103], v112
    v_exp_f32 v106, v106
    v_exp_f32 v107, v107
    v_exp_f32 v108, v108
    v_exp_f32 v109, v109
    v_exp_f32 v110, v110
    v_exp_f32 v111, v111
    v_exp_f32 v80, v80
    v_exp_f32 v81, v81
    v_smfmac_f32_32x32x32_bf16 v[40:55], v[68:71], v[104:111], v112
    v_exp_f32 v82, v82
    v_exp_f32 v83, v83
    v_exp_f32 v84, v84
    v_mfma_f32_32x32x16_bf16 v[96:111], v[60:63], v[20:23], 0
    ds_read_b128 v[56:59], v113 offset:24416
    ds_read_b128 v[64:67], v114 offset:24416
    ds_read_b128 v[68:71], v115 offset:24416
    v_exp_f32 v85, v85
    v_exp_f32 v86, v86
    v_exp_f32 v87, v87
    v_exp_f32 v88, v88
    v_exp_f32 v89, v89
    v_smfmac_f32_32x32x32_bf16 v[24:39], v[72:75], v[80:87], v112
    v_exp_f32 v90, v90
    v_exp_f32 v91, v91
    v_exp_f32 v92, v92
    v_exp_f32 v93, v93
    v_exp_f32 v94, v94
    v_exp_f32 v95, v95
    v_exp_f32 v96, v96
    v_exp_f32 v97, v97
    v_smfmac_f32_32x32x32_bf16 v[24:39], v[76:79], v[88:95], v112
    s_waitcnt lgkmcnt(0)
    v_exp_f32 v98, v98
    v_exp_f32 v99, v99
    v_exp_f32 v100, v100
    v_mfma_f32_32x32x16_bf16 v[80:95], v[56:59], v[16:19], 0
    v_exp_f32 v101, v101
    v_exp_f32 v102, v102
    v_exp_f32 v103, v103
    v_exp_f32 v104, v104
    v_exp_f32 v105, v105
    v_smfmac_f32_32x32x32_bf16 v[40:55], v[72:75], v[96:103], v112
    v_exp_f32 v106, v106
    v_exp_f32 v107, v107
    v_exp_f32 v108, v108
    v_exp_f32 v109, v109
    v_exp_f32 v110, v110
    v_exp_f32 v111, v111
    v_exp_f32 v80, v80
    v_exp_f32 v81, v81
    v_smfmac_f32_32x32x32_bf16 v[40:55], v[76:79], v[104:111], v112
    s_add_u32 s42, s28, 14602240
    buffer_load_dword v0, v120, s[4:7], s42 offen
    v_exp_f32 v82, v82
    v_exp_f32 v83, v83
    v_exp_f32 v84, v84
    v_mfma_f32_32x32x16_bf16 v[96:111], v[56:59], v[20:23], 0
    ds_read_b128 v[60:63], v113 offset:26496
    ds_read_b128 v[72:75], v114 offset:26496
    ds_read_b128 v[76:79], v115 offset:26496
    v_exp_f32 v85, v85
    v_exp_f32 v86, v86
    v_exp_f32 v87, v87
    v_exp_f32 v88, v88
    v_exp_f32 v89, v89
    v_smfmac_f32_32x32x32_bf16 v[24:39], v[64:67], v[80:87], v112
    v_exp_f32 v90, v90
    v_exp_f32 v91, v91
    v_exp_f32 v92, v92
    v_exp_f32 v93, v93
    v_exp_f32 v94, v94
    v_exp_f32 v95, v95
    v_exp_f32 v96, v96
    v_exp_f32 v97, v97
    v_smfmac_f32_32x32x32_bf16 v[24:39], v[68:71], v[88:95], v112
    s_waitcnt lgkmcnt(0)
    v_exp_f32 v98, v98
    v_exp_f32 v99, v99
    v_exp_f32 v100, v100
    v_mfma_f32_32x32x16_bf16 v[80:95], v[60:63], v[16:19], 0
    v_exp_f32 v101, v101
    v_exp_f32 v102, v102
    v_exp_f32 v103, v103
    v_exp_f32 v104, v104
    v_exp_f32 v105, v105
    v_smfmac_f32_32x32x32_bf16 v[40:55], v[64:67], v[96:103], v112
    v_exp_f32 v106, v106
    v_exp_f32 v107, v107
    v_exp_f32 v108, v108
    v_exp_f32 v109, v109
    v_exp_f32 v110, v110
    v_exp_f32 v111, v111
    v_exp_f32 v80, v80
    v_exp_f32 v81, v81
    v_smfmac_f32_32x32x32_bf16 v[40:55], v[68:71], v[104:111], v112
    s_add_u32 s42, s28, 14618624
    buffer_load_dword v0, v120, s[4:7], s42 offen
    v_exp_f32 v82, v82
    v_exp_f32 v83, v83
    v_exp_f32 v84, v84
    v_mfma_f32_32x32x16_bf16 v[96:111], v[60:63], v[20:23], 0
    ds_read_b128 v[56:59], v113 offset:28576
    ds_read_b128 v[64:67], v114 offset:28576
    ds_read_b128 v[68:71], v115 offset:28576
    v_exp_f32 v85, v85
    v_exp_f32 v86, v86
    v_exp_f32 v87, v87
    v_exp_f32 v88, v88
    v_exp_f32 v89, v89
    v_smfmac_f32_32x32x32_bf16 v[24:39], v[72:75], v[80:87], v112
    v_exp_f32 v90, v90
    v_exp_f32 v91, v91
    v_exp_f32 v92, v92
    v_exp_f32 v93, v93
    v_exp_f32 v94, v94
    v_exp_f32 v95, v95
    v_exp_f32 v96, v96
    v_exp_f32 v97, v97
    v_smfmac_f32_32x32x32_bf16 v[24:39], v[76:79], v[88:95], v112
    s_waitcnt lgkmcnt(0)
    v_exp_f32 v98, v98
    v_exp_f32 v99, v99
    v_exp_f32 v100, v100
    v_mfma_f32_32x32x16_bf16 v[80:95], v[56:59], v[16:19], 0
    v_exp_f32 v101, v101
    v_exp_f32 v102, v102
    v_exp_f32 v103, v103
    v_exp_f32 v104, v104
    v_exp_f32 v105, v105
    v_smfmac_f32_32x32x32_bf16 v[40:55], v[72:75], v[96:103], v112
    v_exp_f32 v106, v106
    v_exp_f32 v107, v107
    v_exp_f32 v108, v108
    v_exp_f32 v109, v109
    v_exp_f32 v110, v110
    v_exp_f32 v111, v111
    v_exp_f32 v80, v80
    v_exp_f32 v81, v81
    v_smfmac_f32_32x32x32_bf16 v[40:55], v[76:79], v[104:111], v112
    s_add_u32 s42, s28, 14635008
    buffer_load_dword v0, v120, s[4:7], s42 offen
    v_exp_f32 v82, v82
    v_exp_f32 v83, v83
    v_exp_f32 v84, v84
    v_mfma_f32_32x32x16_bf16 v[96:111], v[56:59], v[20:23], 0
    ds_read_b128 v[60:63], v113 offset:30656
    ds_read_b128 v[72:75], v114 offset:30656
    ds_read_b128 v[76:79], v115 offset:30656
    v_exp_f32 v85, v85
    v_exp_f32 v86, v86
    v_exp_f32 v87, v87
    v_exp_f32 v88, v88
    v_exp_f32 v89, v89
    v_smfmac_f32_32x32x32_bf16 v[24:39], v[64:67], v[80:87], v112
    v_exp_f32 v90, v90
    v_exp_f32 v91, v91
    v_exp_f32 v92, v92
    v_exp_f32 v93, v93
    v_exp_f32 v94, v94
    v_exp_f32 v95, v95
    v_exp_f32 v96, v96
    v_exp_f32 v97, v97
    v_smfmac_f32_32x32x32_bf16 v[24:39], v[68:71], v[88:95], v112
    s_waitcnt lgkmcnt(0)
    v_exp_f32 v98, v98
    v_exp_f32 v99, v99
    v_exp_f32 v100, v100
    v_mfma_f32_32x32x16_bf16 v[80:95], v[60:63], v[16:19], 0
    v_exp_f32 v101, v101
    v_exp_f32 v102, v102
    v_exp_f32 v103, v103
    v_exp_f32 v104, v104
    v_exp_f32 v105, v105
    v_smfmac_f32_32x32x32_bf16 v[40:55], v[64:67], v[96:103], v112
    v_exp_f32 v106, v106
    v_exp_f32 v107, v107
    v_exp_f32 v108, v108
    v_exp_f32 v109, v109
    v_exp_f32 v110, v110
    v_exp_f32 v111, v111
    v_exp_f32 v80, v80
    v_exp_f32 v81, v81
    v_smfmac_f32_32x32x32_bf16 v[40:55], v[68:71], v[104:111], v112
    s_add_u32 s42, s28, 14651392
    s_waitcnt vmcnt(32)
    buffer_load_dword v0, v120, s[4:7], s42 offen
    v_exp_f32 v82, v82
    v_exp_f32 v83, v83
    v_exp_f32 v84, v84
    v_mfma_f32_32x32x16_bf16 v[96:111], v[60:63], v[20:23], 0
    ds_read_b128 v[56:59], v113 offset:32736
    ds_read_b128 v[64:67], v114 offset:32736
    ds_read_b128 v[68:71], v115 offset:32736
    v_exp_f32 v85, v85
    v_exp_f32 v86, v86
    v_exp_f32 v87, v87
    v_exp_f32 v88, v88
    v_exp_f32 v89, v89
    v_smfmac_f32_32x32x32_bf16 v[24:39], v[72:75], v[80:87], v112
    v_exp_f32 v90, v90
    v_exp_f32 v91, v91
    v_exp_f32 v92, v92
    v_exp_f32 v93, v93
    v_exp_f32 v94, v94
    v_exp_f32 v95, v95
    v_exp_f32 v96, v96
    v_exp_f32 v97, v97
    v_smfmac_f32_32x32x32_bf16 v[24:39], v[76:79], v[88:95], v112
    s_waitcnt lgkmcnt(0)
    v_exp_f32 v98, v98
    v_exp_f32 v99, v99
    v_exp_f32 v100, v100
    v_mfma_f32_32x32x16_bf16 v[80:95], v[56:59], v[16:19], 0
    v_exp_f32 v101, v101
    v_exp_f32 v102, v102
    v_exp_f32 v103, v103
    v_exp_f32 v104, v104
    v_exp_f32 v105, v105
    v_smfmac_f32_32x32x32_bf16 v[40:55], v[72:75], v[96:103], v112
    v_exp_f32 v106, v106
    v_exp_f32 v107, v107
    v_exp_f32 v108, v108
    v_exp_f32 v109, v109
    v_exp_f32 v110, v110
    v_exp_f32 v111, v111
    v_exp_f32 v80, v80
    v_exp_f32 v81, v81
    v_smfmac_f32_32x32x32_bf16 v[40:55], v[76:79], v[104:111], v112
    s_add_u32 s42, s28, 14667776
    buffer_load_dword v0, v120, s[4:7], s42 offen
    v_exp_f32 v82, v82
    v_exp_f32 v83, v83
    v_exp_f32 v84, v84
    v_mfma_f32_32x32x16_bf16 v[96:111], v[56:59], v[20:23], 0
    ds_read_b128 v[60:63], v113 offset:34816
    ds_read_b128 v[72:75], v114 offset:34816
    ds_read_b128 v[76:79], v115 offset:34816
    v_exp_f32 v85, v85
    v_exp_f32 v86, v86
    v_exp_f32 v87, v87
    v_exp_f32 v88, v88
    v_exp_f32 v89, v89
    v_smfmac_f32_32x32x32_bf16 v[24:39], v[64:67], v[80:87], v112
    v_exp_f32 v90, v90
    v_exp_f32 v91, v91
    v_exp_f32 v92, v92
    v_exp_f32 v93, v93
    v_exp_f32 v94, v94
    v_exp_f32 v95, v95
    v_exp_f32 v96, v96
    v_exp_f32 v97, v97
    v_smfmac_f32_32x32x32_bf16 v[24:39], v[68:71], v[88:95], v112
    s_waitcnt lgkmcnt(0)
    v_exp_f32 v98, v98
    v_exp_f32 v99, v99
    v_exp_f32 v100, v100
    v_mfma_f32_32x32x16_bf16 v[80:95], v[60:63], v[16:19], 0
    v_exp_f32 v101, v101
    v_exp_f32 v102, v102
    v_exp_f32 v103, v103
    v_exp_f32 v104, v104
    v_exp_f32 v105, v105
    v_smfmac_f32_32x32x32_bf16 v[40:55], v[64:67], v[96:103], v112
    v_exp_f32 v106, v106
    v_exp_f32 v107, v107
    v_exp_f32 v108, v108
    v_exp_f32 v109, v109
    v_exp_f32 v110, v110
    v_exp_f32 v111, v111
    v_exp_f32 v80, v80
    v_exp_f32 v81, v81
    v_smfmac_f32_32x32x32_bf16 v[40:55], v[68:71], v[104:111], v112
    s_add_u32 s42, s28, 14684160
    buffer_load_dword v0, v120, s[4:7], s42 offen
    v_exp_f32 v82, v82
    v_exp_f32 v83, v83
    v_exp_f32 v84, v84
    v_mfma_f32_32x32x16_bf16 v[96:111], v[60:63], v[20:23], 0
    ds_read_b128 v[56:59], v113 offset:37664
    ds_read_b128 v[64:67], v114 offset:37664
    ds_read_b128 v[68:71], v115 offset:37664
    v_exp_f32 v85, v85
    v_exp_f32 v86, v86
    v_exp_f32 v87, v87
    v_exp_f32 v88, v88
    v_exp_f32 v89, v89
    v_smfmac_f32_32x32x32_bf16 v[24:39], v[72:75], v[80:87], v112
    v_exp_f32 v90, v90
    v_exp_f32 v91, v91
    v_exp_f32 v92, v92
    v_exp_f32 v93, v93
    v_exp_f32 v94, v94
    v_exp_f32 v95, v95
    v_exp_f32 v96, v96
    v_exp_f32 v97, v97
    v_smfmac_f32_32x32x32_bf16 v[24:39], v[76:79], v[88:95], v112
    s_waitcnt lgkmcnt(0)
    v_exp_f32 v98, v98
    v_exp_f32 v99, v99
    v_exp_f32 v100, v100
    v_mfma_f32_32x32x16_bf16 v[80:95], v[56:59], v[16:19], 0
    v_exp_f32 v101, v101
    v_exp_f32 v102, v102
    v_exp_f32 v103, v103
    v_exp_f32 v104, v104
    v_exp_f32 v105, v105
    v_smfmac_f32_32x32x32_bf16 v[40:55], v[72:75], v[96:103], v112
    v_exp_f32 v106, v106
    v_exp_f32 v107, v107
    v_exp_f32 v108, v108
    v_exp_f32 v109, v109
    v_exp_f32 v110, v110
    v_exp_f32 v111, v111
    v_exp_f32 v80, v80
    v_exp_f32 v81, v81
    v_smfmac_f32_32x32x32_bf16 v[40:55], v[76:79], v[104:111], v112
    s_add_u32 s42, s16, 7499776
    buffer_load_dword v0, v3, s[4:7], s42 offen
    v_exp_f32 v82, v82
    v_exp_f32 v83, v83
    v_exp_f32 v84, v84
    v_mfma_f32_32x32x16_bf16 v[96:111], v[56:59], v[20:23], 0
    ds_read_b128 v[60:63], v113 offset:39744
    ds_read_b128 v[72:75], v114 offset:39744
    ds_read_b128 v[76:79], v115 offset:39744
    v_exp_f32 v85, v85
    v_exp_f32 v86, v86
    v_exp_f32 v87, v87
    v_exp_f32 v88, v88
    v_exp_f32 v89, v89
    v_smfmac_f32_32x32x32_bf16 v[24:39], v[64:67], v[80:87], v112
    v_exp_f32 v90, v90
    v_exp_f32 v91, v91
    v_exp_f32 v92, v92
    v_exp_f32 v93, v93
    v_exp_f32 v94, v94
    v_exp_f32 v95, v95
    v_exp_f32 v96, v96
    v_exp_f32 v97, v97
    v_smfmac_f32_32x32x32_bf16 v[24:39], v[68:71], v[88:95], v112
    s_waitcnt lgkmcnt(0)
    v_exp_f32 v98, v98
    v_exp_f32 v99, v99
    v_exp_f32 v100, v100
    v_mfma_f32_32x32x16_bf16 v[80:95], v[60:63], v[16:19], 0
    v_exp_f32 v101, v101
    v_exp_f32 v102, v102
    v_exp_f32 v103, v103
    v_exp_f32 v104, v104
    v_exp_f32 v105, v105
    v_smfmac_f32_32x32x32_bf16 v[40:55], v[64:67], v[96:103], v112
    v_exp_f32 v106, v106
    v_exp_f32 v107, v107
    v_exp_f32 v108, v108
    v_exp_f32 v109, v109
    v_exp_f32 v110, v110
    v_exp_f32 v111, v111
    v_exp_f32 v80, v80
    v_exp_f32 v81, v81
    v_smfmac_f32_32x32x32_bf16 v[40:55], v[68:71], v[104:111], v112
    s_add_u32 s42, s18, 35876864
    buffer_load_dword v0, v118, s[4:7], s42 offen
    v_exp_f32 v82, v82
    v_exp_f32 v83, v83
    v_exp_f32 v84, v84
    v_mfma_f32_32x32x16_bf16 v[96:111], v[60:63], v[20:23], 0
    ds_read_b128 v[56:59], v113 offset:41824
    ds_read_b128 v[64:67], v114 offset:41824
    ds_read_b128 v[68:71], v115 offset:41824
    v_exp_f32 v85, v85
    v_exp_f32 v86, v86
    v_exp_f32 v87, v87
    v_exp_f32 v88, v88
    v_exp_f32 v89, v89
    v_smfmac_f32_32x32x32_bf16 v[24:39], v[72:75], v[80:87], v112
    v_exp_f32 v90, v90
    v_exp_f32 v91, v91
    v_exp_f32 v92, v92
    v_exp_f32 v93, v93
    v_exp_f32 v94, v94
    v_exp_f32 v95, v95
    v_exp_f32 v96, v96
    v_exp_f32 v97, v97
    v_smfmac_f32_32x32x32_bf16 v[24:39], v[76:79], v[88:95], v112
    s_waitcnt lgkmcnt(0)
    v_exp_f32 v98, v98
    v_exp_f32 v99, v99
    v_exp_f32 v100, v100
    v_mfma_f32_32x32x16_bf16 v[80:95], v[56:59], v[16:19], 0
    v_exp_f32 v101, v101
    v_exp_f32 v102, v102
    v_exp_f32 v103, v103
    v_exp_f32 v104, v104
    v_exp_f32 v105, v105
    v_smfmac_f32_32x32x32_bf16 v[40:55], v[72:75], v[96:103], v112
    v_exp_f32 v106, v106
    v_exp_f32 v107, v107
    v_exp_f32 v108, v108
    v_exp_f32 v109, v109
    v_exp_f32 v110, v110
    v_exp_f32 v111, v111
    v_exp_f32 v80, v80
    v_exp_f32 v81, v81
    v_smfmac_f32_32x32x32_bf16 v[40:55], v[76:79], v[104:111], v112
    s_add_u32 s42, s30, 13791232
    buffer_load_dword v0, v117, s[4:7], s42 offen
    v_exp_f32 v82, v82
    v_exp_f32 v83, v83
    v_exp_f32 v84, v84
    v_mfma_f32_32x32x16_bf16 v[96:111], v[56:59], v[20:23], 0
    ds_read_b128 v[60:63], v113 offset:43904
    ds_read_b128 v[72:75], v114 offset:43904
    ds_read_b128 v[76:79], v115 offset:43904
    v_exp_f32 v85, v85
    v_exp_f32 v86, v86
    v_exp_f32 v87, v87
    v_exp_f32 v88, v88
    v_exp_f32 v89, v89
    v_smfmac_f32_32x32x32_bf16 v[24:39], v[64:67], v[80:87], v112
    v_exp_f32 v90, v90
    v_exp_f32 v91, v91
    v_exp_f32 v92, v92
    v_exp_f32 v93, v93
    v_exp_f32 v94, v94
    v_exp_f32 v95, v95
    v_exp_f32 v96, v96
    v_exp_f32 v97, v97
    v_smfmac_f32_32x32x32_bf16 v[24:39], v[68:71], v[88:95], v112
    s_waitcnt lgkmcnt(0)
    v_exp_f32 v98, v98
    v_exp_f32 v99, v99
    v_exp_f32 v100, v100
    v_mfma_f32_32x32x16_bf16 v[80:95], v[60:63], v[16:19], 0
    v_exp_f32 v101, v101
    v_exp_f32 v102, v102
    v_exp_f32 v103, v103
    v_exp_f32 v104, v104
    v_exp_f32 v105, v105
    v_smfmac_f32_32x32x32_bf16 v[40:55], v[64:67], v[96:103], v112
    v_exp_f32 v106, v106
    v_exp_f32 v107, v107
    v_exp_f32 v108, v108
    v_exp_f32 v109, v109
    v_exp_f32 v110, v110
    v_exp_f32 v111, v111
    v_exp_f32 v80, v80
    v_exp_f32 v81, v81
    v_smfmac_f32_32x32x32_bf16 v[40:55], v[68:71], v[104:111], v112
    v_exp_f32 v82, v82
    v_exp_f32 v83, v83
    v_exp_f32 v84, v84
    v_mfma_f32_32x32x16_bf16 v[96:111], v[60:63], v[20:23], 0
    ds_read_b128 v[56:59], v113 offset:45984
    ds_read_b128 v[64:67], v114 offset:45984
    ds_read_b128 v[68:71], v115 offset:45984
    v_exp_f32 v85, v85
    v_exp_f32 v86, v86
    v_exp_f32 v87, v87
    v_exp_f32 v88, v88
    v_exp_f32 v89, v89
    v_smfmac_f32_32x32x32_bf16 v[24:39], v[72:75], v[80:87], v112
    v_exp_f32 v90, v90
    v_exp_f32 v91, v91
    v_exp_f32 v92, v92
    v_exp_f32 v93, v93
    v_exp_f32 v94, v94
    v_exp_f32 v95, v95
    v_exp_f32 v96, v96
    v_exp_f32 v97, v97
    v_smfmac_f32_32x32x32_bf16 v[24:39], v[76:79], v[88:95], v112
    s_waitcnt lgkmcnt(0)
    v_exp_f32 v98, v98
    v_exp_f32 v99, v99
    v_exp_f32 v100, v100
    v_mfma_f32_32x32x16_bf16 v[80:95], v[56:59], v[16:19], 0
    v_exp_f32 v101, v101
    v_exp_f32 v102, v102
    v_exp_f32 v103, v103
    v_exp_f32 v104, v104
    v_exp_f32 v105, v105
    v_smfmac_f32_32x32x32_bf16 v[40:55], v[72:75], v[96:103], v112
    v_exp_f32 v106, v106
    v_exp_f32 v107, v107
    v_exp_f32 v108, v108
    v_exp_f32 v109, v109
    v_exp_f32 v110, v110
    v_exp_f32 v111, v111
    v_exp_f32 v80, v80
    v_exp_f32 v81, v81
    v_smfmac_f32_32x32x32_bf16 v[40:55], v[76:79], v[104:111], v112
    global_load_dword v0, v124, s[92:93]
    v_exp_f32 v82, v82
    v_exp_f32 v83, v83
    v_exp_f32 v84, v84
    v_mfma_f32_32x32x16_bf16 v[96:111], v[56:59], v[20:23], 0
    ds_read_b128 v[60:63], v113 offset:48064
    ds_read_b128 v[72:75], v114 offset:48064
    ds_read_b128 v[76:79], v115 offset:48064
    v_exp_f32 v85, v85
    v_exp_f32 v86, v86
    v_exp_f32 v87, v87
    v_exp_f32 v88, v88
    v_exp_f32 v89, v89
    v_smfmac_f32_32x32x32_bf16 v[24:39], v[64:67], v[80:87], v112
    v_exp_f32 v90, v90
    v_exp_f32 v91, v91
    v_exp_f32 v92, v92
    v_exp_f32 v93, v93
    v_exp_f32 v94, v94
    v_exp_f32 v95, v95
    v_exp_f32 v96, v96
    v_exp_f32 v97, v97
    v_smfmac_f32_32x32x32_bf16 v[24:39], v[68:71], v[88:95], v112
    s_waitcnt lgkmcnt(0)
    v_exp_f32 v98, v98
    v_exp_f32 v99, v99
    v_exp_f32 v100, v100
    v_mfma_f32_32x32x16_bf16 v[80:95], v[60:63], v[16:19], 0
    v_exp_f32 v101, v101
    v_exp_f32 v102, v102
    v_exp_f32 v103, v103
    v_exp_f32 v104, v104
    v_exp_f32 v105, v105
    v_smfmac_f32_32x32x32_bf16 v[40:55], v[64:67], v[96:103], v112
    v_exp_f32 v106, v106
    v_exp_f32 v107, v107
    v_exp_f32 v108, v108
    v_exp_f32 v109, v109
    v_exp_f32 v110, v110
    v_exp_f32 v111, v111
    v_exp_f32 v80, v80
    v_exp_f32 v81, v81
    v_smfmac_f32_32x32x32_bf16 v[40:55], v[68:71], v[104:111], v112
    s_barrier
    v_exp_f32 v82, v82
    v_exp_f32 v83, v83
    v_exp_f32 v84, v84
    v_mfma_f32_32x32x16_bf16 v[96:111], v[60:63], v[20:23], 0
    ds_read_b128 v[56:59], v113 offset:50144
    ds_read_b128 v[64:67], v114 offset:50144
    ds_read_b128 v[68:71], v115 offset:50144
    v_exp_f32 v85, v85
    v_exp_f32 v86, v86
    v_exp_f32 v87, v87
    v_exp_f32 v88, v88
    v_exp_f32 v89, v89
    v_smfmac_f32_32x32x32_bf16 v[24:39], v[72:75], v[80:87], v112
    v_exp_f32 v90, v90
    v_exp_f32 v91, v91
    v_exp_f32 v92, v92
    v_exp_f32 v93, v93
    v_exp_f32 v94, v94
    v_exp_f32 v95, v95
    v_exp_f32 v96, v96
    v_exp_f32 v97, v97
    v_smfmac_f32_32x32x32_bf16 v[24:39], v[76:79], v[88:95], v112
    s_waitcnt lgkmcnt(0)
    s_add_u32 m0, s26, 98304
    v_exp_f32 v98, v98
    v_exp_f32 v99, v99
    v_exp_f32 v100, v100
    v_mfma_f32_32x32x16_bf16 v[80:95], v[56:59], v[16:19], 0
    s_add_u32 s43, s25, 1179648
    v_exp_f32 v101, v101
    v_exp_f32 v102, v102
    v_exp_f32 v103, v103
    v_exp_f32 v104, v104
    v_exp_f32 v105, v105
    v_smfmac_f32_32x32x32_bf16 v[40:55], v[72:75], v[96:103], v112
    buffer_load_dwordx4 v2, s[4:7], s43 offen offset:0  lds
    v_exp_f32 v106, v106
    v_exp_f32 v107, v107
    v_exp_f32 v108, v108
    v_exp_f32 v109, v109
    v_exp_f32 v110, v110
    v_exp_f32 v111, v111
    v_exp_f32 v80, v80
    v_exp_f32 v81, v81
    v_smfmac_f32_32x32x32_bf16 v[40:55], v[76:79], v[104:111], v112
    buffer_load_dwordx4 v2, s[4:7], s43 offen offset:1024  lds
    v_exp_f32 v82, v82
    v_exp_f32 v83, v83
    v_exp_f32 v84, v84
    v_mfma_f32_32x32x16_bf16 v[96:111], v[56:59], v[20:23], 0
    ds_read_b128 v[60:63], v113 offset:52224
    ds_read_b128 v[72:75], v114 offset:52224
    ds_read_b128 v[76:79], v115 offset:52224
    v_exp_f32 v85, v85
    v_exp_f32 v86, v86
    v_exp_f32 v87, v87
    v_exp_f32 v88, v88
    v_exp_f32 v89, v89
    v_smfmac_f32_32x32x32_bf16 v[24:39], v[64:67], v[80:87], v112
    buffer_load_dwordx4 v2, s[4:7], s43 offen offset:2048  lds
    v_exp_f32 v90, v90
    v_exp_f32 v91, v91
    v_exp_f32 v92, v92
    v_exp_f32 v93, v93
    v_exp_f32 v94, v94
    v_exp_f32 v95, v95
    v_exp_f32 v96, v96
    v_exp_f32 v97, v97
    v_smfmac_f32_32x32x32_bf16 v[24:39], v[68:71], v[88:95], v112
    s_waitcnt lgkmcnt(0)
    buffer_load_dwordx4 v2, s[4:7], s43 offen offset:3072  lds
    v_exp_f32 v98, v98
    v_exp_f32 v99, v99
    v_exp_f32 v100, v100
    v_mfma_f32_32x32x16_bf16 v[80:95], v[60:63], v[16:19], 0
    s_add_u32 m0, s26, 102400
    v_exp_f32 v101, v101
    v_exp_f32 v102, v102
    v_exp_f32 v103, v103
    v_exp_f32 v104, v104
    v_exp_f32 v105, v105
    v_smfmac_f32_32x32x32_bf16 v[40:55], v[64:67], v[96:103], v112
    s_add_u32 s43, s25, 1183744
    buffer_load_dwordx4 v2, s[4:7], s43 offen offset:0  lds
    v_exp_f32 v106, v106
    v_exp_f32 v107, v107
    v_exp_f32 v108, v108
    v_exp_f32 v109, v109
    v_exp_f32 v110, v110
    v_exp_f32 v111, v111
    v_exp_f32 v80, v80
    v_exp_f32 v81, v81
    v_smfmac_f32_32x32x32_bf16 v[40:55], v[68:71], v[104:111], v112
    buffer_load_dwordx4 v2, s[4:7], s43 offen offset:1024  lds
    v_exp_f32 v82, v82
    v_exp_f32 v83, v83
    v_exp_f32 v84, v84
    v_mfma_f32_32x32x16_bf16 v[96:111], v[60:63], v[20:23], 0
    ds_read_b128 v[56:59], v113 offset:55072
    ds_read_b128 v[64:67], v114 offset:55072
    ds_read_b128 v[68:71], v115 offset:55072
    v_exp_f32 v85, v85
    v_exp_f32 v86, v86
    v_exp_f32 v87, v87
    v_exp_f32 v88, v88
    v_exp_f32 v89, v89
    v_smfmac_f32_32x32x32_bf16 v[24:39], v[72:75], v[80:87], v112
    buffer_load_dwordx4 v2, s[4:7], s43 offen offset:2048  lds
    v_exp_f32 v90, v90
    v_exp_f32 v91, v91
    v_exp_f32 v92, v92
    v_exp_f32 v93, v93
    v_exp_f32 v94, v94
    v_exp_f32 v95, v95
    v_exp_f32 v96, v96
    v_exp_f32 v97, v97
    v_smfmac_f32_32x32x32_bf16 v[24:39], v[76:79], v[88:95], v112
    s_waitcnt lgkmcnt(0)
    buffer_load_dwordx4 v2, s[4:7], s43 offen offset:3072  lds
    v_exp_f32 v98, v98
    v_exp_f32 v99, v99
    v_exp_f32 v100, v100
    v_mfma_f32_32x32x16_bf16 v[80:95], v[56:59], v[16:19], 0
    v_exp_f32 v101, v101
    v_exp_f32 v102, v102
    v_exp_f32 v103, v103
    v_exp_f32 v104, v104
    v_exp_f32 v105, v105
    v_smfmac_f32_32x32x32_bf16 v[40:55], v[72:75], v[96:103], v112
    v_exp_f32 v106, v106
    v_exp_f32 v107, v107
    v_exp_f32 v108, v108
    v_exp_f32 v109, v109
    v_exp_f32 v110, v110
    v_exp_f32 v111, v111
    v_exp_f32 v80, v80
    v_exp_f32 v81, v81
    v_smfmac_f32_32x32x32_bf16 v[40:55], v[76:79], v[104:111], v112
    s_mul_i32 s39, s36, 11
    s_lshr_b32 s39, s39, 4
    v_exp_f32 v82, v82
    v_exp_f32 v83, v83
    v_exp_f32 v84, v84
    v_mfma_f32_32x32x16_bf16 v[96:111], v[56:59], v[20:23], 0
    ds_read_b128 v[60:63], v113 offset:57152
    ds_read_b128 v[72:75], v114 offset:57152
    ds_read_b128 v[76:79], v115 offset:57152
    v_exp_f32 v85, v85
    v_exp_f32 v86, v86
    v_exp_f32 v87, v87
    v_exp_f32 v88, v88
    v_exp_f32 v89, v89
    v_smfmac_f32_32x32x32_bf16 v[24:39], v[64:67], v[80:87], v112
    s_add_u32 s39, s39, s24
    s_add_u32 s42, s39, 3899392
    v_exp_f32 v90, v90
    v_exp_f32 v91, v91
    v_exp_f32 v92, v92
    v_exp_f32 v93, v93
    v_exp_f32 v94, v94
    v_exp_f32 v95, v95
    v_exp_f32 v96, v96
    v_exp_f32 v97, v97
    v_smfmac_f32_32x32x32_bf16 v[24:39], v[68:71], v[88:95], v112
    s_waitcnt lgkmcnt(0)
    buffer_load_dword v0, v122, s[4:7], s42 offen
    v_exp_f32 v98, v98
    v_exp_f32 v99, v99
    v_exp_f32 v100, v100
    v_mfma_f32_32x32x16_bf16 v[80:95], v[60:63], v[16:19], 0
    s_lshr_b32 s39, s13, 4
    v_exp_f32 v101, v101
    v_exp_f32 v102, v102
    v_exp_f32 v103, v103
    v_exp_f32 v104, v104
    v_exp_f32 v105, v105
    v_smfmac_f32_32x32x32_bf16 v[40:55], v[64:67], v[96:103], v112
    s_lshl_b32 s39, s39, 15
    s_add_u32 s39, s39, s25
    v_exp_f32 v106, v106
    v_exp_f32 v107, v107
    v_exp_f32 v108, v108
    v_exp_f32 v109, v109
    v_exp_f32 v110, v110
    v_exp_f32 v111, v111
    v_exp_f32 v80, v80
    v_exp_f32 v81, v81
    v_smfmac_f32_32x32x32_bf16 v[40:55], v[68:71], v[104:111], v112
    s_add_u32 s42, s39, 1212416
    buffer_load_dword v0, v122, s[4:7], s42 offen
    v_exp_f32 v82, v82
    v_exp_f32 v83, v83
    v_exp_f32 v84, v84
    v_mfma_f32_32x32x16_bf16 v[96:111], v[60:63], v[20:23], 0
    ds_read_b128 v[56:59], v113 offset:59232
    ds_read_b128 v[64:67], v114 offset:59232
    ds_read_b128 v[68:71], v115 offset:59232
    v_exp_f32 v85, v85
    v_exp_f32 v86, v86
    v_exp_f32 v87, v87
    v_exp_f32 v88, v88
    v_exp_f32 v89, v89
    v_smfmac_f32_32x32x32_bf16 v[24:39], v[72:75], v[80:87], v112
    s_add_u32 s42, s39, 1216512
    buffer_load_dword v0, v122, s[4:7], s42 offen
    v_exp_f32 v90, v90
    v_exp_f32 v91, v91
    v_exp_f32 v92, v92
    v_exp_f32 v93, v93
    v_exp_f32 v94, v94
    v_exp_f32 v95, v95
    v_exp_f32 v96, v96
    v_exp_f32 v97, v97
    v_smfmac_f32_32x32x32_bf16 v[24:39], v[76:79], v[88:95], v112
    s_waitcnt lgkmcnt(0)
    s_add_u32 s42, s35, 5312512
    v_exp_f32 v98, v98
    v_exp_f32 v99, v99
    v_exp_f32 v100, v100
    v_mfma_f32_32x32x16_bf16 v[80:95], v[56:59], v[16:19], 0
    v_exp_f32 v101, v101
    v_exp_f32 v102, v102
    v_exp_f32 v103, v103
    v_exp_f32 v104, v104
    v_exp_f32 v105, v105
    v_smfmac_f32_32x32x32_bf16 v[40:55], v[72:75], v[96:103], v112
    buffer_load_dword v0, v4, s[4:7], s42 offen
    v_exp_f32 v106, v106
    v_exp_f32 v107, v107
    v_exp_f32 v108, v108
    v_exp_f32 v109, v109
    v_exp_f32 v110, v110
    v_exp_f32 v111, v111
    v_exp_f32 v80, v80
    v_exp_f32 v81, v81
    v_smfmac_f32_32x32x32_bf16 v[40:55], v[76:79], v[104:111], v112
    v_exp_f32 v82, v82
    v_exp_f32 v83, v83
    v_exp_f32 v84, v84
    v_mfma_f32_32x32x16_bf16 v[96:111], v[56:59], v[20:23], 0
    ds_read_b128 v[60:63], v113 offset:61312
    ds_read_b128 v[72:75], v114 offset:61312
    ds_read_b128 v[76:79], v115 offset:61312
    v_exp_f32 v85, v85
    v_exp_f32 v86, v86
    v_exp_f32 v87, v87
    v_exp_f32 v88, v88
    v_exp_f32 v89, v89
    v_smfmac_f32_32x32x32_bf16 v[24:39], v[64:67], v[80:87], v112
    v_exp_f32 v90, v90
    v_exp_f32 v91, v91
    v_exp_f32 v92, v92
    v_exp_f32 v93, v93
    v_exp_f32 v94, v94
    v_exp_f32 v95, v95
    v_exp_f32 v96, v96
    v_exp_f32 v97, v97
    v_smfmac_f32_32x32x32_bf16 v[24:39], v[68:71], v[88:95], v112
    s_waitcnt lgkmcnt(0)
    v_exp_f32 v98, v98
    v_exp_f32 v99, v99
    v_exp_f32 v100, v100
    v_mfma_f32_32x32x16_bf16 v[80:95], v[60:63], v[16:19], 0
    v_exp_f32 v101, v101
    v_exp_f32 v102, v102
    v_exp_f32 v103, v103
    v_exp_f32 v104, v104
    v_exp_f32 v105, v105
    v_smfmac_f32_32x32x32_bf16 v[40:55], v[64:67], v[96:103], v112
    v_exp_f32 v106, v106
    v_exp_f32 v107, v107
    v_exp_f32 v108, v108
    v_exp_f32 v109, v109
    v_exp_f32 v110, v110
    v_exp_f32 v111, v111
    v_exp_f32 v80, v80
    v_exp_f32 v81, v81
    v_smfmac_f32_32x32x32_bf16 v[40:55], v[68:71], v[104:111], v112
    v_exp_f32 v82, v82
    v_exp_f32 v83, v83
    v_exp_f32 v84, v84
    v_mfma_f32_32x32x16_bf16 v[96:111], v[60:63], v[20:23], 0
    ds_read_b128 v[56:59], v113 offset:63392
    ds_read_b128 v[64:67], v114 offset:63392
    ds_read_b128 v[68:71], v115 offset:63392
    v_exp_f32 v85, v85
    v_exp_f32 v86, v86
    v_exp_f32 v87, v87
    v_exp_f32 v88, v88
    v_exp_f32 v89, v89
    v_smfmac_f32_32x32x32_bf16 v[24:39], v[72:75], v[80:87], v112
    v_exp_f32 v90, v90
    v_exp_f32 v91, v91
    v_exp_f32 v92, v92
    v_exp_f32 v93, v93
    v_exp_f32 v94, v94
    v_exp_f32 v95, v95
    v_exp_f32 v96, v96
    v_exp_f32 v97, v97
    v_smfmac_f32_32x32x32_bf16 v[24:39], v[76:79], v[88:95], v112
    s_waitcnt lgkmcnt(0)
    v_exp_f32 v98, v98
    v_exp_f32 v99, v99
    v_exp_f32 v100, v100
    v_mfma_f32_32x32x16_bf16 v[80:95], v[56:59], v[16:19], 0
    v_exp_f32 v101, v101
    v_exp_f32 v102, v102
    v_exp_f32 v103, v103
    v_exp_f32 v104, v104
    v_exp_f32 v105, v105
    v_smfmac_f32_32x32x32_bf16 v[40:55], v[72:75], v[96:103], v112
    v_exp_f32 v106, v106
    v_exp_f32 v107, v107
    v_exp_f32 v108, v108
    v_exp_f32 v109, v109
    v_exp_f32 v110, v110
    v_exp_f32 v111, v111
    v_exp_f32 v80, v80
    v_exp_f32 v81, v81
    v_smfmac_f32_32x32x32_bf16 v[40:55], v[76:79], v[104:111], v112
    v_exp_f32 v82, v82
    v_exp_f32 v83, v83
    v_exp_f32 v84, v84
    v_mfma_f32_32x32x16_bf16 v[96:111], v[56:59], v[20:23], 0
    ds_read_b128 v[60:63], v113 offset:65472
    ds_read_b128 v[72:75], v114 offset:65472
    ds_read_b128 v[76:79], v115 offset:65472
    v_exp_f32 v85, v85
    v_exp_f32 v86, v86
    v_exp_f32 v87, v87
    v_exp_f32 v88, v88
    v_exp_f32 v89, v89
    v_smfmac_f32_32x32x32_bf16 v[24:39], v[64:67], v[80:87], v112
    v_exp_f32 v90, v90
    v_exp_f32 v91, v91
    v_exp_f32 v92, v92
    v_exp_f32 v93, v93
    v_exp_f32 v94, v94
    v_exp_f32 v95, v95
    v_exp_f32 v96, v96
    v_exp_f32 v97, v97
    v_smfmac_f32_32x32x32_bf16 v[24:39], v[68:71], v[88:95], v112
    s_waitcnt lgkmcnt(0)
    v_exp_f32 v98, v98
    v_exp_f32 v99, v99
    v_exp_f32 v100, v100
    v_mfma_f32_32x32x16_bf16 v[80:95], v[60:63], v[16:19], 0
    v_exp_f32 v101, v101
    v_exp_f32 v102, v102
    v_exp_f32 v103, v103
    v_exp_f32 v104, v104
    v_exp_f32 v105, v105
    v_smfmac_f32_32x32x32_bf16 v[40:55], v[64:67], v[96:103], v112
    v_exp_f32 v106, v106
    v_exp_f32 v107, v107
    v_exp_f32 v108, v108
    v_exp_f32 v109, v109
    v_exp_f32 v110, v110
    v_exp_f32 v111, v111
    v_exp_f32 v80, v80
    v_exp_f32 v81, v81
    v_smfmac_f32_32x32x32_bf16 v[40:55], v[68:71], v[104:111], v112
    v_exp_f32 v82, v82
    v_exp_f32 v83, v83
    v_exp_f32 v84, v84
    v_mfma_f32_32x32x16_bf16 v[96:111], v[60:63], v[20:23], 0
    v_add_u32 v113, 67552, v113
    v_add_u32 v114, 67552, v114
    v_add_u32 v115, 67552, v115
    ds_read_b128 v[56:59], v113 offset:0
    ds_read_b128 v[64:67], v114 offset:0
    ds_read_b128 v[68:71], v115 offset:0
    v_exp_f32 v85, v85
    v_exp_f32 v86, v86
    v_exp_f32 v87, v87
    v_exp_f32 v88, v88
    v_exp_f32 v89, v89
    v_smfmac_f32_32x32x32_bf16 v[24:39], v[72:75], v[80:87], v112
    v_exp_f32 v90, v90
    v_exp_f32 v91, v91
    v_exp_f32 v92, v92
    v_exp_f32 v93, v93
    v_exp_f32 v94, v94
    v_exp_f32 v95, v95
    v_exp_f32 v96, v96
    v_exp_f32 v97, v97
    v_smfmac_f32_32x32x32_bf16 v[24:39], v[76:79], v[88:95], v112
    s_waitcnt lgkmcnt(0)
    v_exp_f32 v98, v98
    v_exp_f32 v99, v99
    v_exp_f32 v100, v100
    v_mfma_f32_32x32x16_bf16 v[80:95], v[56:59], v[16:19], 0
    v_exp_f32 v101, v101
    v_exp_f32 v102, v102
    v_exp_f32 v103, v103
    v_exp_f32 v104, v104
    v_exp_f32 v105, v105
    v_smfmac_f32_32x32x32_bf16 v[40:55], v[72:75], v[96:103], v112
    v_exp_f32 v106, v106
    v_exp_f32 v107, v107
    v_exp_f32 v108, v108
    v_exp_f32 v109, v109
    v_exp_f32 v110, v110
    v_exp_f32 v111, v111
    v_exp_f32 v80, v80
    v_exp_f32 v81, v81
    v_smfmac_f32_32x32x32_bf16 v[40:55], v[76:79], v[104:111], v112
    v_exp_f32 v82, v82
    v_exp_f32 v83, v83
    v_exp_f32 v84, v84
    v_mfma_f32_32x32x16_bf16 v[96:111], v[56:59], v[20:23], 0
    ds_read_b128 v[60:63], v113 offset:2080
    ds_read_b128 v[72:75], v114 offset:2080
    ds_read_b128 v[76:79], v115 offset:2080
    v_exp_f32 v85, v85
    v_exp_f32 v86, v86
    v_exp_f32 v87, v87
    v_exp_f32 v88, v88
    v_exp_f32 v89, v89
    v_smfmac_f32_32x32x32_bf16 v[24:39], v[64:67], v[80:87], v112
    v_exp_f32 v90, v90
    v_exp_f32 v91, v91
    v_exp_f32 v92, v92
    v_exp_f32 v93, v93
    v_exp_f32 v94, v94
    v_exp_f32 v95, v95
    v_exp_f32 v96, v96
    v_exp_f32 v97, v97
    v_smfmac_f32_32x32x32_bf16 v[24:39], v[68:71], v[88:95], v112
    s_waitcnt lgkmcnt(0)
    v_exp_f32 v98, v98
    v_exp_f32 v99, v99
    v_exp_f32 v100, v100
    v_mfma_f32_32x32x16_bf16 v[80:95], v[60:63], v[16:19], 0
    v_exp_f32 v101, v101
    v_exp_f32 v102, v102
    v_exp_f32 v103, v103
    v_exp_f32 v104, v104
    v_exp_f32 v105, v105
    v_smfmac_f32_32x32x32_bf16 v[40:55], v[64:67], v[96:103], v112
    v_exp_f32 v106, v106
    v_exp_f32 v107, v107
    v_exp_f32 v108, v108
    v_exp_f32 v109, v109
    v_exp_f32 v110, v110
    v_exp_f32 v111, v111
    v_exp_f32 v80, v80
    v_exp_f32 v81, v81
    v_smfmac_f32_32x32x32_bf16 v[40:55], v[68:71], v[104:111], v112
    v_exp_f32 v82, v82
    v_exp_f32 v83, v83
    v_exp_f32 v84, v84
    v_mfma_f32_32x32x16_bf16 v[96:111], v[60:63], v[20:23], 0
    v_exp_f32 v85, v85
    v_exp_f32 v86, v86
    v_exp_f32 v87, v87
    v_exp_f32 v88, v88
    v_exp_f32 v89, v89
    v_smfmac_f32_32x32x32_bf16 v[24:39], v[72:75], v[80:87], v112
    v_exp_f32 v90, v90
    v_exp_f32 v91, v91
    v_exp_f32 v92, v92
    v_exp_f32 v93, v93
    v_exp_f32 v94, v94
    v_exp_f32 v95, v95
    v_exp_f32 v96, v96
    v_exp_f32 v97, v97
    v_smfmac_f32_32x32x32_bf16 v[24:39], v[76:79], v[88:95], v112
    s_waitcnt lgkmcnt(0)
    v_exp_f32 v98, v98
    v_exp_f32 v99, v99
    v_exp_f32 v100, v100
    v_exp_f32 v101, v101
    v_exp_f32 v102, v102
    v_exp_f32 v103, v103
    v_exp_f32 v104, v104
    v_exp_f32 v105, v105
    v_smfmac_f32_32x32x32_bf16 v[40:55], v[72:75], v[96:103], v112
    v_exp_f32 v106, v106
    v_exp_f32 v107, v107
    v_exp_f32 v108, v108
    v_exp_f32 v109, v109
    v_exp_f32 v110, v110
    v_exp_f32 v111, v111
    s_nop 1
    v_smfmac_f32_32x32x32_bf16 v[40:55], v[76:79], v[104:111], v112
    v_mul_f32 v12, 0, v24
    v_fmac_f32 v12, 0, v25
    v_fmac_f32 v12, 0, v26
    v_fmac_f32 v12, 0, v27
    v_fmac_f32 v12, 0, v28
    v_fmac_f32 v12, 0, v29
    v_fmac_f32 v12, 0, v30
    v_fmac_f32 v12, 0, v31
    v_fmac_f32 v12, 0, v32
    s_nop 3
    v_fmac_f32 v12, 0, v40
    v_fmac_f32 v12, 0, v41
    v_fmac_f32 v12, 0, v42
    v_fmac_f32 v12, 0, v43
    v_fmac_f32 v12, 0, v44
    v_fmac_f32 v12, 0, v45
    v_fmac_f32 v12, 0, v46
    v_fmac_f32 v12, 0, v47
    v_fmac_f32 v12, 0, v48
    v_min_f32 v13, v32, v48
    v_max_f32 v14, v32, v48
    v_cmp_u_f32 vcc, v12, v12
    s_mov_b64 s[42:43], vcc
    v_cmp_nle_f32 vcc, 0x1f800000, v13
    s_or_b64 s[42:43], s[42:43], vcc
    v_cmp_nge_f32 vcc, 0x71800000, v14
    s_or_b64 s[42:43], s[42:43], vcc
    s_cmp_lg_u64 s[42:43], 0
    s_cbranch_scc1 L_main_kernel_afb_23
L_main_kernel_afin_22:
    v_rcp_f32 v12, v32
    v_rcp_f32 v13, v48
    v_add_u32 v14, 131072, v5
    v_mul_f32 v24, v24, v12
    v_mul_f32 v25, v25, v12
    v_mul_f32 v26, v26, v12
    v_mul_f32 v27, v27, v12
    v_mul_f32 v28, v28, v12
    v_mul_f32 v29, v29, v12
    v_mul_f32 v30, v30, v12
    v_mul_f32 v31, v31, v12
    v_cvt_pk_bf16_f32 v80, v24, v25
    v_cvt_pk_bf16_f32 v81, v26, v27
    v_cvt_pk_bf16_f32 v82, v28, v29
    v_cvt_pk_bf16_f32 v83, v30, v31
    ds_write_b128 v14, v[80:83] offset:0
    v_mul_f32 v40, v40, v13
    v_mul_f32 v41, v41, v13
    v_mul_f32 v42, v42, v13
    v_mul_f32 v43, v43, v13
    v_mul_f32 v44, v44, v13
    v_mul_f32 v45, v45, v13
    v_mul_f32 v46, v46, v13
    v_mul_f32 v47, v47, v13
    v_cvt_pk_bf16_f32 v84, v40, v41
    v_cvt_pk_bf16_f32 v85, v42, v43
    v_cvt_pk_bf16_f32 v86, v44, v45
    v_cvt_pk_bf16_f32 v87, v46, v47
    ds_write_b128 v14, v[84:87] offset:16
    s_add_u32 s42, s101, 131072
    v_add_u32 v14, s42, v2
    s_add_u32 s42, s31, 7499776
    s_add_u32 s43, s31, 7503872
    s_waitcnt lgkmcnt(0)
    s_barrier
    ds_read_b128 v[88:91], v14
    ds_read_b128 v[92:95], v14 offset:1024
    s_waitcnt lgkmcnt(1)
    buffer_store_dwordx4 v[88:91], v121, s[4:7], s42 offen
    s_waitcnt lgkmcnt(0)
    buffer_store_dwordx4 v[92:95], v121, s[4:7], s43 offen
    s_waitcnt vmcnt(0)
    s_add_u32 s41, s18, 36139008
    v_mov_b32 v15, 1
    buffer_store_dword v15, v8, s[4:7], s41 offen
    s_add_u32 s42, s16, 5402624
    buffer_load_dwordx4 v[64:67], v2, s[4:7], s42 offen sc1
    buffer_load_dwordx4 v[68:71], v2, s[4:7], s42 offen offset:1024 sc1
    v_add_u32 v14, 131072, v2
    s_lshl_b32 s39, s3, 11
    s_add_u32 s38, s39, s17
    s_add_u32 s41, s19, 36139008
    s_mov_b32 s40, 0
L_main_kernel_poll_24:
    buffer_load_dword v15, v3, s[4:7], s41 offen sc1
    s_add_u32 s40, s40, 1
    s_waitcnt vmcnt(0)
    v_cmp_gt_u32 vcc, 1, v15
    s_cbranch_vccz L_main_kernel_polld_25
    s_cmp_lt_u32 s40, 262144
    s_cbranch_scc1 L_main_kernel_poll_24
L_main_kernel_polld_25:
    s_add_u32 m0, s39, 131072
    s_add_u32 s43, s38, 7499776
    buffer_load_dwordx4 v2, s[4:7], s43 offen offset:0 sc1 lds
    buffer_load_dwordx4 v2, s[4:7], s43 offen offset:1024 sc1 lds
    s_add_u32 m0, s39, 139264
    s_add_u32 s43, s38, 7507968
    buffer_load_dwordx4 v2, s[4:7], s43 offen offset:0 sc1 lds
    buffer_load_dwordx4 v2, s[4:7], s43 offen offset:1024 sc1 lds
    s_add_u32 m0, s39, 147456
    s_add_u32 s43, s38, 7516160
    buffer_load_dwordx4 v2, s[4:7], s43 offen offset:0 sc1 lds
    buffer_load_dwordx4 v2, s[4:7], s43 offen offset:1024 sc1 lds
    s_add_u32 m0, s39, 155648
    s_add_u32 s43, s38, 7524352
    buffer_load_dwordx4 v2, s[4:7], s43 offen offset:0 sc1 lds
    buffer_load_dwordx4 v2, s[4:7], s43 offen offset:1024 sc1 lds
    v_lshlrev_b32 v72, 16, v64
    v_and_b32 v73, 0xffff0000, v64
    v_lshlrev_b32 v74, 16, v65
    v_and_b32 v75, 0xffff0000, v65
    v_lshlrev_b32 v76, 16, v66
    v_and_b32 v77, 0xffff0000, v66
    v_lshlrev_b32 v78, 16, v67
    v_and_b32 v79, 0xffff0000, v67
    v_lshlrev_b32 v80, 16, v68
    v_and_b32 v81, 0xffff0000, v68
    v_lshlrev_b32 v82, 16, v69
    v_and_b32 v83, 0xffff0000, v69
    v_lshlrev_b32 v84, 16, v70
    v_and_b32 v85, 0xffff0000, v70
    v_lshlrev_b32 v86, 16, v71
    v_and_b32 v87, 0xffff0000, v71
    s_waitcnt vmcnt(6)
    s_barrier
    ds_read_b128 v[32:35], v14 offset:0
    ds_read_b128 v[36:39], v14 offset:1024
    ds_read_b128 v[40:43], v14 offset:2048
    ds_read_b128 v[44:47], v14 offset:3072
    ds_read_b128 v[48:51], v14 offset:4096
    ds_read_b128 v[52:55], v14 offset:5120
    ds_read_b128 v[56:59], v14 offset:6144
    s_waitcnt lgkmcnt(5)
    v_mfma_f32_32x32x16_bf16 v[16:31], a[0:3], v[32:35], v[72:87]
    ds_read_b128 v[60:63], v14 offset:7168
    v_mfma_f32_32x32x16_bf16 v[16:31], a[4:7], v[36:39], v[16:31]
    s_waitcnt vmcnt(0)
    s_barrier
    ds_read_b128 v[32:35], v14 offset:8192
    s_waitcnt lgkmcnt(5)
    v_mfma_f32_32x32x16_bf16 v[16:31], a[8:11], v[40:43], v[16:31]
    ds_read_b128 v[36:39], v14 offset:9216
    v_mfma_f32_32x32x16_bf16 v[16:31], a[12:15], v[44:47], v[16:31]
    ds_read_b128 v[40:43], v14 offset:10240
    s_waitcnt lgkmcnt(5)
    v_mfma_f32_32x32x16_bf16 v[16:31], a[16:19], v[48:51], v[16:31]
    ds_read_b128 v[44:47], v14 offset:11264
    v_mfma_f32_32x32x16_bf16 v[16:31], a[20:23], v[52:55], v[16:31]
    ds_read_b128 v[48:51], v14 offset:12288
    s_waitcnt lgkmcnt(5)
    v_mfma_f32_32x32x16_bf16 v[16:31], a[24:27], v[56:59], v[16:31]
    ds_read_b128 v[52:55], v14 offset:13312
    v_mfma_f32_32x32x16_bf16 v[16:31], a[28:31], v[60:63], v[16:31]
    ds_read_b128 v[56:59], v14 offset:14336
    s_waitcnt lgkmcnt(5)
    v_mfma_f32_32x32x16_bf16 v[16:31], a[32:35], v[32:35], v[16:31]
    ds_read_b128 v[60:63], v14 offset:15360
    v_mfma_f32_32x32x16_bf16 v[16:31], a[36:39], v[36:39], v[16:31]
    ds_read_b128 v[32:35], v14 offset:16384
    s_waitcnt lgkmcnt(5)
    v_mfma_f32_32x32x16_bf16 v[16:31], a[40:43], v[40:43], v[16:31]
    ds_read_b128 v[36:39], v14 offset:17408
    v_mfma_f32_32x32x16_bf16 v[16:31], a[44:47], v[44:47], v[16:31]
    ds_read_b128 v[40:43], v14 offset:18432
    s_waitcnt lgkmcnt(5)
    v_mfma_f32_32x32x16_bf16 v[16:31], a[48:51], v[48:51], v[16:31]
    ds_read_b128 v[44:47], v14 offset:19456
    v_mfma_f32_32x32x16_bf16 v[16:31], a[52:55], v[52:55], v[16:31]
    ds_read_b128 v[48:51], v14 offset:20480
    s_waitcnt lgkmcnt(5)
    v_mfma_f32_32x32x16_bf16 v[16:31], a[56:59], v[56:59], v[16:31]
    ds_read_b128 v[52:55], v14 offset:21504
    v_mfma_f32_32x32x16_bf16 v[16:31], a[60:63], v[60:63], v[16:31]
    ds_read_b128 v[56:59], v14 offset:22528
    s_waitcnt lgkmcnt(5)
    v_mfma_f32_32x32x16_bf16 v[16:31], a[64:67], v[32:35], v[16:31]
    ds_read_b128 v[60:63], v14 offset:23552
    v_mfma_f32_32x32x16_bf16 v[16:31], a[68:71], v[36:39], v[16:31]
    ds_read_b128 v[32:35], v14 offset:24576
    s_waitcnt lgkmcnt(5)
    v_mfma_f32_32x32x16_bf16 v[16:31], a[72:75], v[40:43], v[16:31]
    ds_read_b128 v[36:39], v14 offset:25600
    v_mfma_f32_32x32x16_bf16 v[16:31], a[76:79], v[44:47], v[16:31]
    ds_read_b128 v[40:43], v14 offset:26624
    s_waitcnt lgkmcnt(5)
    v_mfma_f32_32x32x16_bf16 v[16:31], a[80:83], v[48:51], v[16:31]
    ds_read_b128 v[44:47], v14 offset:27648
    v_mfma_f32_32x32x16_bf16 v[16:31], a[84:87], v[52:55], v[16:31]
    ds_read_b128 v[48:51], v14 offset:28672
    s_waitcnt lgkmcnt(5)
    v_mfma_f32_32x32x16_bf16 v[16:31], a[88:91], v[56:59], v[16:31]
    ds_read_b128 v[52:55], v14 offset:29696
    v_mfma_f32_32x32x16_bf16 v[16:31], a[92:95], v[60:63], v[16:31]
    ds_read_b128 v[56:59], v14 offset:30720
    s_waitcnt lgkmcnt(5)
    v_mfma_f32_32x32x16_bf16 v[16:31], a[96:99], v[32:35], v[16:31]
    ds_read_b128 v[60:63], v14 offset:31744
    v_mfma_f32_32x32x16_bf16 v[16:31], a[100:103], v[36:39], v[16:31]
    s_waitcnt lgkmcnt(4)
    v_mfma_f32_32x32x16_bf16 v[16:31], a[104:107], v[40:43], v[16:31]
    v_mfma_f32_32x32x16_bf16 v[16:31], a[108:111], v[44:47], v[16:31]
    s_waitcnt lgkmcnt(2)
    v_mfma_f32_32x32x16_bf16 v[16:31], a[112:115], v[48:51], v[16:31]
    v_mfma_f32_32x32x16_bf16 v[16:31], a[116:119], v[52:55], v[16:31]
    s_waitcnt lgkmcnt(0)
    v_mfma_f32_32x32x16_bf16 v[16:31], a[120:123], v[56:59], v[16:31]
    v_mfma_f32_32x32x16_bf16 v[16:31], a[124:127], v[60:63], v[16:31]
    v_and_b32 v12, 0xffff, v6
    s_add_u32 s42, s16, 5402624
    s_nop 9
    v_cvt_pk_bf16_f32 v48, v16, v17
    v_cvt_pk_bf16_f32 v49, v18, v19
    v_cvt_pk_bf16_f32 v50, v20, v21
    v_cvt_pk_bf16_f32 v51, v22, v23
    buffer_store_dwordx4 v[48:51], v2, s[4:7], s42 offen offset:0
    v_cvt_pk_bf16_f32 v52, v24, v25
    v_cvt_pk_bf16_f32 v53, v26, v27
    v_cvt_pk_bf16_f32 v54, v28, v29
    v_cvt_pk_bf16_f32 v55, v30, v31
    buffer_store_dwordx4 v[52:55], v2, s[4:7], s42 offen offset:1024
    v_pk_mul_f32 v[58:59], v[16:17], v[16:17]
    v_pk_add_f32 v[56:57], v[16:17], v[18:19]
    v_pk_fma_f32 v[58:59], v[18:19], v[18:19], v[58:59]
    v_pk_fma_f32 v[58:59], v[20:21], v[20:21], v[58:59]
    v_pk_add_f32 v[56:57], v[56:57], v[20:21]
    v_pk_fma_f32 v[58:59], v[22:23], v[22:23], v[58:59]
    v_pk_add_f32 v[56:57], v[56:57], v[22:23]
    v_pk_fma_f32 v[58:59], v[24:25], v[24:25], v[58:59]
    v_pk_add_f32 v[56:57], v[56:57], v[24:25]
    v_pk_fma_f32 v[58:59], v[26:27], v[26:27], v[58:59]
    v_pk_add_f32 v[56:57], v[56:57], v[26:27]
    v_pk_fma_f32 v[58:59], v[28:29], v[28:29], v[58:59]
    v_pk_add_f32 v[56:57], v[56:57], v[28:29]
    v_pk_fma_f32 v[58:59], v[30:31], v[30:31], v[58:59]
    v_pk_add_f32 v[56:57], v[56:57], v[30:31]
    v_add_f32 v56, v56, v57
    v_add_f32 v57, v58, v59
    v_mov_b32 v58, v56
    v_mov_b32 v59, v57
    s_add_u32 s42, s30, 13791232
    s_nop 0
    v_permlane32_swap_b32 v56, v58
    v_permlane32_swap_b32 v57, v59
    s_nop 0
    v_add_f32 v56, v56, v58
    v_add_f32 v57, v57, v59
    buffer_store_dwordx2 v[56:57], v12, s[4:7], s42 offen
    s_waitcnt vmcnt(0)
    s_add_u32 s41, s18, 36270080
    v_mov_b32 v15, 1
    buffer_store_dword v15, v8, s[4:7], s41 offen
    v_add_u32 v14, 0x10000, v2
    v_add_u32 v13, 0x20000, v2
    s_add_u32 s42, s35, 5312512
    buffer_load_dwordx4 v[108:111], v2, s[4:7], s42 offen
    s_add_u32 s42, s35, 5313536
    buffer_load_dwordx4 v[112:115], v2, s[4:7], s42 offen
    s_add_u32 s41, s20, 36270080
    s_mov_b32 s40, 0
L_main_kernel_poll_26:
    buffer_load_dword v15, v3, s[4:7], s41 offen sc1
    s_add_u32 s40, s40, 1
    s_waitcnt vmcnt(0)
    v_cmp_gt_u32 vcc, 1, v15
    s_cbranch_vccz L_main_kernel_polld_27
    s_cmp_lt_u32 s40, 262144
    s_cbranch_scc1 L_main_kernel_poll_26
L_main_kernel_polld_27:
    s_add_u32 s38, s22, 5402624
    buffer_load_dwordx4 a[0:3], v2, s[4:7], s38 offen offset:0 sc1
    buffer_load_dwordx4 a[4:7], v2, s[4:7], s38 offen offset:1024 sc1
    buffer_load_dwordx4 a[8:11], v2, s[4:7], s38 offen offset:2048 sc1
    buffer_load_dwordx4 a[12:15], v2, s[4:7], s38 offen offset:3072 sc1
    s_add_u32 s38, s22, 5406720
    buffer_load_dwordx4 a[16:19], v2, s[4:7], s38 offen offset:0 sc1
    buffer_load_dwordx4 a[20:23], v2, s[4:7], s38 offen offset:1024 sc1
    buffer_load_dwordx4 a[24:27], v2, s[4:7], s38 offen offset:2048 sc1
    buffer_load_dwordx4 a[28:31], v2, s[4:7], s38 offen offset:3072 sc1
    ds_read_b128 v[64:67], v2 offset:0
    ds_read_b128 v[68:71], v2 offset:32768
    ds_read_b128 v[72:75], v2 offset:1024
    ds_read_b128 v[76:79], v2 offset:33792
    ds_read_b128 v[80:83], v2 offset:2048
    ds_read_b128 v[84:87], v2 offset:34816
    ds_read_b128 v[88:91], v2 offset:3072
    s_waitcnt lgkmcnt(5)
    s_add_u32 s38, s22, 5410816
    buffer_load_dwordx4 a[32:35], v2, s[4:7], s38 offen offset:0 sc1
    s_waitcnt vmcnt(8)
    v_mfma_f32_32x32x16_bf16 v[16:31], v[64:67], a[0:3], 0
    ds_read_b128 v[92:95], v2 offset:35840
    v_mfma_f32_32x32x16_bf16 v[32:47], v[68:71], a[0:3], 0
    ds_read_b128 v[64:67], v2 offset:4096
    s_waitcnt lgkmcnt(5)
    s_add_u32 s42, s34, 13791232
    buffer_load_dwordx2 v[48:49], v6, s[4:7], s42 offen sc1
    buffer_load_dwordx4 a[36:39], v2, s[4:7], s38 offen offset:1024 sc1
    s_waitcnt vmcnt(9)
    v_mfma_f32_32x32x16_bf16 v[16:31], v[72:75], a[4:7], v[16:31]
    ds_read_b128 v[68:71], v2 offset:36864
    v_mfma_f32_32x32x16_bf16 v[32:47], v[76:79], a[4:7], v[32:47]
    ds_read_b128 v[72:75], v2 offset:5120
    s_waitcnt lgkmcnt(5)
    s_add_u32 s42, s34, 13807616
    buffer_load_dwordx2 v[50:51], v6, s[4:7], s42 offen sc1
    buffer_load_dwordx4 a[40:43], v2, s[4:7], s38 offen offset:2048 sc1
    s_waitcnt vmcnt(10)
    v_mfma_f32_32x32x16_bf16 v[16:31], v[80:83], a[8:11], v[16:31]
    ds_read_b128 v[76:79], v2 offset:37888
    v_mfma_f32_32x32x16_bf16 v[32:47], v[84:87], a[8:11], v[32:47]
    ds_read_b128 v[80:83], v2 offset:6144
    s_waitcnt lgkmcnt(5)
    s_add_u32 s42, s34, 13824000
    buffer_load_dwordx2 v[52:53], v6, s[4:7], s42 offen sc1
    buffer_load_dwordx4 a[44:47], v2, s[4:7], s38 offen offset:3072 sc1
    s_waitcnt vmcnt(11)
    v_mfma_f32_32x32x16_bf16 v[16:31], v[88:91], a[12:15], v[16:31]
    ds_read_b128 v[84:87], v2 offset:38912
    v_mfma_f32_32x32x16_bf16 v[32:47], v[92:95], a[12:15], v[32:47]
    ds_read_b128 v[88:91], v2 offset:7168
    s_waitcnt lgkmcnt(5)
    s_add_u32 s42, s34, 13840384
    buffer_load_dwordx2 v[54:55], v6, s[4:7], s42 offen sc1
    s_add_u32 s38, s22, 5414912
    buffer_load_dwordx4 a[48:51], v2, s[4:7], s38 offen offset:0 sc1
    s_waitcnt vmcnt(12)
    v_mfma_f32_32x32x16_bf16 v[16:31], v[64:67], a[16:19], v[16:31]
    ds_read_b128 v[92:95], v2 offset:39936
    v_mfma_f32_32x32x16_bf16 v[32:47], v[68:71], a[16:19], v[32:47]
    ds_read_b128 v[64:67], v2 offset:8192
    s_waitcnt lgkmcnt(5)
    s_add_u32 s42, s34, 13856768
    buffer_load_dwordx2 v[56:57], v6, s[4:7], s42 offen sc1
    buffer_load_dwordx4 a[52:55], v2, s[4:7], s38 offen offset:1024 sc1
    s_waitcnt vmcnt(13)
    v_mfma_f32_32x32x16_bf16 v[16:31], v[72:75], a[20:23], v[16:31]
    ds_read_b128 v[68:71], v2 offset:40960
    v_mfma_f32_32x32x16_bf16 v[32:47], v[76:79], a[20:23], v[32:47]
    ds_read_b128 v[72:75], v2 offset:9216
    s_waitcnt lgkmcnt(5)
    s_add_u32 s42, s34, 13873152
    buffer_load_dwordx2 v[58:59], v6, s[4:7], s42 offen sc1
    buffer_load_dwordx4 a[56:59], v2, s[4:7], s38 offen offset:2048 sc1
    s_waitcnt vmcnt(14)
    v_mfma_f32_32x32x16_bf16 v[16:31], v[80:83], a[24:27], v[16:31]
    ds_read_b128 v[76:79], v2 offset:41984
    v_mfma_f32_32x32x16_bf16 v[32:47], v[84:87], a[24:27], v[32:47]
    ds_read_b128 v[80:83], v2 offset:10240
    s_waitcnt lgkmcnt(5)
    s_add_u32 s42, s34, 13889536
    buffer_load_dwordx2 v[60:61], v6, s[4:7], s42 offen sc1
    buffer_load_dwordx4 a[60:63], v2, s[4:7], s38 offen offset:3072 sc1
    s_waitcnt vmcnt(15)
    v_mfma_f32_32x32x16_bf16 v[16:31], v[88:91], a[28:31], v[16:31]
    ds_read_b128 v[84:87], v2 offset:43008
    v_mfma_f32_32x32x16_bf16 v[32:47], v[92:95], a[28:31], v[32:47]
    ds_read_b128 v[88:91], v2 offset:11264
    s_waitcnt lgkmcnt(5)
    s_add_u32 s42, s34, 13905920
    buffer_load_dwordx2 v[62:63], v6, s[4:7], s42 offen sc1
    s_add_u32 s38, s22, 5419008
    buffer_load_dwordx4 a[64:67], v2, s[4:7], s38 offen offset:0 sc1
    s_waitcnt vmcnt(16)
    v_mfma_f32_32x32x16_bf16 v[16:31], v[64:67], a[32:35], v[16:31]
    ds_read_b128 v[92:95], v2 offset:44032
    v_mfma_f32_32x32x16_bf16 v[32:47], v[68:71], a[32:35], v[32:47]
    ds_read_b128 v[64:67], v2 offset:12288
    s_waitcnt lgkmcnt(5)
    buffer_load_dwordx4 a[68:71], v2, s[4:7], s38 offen offset:1024 sc1
    s_waitcnt vmcnt(15)
    v_mfma_f32_32x32x16_bf16 v[16:31], v[72:75], a[36:39], v[16:31]
    ds_read_b128 v[68:71], v2 offset:45056
    v_mfma_f32_32x32x16_bf16 v[32:47], v[76:79], a[36:39], v[32:47]
    ds_read_b128 v[72:75], v2 offset:13312
    s_waitcnt lgkmcnt(5)
    buffer_load_dwordx4 a[72:75], v2, s[4:7], s38 offen offset:2048 sc1
    s_waitcnt vmcnt(14)
    v_mfma_f32_32x32x16_bf16 v[16:31], v[80:83], a[40:43], v[16:31]
    ds_read_b128 v[76:79], v2 offset:46080
    v_mfma_f32_32x32x16_bf16 v[32:47], v[84:87], a[40:43], v[32:47]
    ds_read_b128 v[80:83], v2 offset:14336
    s_waitcnt lgkmcnt(5)
    buffer_load_dwordx4 a[76:79], v2, s[4:7], s38 offen offset:3072 sc1
    s_waitcnt vmcnt(13)
    v_mfma_f32_32x32x16_bf16 v[16:31], v[88:91], a[44:47], v[16:31]
    ds_read_b128 v[84:87], v2 offset:47104
    v_mfma_f32_32x32x16_bf16 v[32:47], v[92:95], a[44:47], v[32:47]
    ds_read_b128 v[88:91], v2 offset:15360
    s_waitcnt lgkmcnt(5)
    s_add_u32 s38, s22, 5423104
    buffer_load_dwordx4 a[80:83], v2, s[4:7], s38 offen offset:0 sc1
    s_waitcnt vmcnt(12)
    v_mfma_f32_32x32x16_bf16 v[16:31], v[64:67], a[48:51], v[16:31]
    ds_read_b128 v[92:95], v2 offset:48128
    v_mfma_f32_32x32x16_bf16 v[32:47], v[68:71], a[48:51], v[32:47]
    ds_read_b128 v[64:67], v2 offset:16384
    s_waitcnt lgkmcnt(5)
    buffer_load_dwordx4 a[84:87], v2, s[4:7], s38 offen offset:1024 sc1
    s_waitcnt vmcnt(11)
    v_mfma_f32_32x32x16_bf16 v[16:31], v[72:75], a[52:55], v[16:31]
    ds_read_b128 v[68:71], v2 offset:49152
    v_mfma_f32_32x32x16_bf16 v[32:47], v[76:79], a[52:55], v[32:47]
    ds_read_b128 v[72:75], v2 offset:17408
    s_waitcnt lgkmcnt(5)
    buffer_load_dwordx4 a[88:91], v2, s[4:7], s38 offen offset:2048 sc1
    s_waitcnt vmcnt(10)
    v_mfma_f32_32x32x16_bf16 v[16:31], v[80:83], a[56:59], v[16:31]
    ds_read_b128 v[76:79], v2 offset:50176
    v_mfma_f32_32x32x16_bf16 v[32:47], v[84:87], a[56:59], v[32:47]
    ds_read_b128 v[80:83], v2 offset:18432
    s_waitcnt lgkmcnt(5)
    buffer_load_dwordx4 a[92:95], v2, s[4:7], s38 offen offset:3072 sc1
    s_waitcnt vmcnt(9)
    v_mfma_f32_32x32x16_bf16 v[16:31], v[88:91], a[60:63], v[16:31]
    ds_read_b128 v[84:87], v2 offset:51200
    v_mfma_f32_32x32x16_bf16 v[32:47], v[92:95], a[60:63], v[32:47]
    ds_read_b128 v[88:91], v2 offset:19456
    s_waitcnt lgkmcnt(5)
    s_add_u32 s38, s22, 5427200
    buffer_load_dwordx4 a[96:99], v2, s[4:7], s38 offen offset:0 sc1
    s_waitcnt vmcnt(8)
    v_mfma_f32_32x32x16_bf16 v[16:31], v[64:67], a[64:67], v[16:31]
    ds_read_b128 v[92:95], v2 offset:52224
    v_mfma_f32_32x32x16_bf16 v[32:47], v[68:71], a[64:67], v[32:47]
    ds_read_b128 v[64:67], v2 offset:20480
    s_waitcnt lgkmcnt(5)
    buffer_load_dwordx4 a[100:103], v2, s[4:7], s38 offen offset:1024 sc1
    s_waitcnt vmcnt(8)
    v_mfma_f32_32x32x16_bf16 v[16:31], v[72:75], a[68:71], v[16:31]
    ds_read_b128 v[68:71], v2 offset:53248
    v_mfma_f32_32x32x16_bf16 v[32:47], v[76:79], a[68:71], v[32:47]
    ds_read_b128 v[72:75], v2 offset:21504
    s_waitcnt lgkmcnt(5)
    buffer_load_dwordx4 a[104:107], v2, s[4:7], s38 offen offset:2048 sc1
    s_waitcnt vmcnt(8)
    v_mfma_f32_32x32x16_bf16 v[16:31], v[80:83], a[72:75], v[16:31]
    ds_read_b128 v[76:79], v2 offset:54272
    v_mfma_f32_32x32x16_bf16 v[32:47], v[84:87], a[72:75], v[32:47]
    ds_read_b128 v[80:83], v2 offset:22528
    s_waitcnt lgkmcnt(5)
    buffer_load_dwordx4 a[108:111], v2, s[4:7], s38 offen offset:3072 sc1
    s_waitcnt vmcnt(8)
    v_mfma_f32_32x32x16_bf16 v[16:31], v[88:91], a[76:79], v[16:31]
    ds_read_b128 v[84:87], v2 offset:55296
    v_mfma_f32_32x32x16_bf16 v[32:47], v[92:95], a[76:79], v[32:47]
    ds_read_b128 v[88:91], v2 offset:23552
    s_waitcnt lgkmcnt(5)
    s_add_u32 s38, s22, 5431296
    buffer_load_dwordx4 a[112:115], v2, s[4:7], s38 offen offset:0 sc1
    s_waitcnt vmcnt(8)
    v_mfma_f32_32x32x16_bf16 v[16:31], v[64:67], a[80:83], v[16:31]
    ds_read_b128 v[92:95], v2 offset:56320
    v_mfma_f32_32x32x16_bf16 v[32:47], v[68:71], a[80:83], v[32:47]
    ds_read_b128 v[64:67], v2 offset:24576
    s_waitcnt lgkmcnt(5)
    v_add_f32 v48, v48, v50
    buffer_load_dwordx4 a[116:119], v2, s[4:7], s38 offen offset:1024 sc1
    s_waitcnt vmcnt(8)
    v_mfma_f32_32x32x16_bf16 v[16:31], v[72:75], a[84:87], v[16:31]
    ds_read_b128 v[68:71], v2 offset:57344
    v_add_f32 v49, v49, v51
    v_mfma_f32_32x32x16_bf16 v[32:47], v[76:79], a[84:87], v[32:47]
    ds_read_b128 v[72:75], v2 offset:25600
    s_waitcnt lgkmcnt(5)
    v_add_f32 v48, v48, v52
    buffer_load_dwordx4 a[120:123], v2, s[4:7], s38 offen offset:2048 sc1
    s_waitcnt vmcnt(8)
    v_mfma_f32_32x32x16_bf16 v[16:31], v[80:83], a[88:91], v[16:31]
    ds_read_b128 v[76:79], v2 offset:58368
    v_add_f32 v49, v49, v53
    v_mfma_f32_32x32x16_bf16 v[32:47], v[84:87], a[88:91], v[32:47]
    ds_read_b128 v[80:83], v2 offset:26624
    s_waitcnt lgkmcnt(5)
    v_add_f32 v48, v48, v54
    buffer_load_dwordx4 a[124:127], v2, s[4:7], s38 offen offset:3072 sc1
    s_waitcnt vmcnt(8)
    v_mfma_f32_32x32x16_bf16 v[16:31], v[88:91], a[92:95], v[16:31]
    ds_read_b128 v[84:87], v2 offset:59392
    v_add_f32 v49, v49, v55
    v_mfma_f32_32x32x16_bf16 v[32:47], v[92:95], a[92:95], v[32:47]
    ds_read_b128 v[88:91], v2 offset:27648
    s_waitcnt lgkmcnt(5)
    v_add_f32 v48, v48, v56
    s_waitcnt vmcnt(7)
    v_mfma_f32_32x32x16_bf16 v[16:31], v[64:67], a[96:99], v[16:31]
    ds_read_b128 v[92:95], v2 offset:60416
    v_add_f32 v49, v49, v57
    v_mfma_f32_32x32x16_bf16 v[32:47], v[68:71], a[96:99], v[32:47]
    ds_read_b128 v[64:67], v2 offset:28672
    s_waitcnt lgkmcnt(5)
    v_add_f32 v48, v48, v58
    s_waitcnt vmcnt(6)
    v_mfma_f32_32x32x16_bf16 v[16:31], v[72:75], a[100:103], v[16:31]
    ds_read_b128 v[68:71], v2 offset:61440
    v_add_f32 v49, v49, v59
    v_mfma_f32_32x32x16_bf16 v[32:47], v[76:79], a[100:103], v[32:47]
    ds_read_b128 v[72:75], v2 offset:29696
    s_waitcnt lgkmcnt(5)
    v_add_f32 v48, v48, v60
    s_waitcnt vmcnt(5)
    v_mfma_f32_32x32x16_bf16 v[16:31], v[80:83], a[104:107], v[16:31]
    ds_read_b128 v[76:79], v2 offset:62464
    v_add_f32 v49, v49, v61
    v_mfma_f32_32x32x16_bf16 v[32:47], v[84:87], a[104:107], v[32:47]
    ds_read_b128 v[80:83], v2 offset:30720
    s_waitcnt lgkmcnt(5)
    v_add_f32 v48, v48, v62
    s_waitcnt vmcnt(4)
    v_mfma_f32_32x32x16_bf16 v[16:31], v[88:91], a[108:111], v[16:31]
    ds_read_b128 v[84:87], v2 offset:63488
    v_add_f32 v49, v49, v63
    v_mfma_f32_32x32x16_bf16 v[32:47], v[92:95], a[108:111], v[32:47]
    ds_read_b128 v[88:91], v2 offset:31744
    s_waitcnt lgkmcnt(5)
    v_mov_b32 v50, v48
    v_mov_b32 v51, v49
    s_nop 1
    v_permlane32_swap_b32 v48, v50
    v_permlane32_swap_b32 v49, v51
    s_nop 1
    v_add_f32 v48, v48, v50
    v_add_f32 v49, v49, v51
    s_waitcnt vmcnt(3)
    v_mfma_f32_32x32x16_bf16 v[16:31], v[64:67], a[112:115], v[16:31]
    ds_read_b128 v[92:95], v2 offset:64512
    v_mul_f32 v10, 0x3b000000, v48
    v_mul_f32 v12, 0x3b000000, v49
    v_fma_f32 v12, -v10, v10, v12
    v_max_f32 v12, 0, v12
    v_mfma_f32_32x32x16_bf16 v[32:47], v[68:71], a[112:115], v[32:47]
    ds_read_b128 v[64:67], v14 offset:0
    s_waitcnt lgkmcnt(5)
    v_add_f32 v12, 0x3727c5ac, v12
    v_rsq_f32 v11, v12
    s_nop 0
    s_waitcnt vmcnt(2)
    v_mfma_f32_32x32x16_bf16 v[16:31], v[72:75], a[116:119], v[16:31]
    ds_read_b128 v[68:71], v14 offset:1024
    v_mov_b32 v122, v12
    v_mul_f32 v120, 0xc0135761, v11
    v_mul_f32 v15, v11, v11
    v_mul_f32 v15, v15, v11
    v_mfma_f32_32x32x16_bf16 v[32:47], v[76:79], a[116:119], v[32:47]
    ds_read_b128 v[72:75], v14 offset:2048
    s_waitcnt lgkmcnt(5)
    v_mul_f32 v121, 0xbdd2d3e8, v15
    v_sub_f32 v12, 0, v10
    v_cvt_pk_bf16_f32 v116, v12, v12
    v_and_b32 v15, 0xffff0000, v116
    s_waitcnt vmcnt(1)
    v_mfma_f32_32x32x16_bf16 v[16:31], v[80:83], a[120:123], v[16:31]
    ds_read_b128 v[76:79], v14 offset:3072
    v_sub_f32 v15, v12, v15
    v_cvt_pk_bf16_f32 v117, v15, v8
    v_mov_b32 v118, v116
    v_mov_b32 v119, v117
    v_mfma_f32_32x32x16_bf16 v[32:47], v[84:87], a[120:123], v[32:47]
    ds_read_b128 v[80:83], v14 offset:4096
    s_waitcnt lgkmcnt(5)
    s_waitcnt vmcnt(0)
    v_mfma_f32_32x32x16_bf16 v[16:31], v[88:91], a[124:127], v[16:31]
    ds_read_b128 v[84:87], v14 offset:5120
    v_mfma_f32_32x32x16_bf16 v[32:47], v[92:95], a[124:127], v[32:47]
    s_barrier
    ds_read_b128 v[88:91], v14 offset:6144
    s_waitcnt lgkmcnt(5)
    v_mfma_f32_32x32x16_bf16 v[16:31], v[108:111], v[116:119], v[16:31]
    s_add_u32 s42, s35, 5314560
    buffer_load_dwordx4 v[108:111], v2, s[4:7], s42 offen
    v_mfma_f32_32x32x16_bf16 v[32:47], v[112:115], v[116:119], v[32:47]
    s_add_u32 s42, s35, 5315584
    buffer_load_dwordx4 v[112:115], v2, s[4:7], s42 offen
    v_mfma_f32_32x32x16_bf16 v[48:63], v[64:67], a[0:3], 0
    ds_read_b128 v[92:95], v14 offset:7168
    v_mfma_f32_32x32x16_bf16 v[48:63], v[68:71], a[4:7], v[48:63]
    ds_read_b128 v[64:67], v14 offset:8192
    s_waitcnt lgkmcnt(5)
    v_mfma_f32_32x32x16_bf16 v[48:63], v[72:75], a[8:11], v[48:63]
    ds_read_b128 v[68:71], v14 offset:9216
    v_mfma_f32_32x32x16_bf16 v[48:63], v[76:79], a[12:15], v[48:63]
    ds_read_b128 v[72:75], v14 offset:10240
    s_waitcnt lgkmcnt(5)
    v_mfma_f32_32x32x16_bf16 v[48:63], v[80:83], a[16:19], v[48:63]
    ds_read_b128 v[76:79], v14 offset:11264
    v_mfma_f32_32x32x16_bf16 v[48:63], v[84:87], a[20:23], v[48:63]
    ds_read_b128 v[80:83], v14 offset:12288
    s_waitcnt lgkmcnt(5)
    v_mul_f32 v96, v16, v16
    v_mul_f32 v97, v17, v17
    v_mul_f32 v98, v18, v18
    v_mul_f32 v99, v19, v19
    v_mfma_f32_32x32x16_bf16 v[48:63], v[88:91], a[24:27], v[48:63]
    ds_read_b128 v[84:87], v14 offset:13312
    v_mul_f32 v100, v20, v20
    v_mul_f32 v101, v21, v21
    v_mul_f32 v102, v22, v22
    v_mfma_f32_32x32x16_bf16 v[48:63], v[92:95], a[28:31], v[48:63]
    ds_read_b128 v[88:91], v14 offset:14336
    s_waitcnt lgkmcnt(5)
    v_mul_f32 v103, v23, v23
    v_fma_f32 v96, v96, v121, v120
    v_fma_f32 v97, v97, v121, v120
    v_fma_f32 v98, v98, v121, v120
    v_mfma_f32_32x32x16_bf16 v[48:63], v[64:67], a[32:35], v[48:63]
    ds_read_b128 v[92:95], v14 offset:15360
    s_add_u32 m0, s26, 131072
    s_add_u32 s43, s25, 1212416
    buffer_load_dwordx4 v2, s[4:7], s43 offen offset:0  lds
    v_fma_f32 v99, v99, v121, v120
    v_fma_f32 v100, v100, v121, v120
    v_mfma_f32_32x32x16_bf16 v[48:63], v[68:71], a[36:39], v[48:63]
    ds_read_b128 v[64:67], v14 offset:16384
    s_waitcnt lgkmcnt(5)
    v_fma_f32 v101, v101, v121, v120
    v_fma_f32 v102, v102, v121, v120
    v_fma_f32 v103, v103, v121, v120
    v_mul_f32 v96, v96, v16
    v_mfma_f32_32x32x16_bf16 v[48:63], v[72:75], a[40:43], v[48:63]
    ds_read_b128 v[68:71], v14 offset:17408
    v_mul_f32 v97, v97, v17
    v_mul_f32 v98, v98, v18
    v_mul_f32 v99, v99, v19
    v_mfma_f32_32x32x16_bf16 v[48:63], v[76:79], a[44:47], v[48:63]
    ds_read_b128 v[72:75], v14 offset:18432
    s_waitcnt lgkmcnt(5)
    v_mul_f32 v100, v100, v20
    v_mul_f32 v101, v101, v21
    buffer_load_dwordx4 v2, s[4:7], s43 offen offset:1024  lds
    v_mul_f32 v102, v102, v22
    v_mfma_f32_32x32x16_bf16 v[48:63], v[80:83], a[48:51], v[48:63]
    ds_read_b128 v[76:79], v14 offset:19456
    v_mul_f32 v103, v103, v23
    v_exp_f32 v96, v96
    v_mul_f32 v16, v16, v24
    v_mfma_f32_32x32x16_bf16 v[48:63], v[84:87], a[52:55], v[48:63]
    ds_read_b128 v[80:83], v14 offset:20480
    s_waitcnt lgkmcnt(5)
    v_exp_f32 v97, v97
    v_mul_f32 v17, v17, v25
    v_exp_f32 v98, v98
    v_mul_f32 v18, v18, v26
    v_mfma_f32_32x32x16_bf16 v[48:63], v[88:91], a[56:59], v[48:63]
    ds_read_b128 v[84:87], v14 offset:21504
    v_exp_f32 v99, v99
    v_mul_f32 v19, v19, v27
    v_exp_f32 v100, v100
    v_mfma_f32_32x32x16_bf16 v[48:63], v[92:95], a[60:63], v[48:63]
    ds_read_b128 v[88:91], v14 offset:22528
    s_waitcnt lgkmcnt(5)
    buffer_load_dwordx4 v2, s[4:7], s43 offen offset:2048  lds
    v_mul_f32 v20, v20, v28
    v_exp_f32 v101, v101
    v_mul_f32 v21, v21, v29
    v_mfma_f32_32x32x16_bf16 v[48:63], v[64:67], a[64:67], v[48:63]
    ds_read_b128 v[92:95], v14 offset:23552
    v_exp_f32 v102, v102
    v_mul_f32 v22, v22, v30
    v_exp_f32 v103, v103
    v_mfma_f32_32x32x16_bf16 v[48:63], v[68:71], a[68:71], v[48:63]
    ds_read_b128 v[64:67], v14 offset:24576
    s_waitcnt lgkmcnt(5)
    v_mul_f32 v23, v23, v31
    v_fma_f32 v96, v96, v122, v122
    v_fma_f32 v97, v97, v122, v122
    v_fma_f32 v98, v98, v122, v122
    v_mfma_f32_32x32x16_bf16 v[48:63], v[72:75], a[72:75], v[48:63]
    ds_read_b128 v[68:71], v14 offset:25600
    buffer_load_dwordx4 v2, s[4:7], s43 offen offset:3072  lds
    v_fma_f32 v99, v99, v122, v122
    v_fma_f32 v100, v100, v122, v122
    v_mfma_f32_32x32x16_bf16 v[48:63], v[76:79], a[76:79], v[48:63]
    ds_read_b128 v[72:75], v14 offset:26624
    s_waitcnt lgkmcnt(5)
    v_fma_f32 v101, v101, v122, v122
    v_fma_f32 v102, v102, v122, v122
    v_fma_f32 v103, v103, v122, v122
    v_rcp_f32 v96, v96
    v_mfma_f32_32x32x16_bf16 v[48:63], v[80:83], a[80:83], v[48:63]
    ds_read_b128 v[76:79], v14 offset:27648
    v_rcp_f32 v97, v97
    v_mul_f32 v16, v16, v96
    v_rcp_f32 v98, v98
    v_mfma_f32_32x32x16_bf16 v[48:63], v[84:87], a[84:87], v[48:63]
    ds_read_b128 v[80:83], v14 offset:28672
    s_waitcnt lgkmcnt(5)
    v_mul_f32 v17, v17, v97
    v_rcp_f32 v99, v99
    s_add_u32 m0, s26, 135168
    s_add_u32 s43, s25, 1216512
    buffer_load_dwordx4 v2, s[4:7], s43 offen offset:0  lds
    v_mul_f32 v18, v18, v98
    v_mfma_f32_32x32x16_bf16 v[48:63], v[88:91], a[88:91], v[48:63]
    ds_read_b128 v[84:87], v14 offset:29696
    v_rcp_f32 v100, v100
    v_mul_f32 v19, v19, v99
    v_rcp_f32 v101, v101
    v_mfma_f32_32x32x16_bf16 v[48:63], v[92:95], a[92:95], v[48:63]
    ds_read_b128 v[88:91], v14 offset:30720
    s_waitcnt lgkmcnt(5)
    v_mul_f32 v20, v20, v100
    v_rcp_f32 v102, v102
    v_mul_f32 v21, v21, v101
    v_rcp_f32 v103, v103
    v_mfma_f32_32x32x16_bf16 v[48:63], v[64:67], a[96:99], v[48:63]
    ds_read_b128 v[92:95], v14 offset:31744
    v_mul_f32 v22, v22, v102
    v_cvt_pk_bf16_f32 v104, v16, v17
    v_mul_f32 v23, v23, v103
    v_mfma_f32_32x32x16_bf16 v[48:63], v[68:71], a[100:103], v[48:63]
    ds_read_b128 v[64:67], v14 offset:32768
    s_waitcnt lgkmcnt(5)
    buffer_load_dwordx4 v2, s[4:7], s43 offen offset:1024  lds
    v_cvt_pk_bf16_f32 v105, v18, v19
    v_cvt_pk_bf16_f32 v106, v20, v21
    v_cvt_pk_bf16_f32 v107, v22, v23
    v_mfma_f32_32x32x16_bf16 v[48:63], v[72:75], a[104:107], v[48:63]
    ds_read_b128 v[68:71], v14 offset:33792
    s_add_u32 s42, s28, 14602240
    buffer_store_dwordx4 v[104:107], v2, s[4:7], s42 offen
    v_mul_f32 v96, v32, v32
    v_mul_f32 v97, v33, v33
    v_mfma_f32_32x32x16_bf16 v[48:63], v[76:79], a[108:111], v[48:63]
    ds_read_b128 v[72:75], v14 offset:34816
    s_waitcnt lgkmcnt(5)
    v_mul_f32 v98, v34, v34
    v_mul_f32 v99, v35, v35
    v_mul_f32 v100, v36, v36
    v_mul_f32 v101, v37, v37
    v_mfma_f32_32x32x16_bf16 v[48:63], v[80:83], a[112:115], v[48:63]
    ds_read_b128 v[76:79], v14 offset:35840
    v_mul_f32 v102, v38, v38
    buffer_load_dwordx4 v2, s[4:7], s43 offen offset:2048  lds
    v_mul_f32 v103, v39, v39
    v_mfma_f32_32x32x16_bf16 v[48:63], v[84:87], a[116:119], v[48:63]
    ds_read_b128 v[80:83], v14 offset:36864
    s_waitcnt lgkmcnt(5)
    v_fma_f32 v96, v96, v121, v120
    v_fma_f32 v97, v97, v121, v120
    v_fma_f32 v98, v98, v121, v120
    v_fma_f32 v99, v99, v121, v120
    v_mfma_f32_32x32x16_bf16 v[48:63], v[88:91], a[120:123], v[48:63]
    ds_read_b128 v[84:87], v14 offset:37888
    v_fma_f32 v100, v100, v121, v120
    v_fma_f32 v101, v101, v121, v120
    v_fma_f32 v102, v102, v121, v120
    v_mfma_f32_32x32x16_bf16 v[48:63], v[92:95], a[124:127], v[48:63]
    ds_read_b128 v[88:91], v14 offset:38912
    s_waitcnt lgkmcnt(5)
    v_fma_f32 v103, v103, v121, v120
    v_mul_f32 v96, v96, v32
    buffer_load_dwordx4 v2, s[4:7], s43 offen offset:3072  lds
    s_waitcnt vmcnt(10)
    v_mfma_f32_32x32x16_bf16 v[48:63], v[108:111], v[116:119], v[48:63]
    s_add_u32 s42, s35, 5316608
    buffer_load_dwordx4 v[108:111], v2, s[4:7], s42 offen
    v_mfma_f32_32x32x16_bf16 v[16:31], v[64:67], a[0:3], 0
    ds_read_b128 v[92:95], v14 offset:39936
    v_mul_f32 v97, v97, v33
    v_mul_f32 v98, v98, v34
    v_mul_f32 v99, v99, v35
    v_mfma_f32_32x32x16_bf16 v[16:31], v[68:71], a[4:7], v[16:31]
    ds_read_b128 v[64:67], v14 offset:40960
    s_waitcnt lgkmcnt(5)
    v_mul_f32 v100, v100, v36
    v_mul_f32 v101, v101, v37
    v_mul_f32 v102, v102, v38
    v_mfma_f32_32x32x16_bf16 v[16:31], v[72:75], a[8:11], v[16:31]
    ds_read_b128 v[68:71], v14 offset:41984
    v_mul_f32 v103, v103, v39
    v_exp_f32 v96, v96
    v_mul_f32 v32, v32, v40
    v_mfma_f32_32x32x16_bf16 v[16:31], v[76:79], a[12:15], v[16:31]
    ds_read_b128 v[72:75], v14 offset:43008
    s_waitcnt lgkmcnt(5)
    v_exp_f32 v97, v97
    v_mul_f32 v33, v33, v41
    s_add_u32 m0, s26, 0
    s_add_u32 s43, s25, 1245184
    s_cmp_ge_u32 s15, 6
    s_cselect_b32 s43, 2147418112, s43
    buffer_load_dwordx4 v2, s[4:7], s43 offen offset:0  lds
    v_mfma_f32_32x32x16_bf16 v[16:31], v[80:83], a[16:19], v[16:31]
    ds_read_b128 v[76:79], v14 offset:44032
    v_exp_f32 v98, v98
    v_mul_f32 v34, v34, v42
    v_exp_f32 v99, v99
    v_mfma_f32_32x32x16_bf16 v[16:31], v[84:87], a[20:23], v[16:31]
    ds_read_b128 v[80:83], v14 offset:45056
    s_waitcnt lgkmcnt(5)
    v_mul_f32 v35, v35, v43
    v_exp_f32 v100, v100
    v_mul_f32 v36, v36, v44
    v_mfma_f32_32x32x16_bf16 v[16:31], v[88:91], a[24:27], v[16:31]
    ds_read_b128 v[84:87], v14 offset:46080
    v_exp_f32 v101, v101
    v_mul_f32 v37, v37, v45
    v_exp_f32 v102, v102
    v_mfma_f32_32x32x16_bf16 v[16:31], v[92:95], a[28:31], v[16:31]
    ds_read_b128 v[88:91], v14 offset:47104
    s_waitcnt lgkmcnt(5)
    v_mul_f32 v38, v38, v46
    v_exp_f32 v103, v103
    buffer_load_dwordx4 v2, s[4:7], s43 offen offset:1024  lds
    v_mfma_f32_32x32x16_bf16 v[16:31], v[64:67], a[32:35], v[16:31]
    ds_read_b128 v[92:95], v14 offset:48128
    v_mul_f32 v39, v39, v47
    v_fma_f32 v96, v96, v122, v122
    v_fma_f32 v97, v97, v122, v122
    v_mfma_f32_32x32x16_bf16 v[16:31], v[68:71], a[36:39], v[16:31]
    ds_read_b128 v[64:67], v14 offset:49152
    s_waitcnt lgkmcnt(5)
    v_fma_f32 v98, v98, v122, v122
    v_fma_f32 v99, v99, v122, v122
    v_fma_f32 v100, v100, v122, v122
    v_mfma_f32_32x32x16_bf16 v[16:31], v[72:75], a[40:43], v[16:31]
    ds_read_b128 v[68:71], v14 offset:50176
    v_fma_f32 v101, v101, v122, v122
    v_fma_f32 v102, v102, v122, v122
    v_fma_f32 v103, v103, v122, v122
    v_mfma_f32_32x32x16_bf16 v[16:31], v[76:79], a[44:47], v[16:31]
    ds_read_b128 v[72:75], v14 offset:51200
    s_waitcnt lgkmcnt(5)
    v_rcp_f32 v96, v96
    v_rcp_f32 v97, v97
    buffer_load_dwordx4 v2, s[4:7], s43 offen offset:2048  lds
    v_mfma_f32_32x32x16_bf16 v[16:31], v[80:83], a[48:51], v[16:31]
    ds_read_b128 v[76:79], v14 offset:52224
    v_mul_f32 v32, v32, v96
    v_rcp_f32 v98, v98
    v_mul_f32 v33, v33, v97
    v_mfma_f32_32x32x16_bf16 v[16:31], v[84:87], a[52:55], v[16:31]
    ds_read_b128 v[80:83], v14 offset:53248
    s_waitcnt lgkmcnt(5)
    v_rcp_f32 v99, v99
    v_mul_f32 v34, v34, v98
    v_rcp_f32 v100, v100
    v_mfma_f32_32x32x16_bf16 v[16:31], v[88:91], a[56:59], v[16:31]
    ds_read_b128 v[84:87], v14 offset:54272
    v_mul_f32 v35, v35, v99
    v_rcp_f32 v101, v101
    v_mul_f32 v36, v36, v100
    v_mfma_f32_32x32x16_bf16 v[16:31], v[92:95], a[60:63], v[16:31]
    ds_read_b128 v[88:91], v14 offset:55296
    s_waitcnt lgkmcnt(5)
    v_rcp_f32 v102, v102
    buffer_load_dwordx4 v2, s[4:7], s43 offen offset:3072  lds
    v_mfma_f32_32x32x16_bf16 v[16:31], v[64:67], a[64:67], v[16:31]
    ds_read_b128 v[92:95], v14 offset:56320
    v_mul_f32 v37, v37, v101
    v_rcp_f32 v103, v103
    v_mul_f32 v38, v38, v102
    v_mfma_f32_32x32x16_bf16 v[16:31], v[68:71], a[68:71], v[16:31]
    ds_read_b128 v[64:67], v14 offset:57344
    s_waitcnt lgkmcnt(5)
    v_cvt_pk_bf16_f32 v104, v32, v33
    v_mul_f32 v39, v39, v103
    v_cvt_pk_bf16_f32 v105, v34, v35
    v_mfma_f32_32x32x16_bf16 v[16:31], v[72:75], a[72:75], v[16:31]
    ds_read_b128 v[68:71], v14 offset:58368
    v_cvt_pk_bf16_f32 v106, v36, v37
    v_cvt_pk_bf16_f32 v107, v38, v39
    s_add_u32 s42, s28, 14618624
    buffer_store_dwordx4 v[104:107], v2, s[4:7], s42 offen
    v_mfma_f32_32x32x16_bf16 v[16:31], v[76:79], a[76:79], v[16:31]
    ds_read_b128 v[72:75], v14 offset:59392
    s_waitcnt lgkmcnt(5)
    v_mul_f32 v96, v48, v48
    v_mul_f32 v97, v49, v49
    s_add_u32 m0, s26, 4096
    s_add_u32 s43, s25, 1249280
    s_cmp_ge_u32 s15, 6
    s_cselect_b32 s43, 2147418112, s43
    buffer_load_dwordx4 v2, s[4:7], s43 offen offset:0  lds
    v_mfma_f32_32x32x16_bf16 v[16:31], v[80:83], a[80:83], v[16:31]
    ds_read_b128 v[76:79], v14 offset:60416
    v_mul_f32 v98, v50, v50
    v_mul_f32 v99, v51, v51
    v_mul_f32 v100, v52, v52
    v_mfma_f32_32x32x16_bf16 v[16:31], v[84:87], a[84:87], v[16:31]
    ds_read_b128 v[80:83], v14 offset:61440
    s_waitcnt lgkmcnt(5)
    v_mul_f32 v101, v53, v53
    v_mul_f32 v102, v54, v54
    v_mul_f32 v103, v55, v55
    v_mfma_f32_32x32x16_bf16 v[16:31], v[88:91], a[88:91], v[16:31]
    ds_read_b128 v[84:87], v14 offset:62464
    v_fma_f32 v96, v96, v121, v120
    v_fma_f32 v97, v97, v121, v120
    v_fma_f32 v98, v98, v121, v120
    v_mfma_f32_32x32x16_bf16 v[16:31], v[92:95], a[92:95], v[16:31]
    ds_read_b128 v[88:91], v14 offset:63488
    s_waitcnt lgkmcnt(5)
    v_fma_f32 v99, v99, v121, v120
    v_fma_f32 v100, v100, v121, v120
    buffer_load_dwordx4 v2, s[4:7], s43 offen offset:1024  lds
    v_mfma_f32_32x32x16_bf16 v[16:31], v[64:67], a[96:99], v[16:31]
    ds_read_b128 v[92:95], v14 offset:64512
    v_fma_f32 v101, v101, v121, v120
    v_fma_f32 v102, v102, v121, v120
    v_fma_f32 v103, v103, v121, v120
    v_mfma_f32_32x32x16_bf16 v[16:31], v[68:71], a[100:103], v[16:31]
    s_waitcnt vmcnt(8)
    s_barrier
    ds_read_b128 v[64:67], v13 offset:0
    s_waitcnt lgkmcnt(5)
    v_mul_f32 v96, v96, v48
    v_mul_f32 v97, v97, v49
    v_mul_f32 v98, v98, v50
    v_mfma_f32_32x32x16_bf16 v[16:31], v[72:75], a[104:107], v[16:31]
    ds_read_b128 v[68:71], v13 offset:1024
    v_mul_f32 v99, v99, v51
    v_mul_f32 v100, v100, v52
    v_mul_f32 v101, v101, v53
    v_mfma_f32_32x32x16_bf16 v[16:31], v[76:79], a[108:111], v[16:31]
    ds_read_b128 v[72:75], v13 offset:2048
    s_waitcnt lgkmcnt(5)
    v_mul_f32 v102, v102, v54
    v_mul_f32 v103, v103, v55
    buffer_load_dwordx4 v2, s[4:7], s43 offen offset:2048  lds
    v_mfma_f32_32x32x16_bf16 v[16:31], v[80:83], a[112:115], v[16:31]
    ds_read_b128 v[76:79], v13 offset:3072
    v_exp_f32 v96, v96
    v_mul_f32 v48, v48, v56
    v_exp_f32 v97, v97
    v_mfma_f32_32x32x16_bf16 v[16:31], v[84:87], a[116:119], v[16:31]
    ds_read_b128 v[80:83], v13 offset:4096
    s_waitcnt lgkmcnt(5)
    v_mul_f32 v49, v49, v57
    v_exp_f32 v98, v98
    v_mul_f32 v50, v50, v58
    v_mfma_f32_32x32x16_bf16 v[16:31], v[88:91], a[120:123], v[16:31]
    ds_read_b128 v[84:87], v13 offset:5120
    v_exp_f32 v99, v99
    v_mul_f32 v51, v51, v59
    v_exp_f32 v100, v100
    v_mfma_f32_32x32x16_bf16 v[16:31], v[92:95], a[124:127], v[16:31]
    ds_read_b128 v[88:91], v13 offset:6144
    s_waitcnt lgkmcnt(5)
    v_mul_f32 v52, v52, v60
    buffer_load_dwordx4 v2, s[4:7], s43 offen offset:3072  lds
    v_mfma_f32_32x32x16_bf16 v[16:31], v[112:115], v[116:119], v[16:31]
    s_add_u32 s42, s35, 5317632
    buffer_load_dwordx4 v[112:115], v2, s[4:7], s42 offen
    v_mfma_f32_32x32x16_bf16 v[32:47], v[64:67], a[0:3], 0
    ds_read_b128 v[92:95], v13 offset:7168
    v_exp_f32 v101, v101
    v_mul_f32 v53, v53, v61
    v_exp_f32 v102, v102
    v_mfma_f32_32x32x16_bf16 v[32:47], v[68:71], a[4:7], v[32:47]
    ds_read_b128 v[64:67], v13 offset:8192
    s_waitcnt lgkmcnt(5)
    v_mul_f32 v54, v54, v62
    v_exp_f32 v103, v103
    v_mul_f32 v55, v55, v63
    v_mfma_f32_32x32x16_bf16 v[32:47], v[72:75], a[8:11], v[32:47]
    ds_read_b128 v[68:71], v13 offset:9216
    v_fma_f32 v96, v96, v122, v122
    v_fma_f32 v97, v97, v122, v122
    v_fma_f32 v98, v98, v122, v122
    v_mfma_f32_32x32x16_bf16 v[32:47], v[76:79], a[12:15], v[32:47]
    ds_read_b128 v[72:75], v13 offset:10240
    s_waitcnt lgkmcnt(5)
    v_fma_f32 v99, v99, v122, v122
    v_fma_f32 v100, v100, v122, v122
    v_mfma_f32_32x32x16_bf16 v[32:47], v[80:83], a[16:19], v[32:47]
    ds_read_b128 v[76:79], v13 offset:11264
    v_fma_f32 v101, v101, v122, v122
    v_fma_f32 v102, v102, v122, v122
    v_fma_f32 v103, v103, v122, v122
    v_mfma_f32_32x32x16_bf16 v[32:47], v[84:87], a[20:23], v[32:47]
    ds_read_b128 v[80:83], v13 offset:12288
    s_waitcnt lgkmcnt(5)
    v_rcp_f32 v96, v96
    v_rcp_f32 v97, v97
    v_mul_f32 v48, v48, v96
    v_mfma_f32_32x32x16_bf16 v[32:47], v[88:91], a[24:27], v[32:47]
    ds_read_b128 v[84:87], v13 offset:13312
    v_rcp_f32 v98, v98
    v_mul_f32 v49, v49, v97
    v_mfma_f32_32x32x16_bf16 v[32:47], v[92:95], a[28:31], v[32:47]
    ds_read_b128 v[88:91], v13 offset:14336
    s_waitcnt lgkmcnt(5)
    v_rcp_f32 v99, v99
    v_mul_f32 v50, v50, v98
    v_rcp_f32 v100, v100
    v_mfma_f32_32x32x16_bf16 v[32:47], v[64:67], a[32:35], v[32:47]
    ds_read_b128 v[92:95], v13 offset:15360
    v_mul_f32 v51, v51, v99
    v_rcp_f32 v101, v101
    v_mul_f32 v52, v52, v100
    v_mfma_f32_32x32x16_bf16 v[32:47], v[68:71], a[36:39], v[32:47]
    ds_read_b128 v[64:67], v13 offset:16384
    s_waitcnt lgkmcnt(5)
    v_rcp_f32 v102, v102
    v_mul_f32 v53, v53, v101
    v_mfma_f32_32x32x16_bf16 v[32:47], v[72:75], a[40:43], v[32:47]
    ds_read_b128 v[68:71], v13 offset:17408
    v_rcp_f32 v103, v103
    v_mul_f32 v54, v54, v102
    v_cvt_pk_bf16_f32 v104, v48, v49
    v_mfma_f32_32x32x16_bf16 v[32:47], v[76:79], a[44:47], v[32:47]
    ds_read_b128 v[72:75], v13 offset:18432
    s_waitcnt lgkmcnt(5)
    v_mul_f32 v55, v55, v103
    v_cvt_pk_bf16_f32 v105, v50, v51
    v_cvt_pk_bf16_f32 v106, v52, v53
    v_mfma_f32_32x32x16_bf16 v[32:47], v[80:83], a[48:51], v[32:47]
    ds_read_b128 v[76:79], v13 offset:19456
    v_cvt_pk_bf16_f32 v107, v54, v55
    s_add_u32 s42, s28, 14635008
    buffer_store_dwordx4 v[104:107], v2, s[4:7], s42 offen
    v_mfma_f32_32x32x16_bf16 v[32:47], v[84:87], a[52:55], v[32:47]
    ds_read_b128 v[80:83], v13 offset:20480
    s_waitcnt lgkmcnt(5)
    v_mul_f32 v96, v16, v16
    v_mul_f32 v97, v17, v17
    v_mul_f32 v98, v18, v18
    v_mfma_f32_32x32x16_bf16 v[32:47], v[88:91], a[56:59], v[32:47]
    ds_read_b128 v[84:87], v13 offset:21504
    v_mul_f32 v99, v19, v19
    v_mul_f32 v100, v20, v20
    v_mul_f32 v101, v21, v21
    v_mfma_f32_32x32x16_bf16 v[32:47], v[92:95], a[60:63], v[32:47]
    ds_read_b128 v[88:91], v13 offset:22528
    s_waitcnt lgkmcnt(5)
    v_mul_f32 v102, v22, v22
    v_mul_f32 v103, v23, v23
    v_mfma_f32_32x32x16_bf16 v[32:47], v[64:67], a[64:67], v[32:47]
    ds_read_b128 v[92:95], v13 offset:23552
    v_fma_f32 v96, v96, v121, v120
    v_fma_f32 v97, v97, v121, v120
    v_fma_f32 v98, v98, v121, v120
    v_mfma_f32_32x32x16_bf16 v[32:47], v[68:71], a[68:71], v[32:47]
    ds_read_b128 v[64:67], v13 offset:24576
    s_waitcnt lgkmcnt(5)
    v_fma_f32 v99, v99, v121, v120
    v_fma_f32 v100, v100, v121, v120
    v_fma_f32 v101, v101, v121, v120
    v_mfma_f32_32x32x16_bf16 v[32:47], v[72:75], a[72:75], v[32:47]
    ds_read_b128 v[68:71], v13 offset:25600
    v_fma_f32 v102, v102, v121, v120
    v_fma_f32 v103, v103, v121, v120
    v_mul_f32 v96, v96, v16
    v_mfma_f32_32x32x16_bf16 v[32:47], v[76:79], a[76:79], v[32:47]
    ds_read_b128 v[72:75], v13 offset:26624
    s_waitcnt lgkmcnt(5)
    v_mul_f32 v97, v97, v17
    v_mul_f32 v98, v98, v18
    v_mfma_f32_32x32x16_bf16 v[32:47], v[80:83], a[80:83], v[32:47]
    ds_read_b128 v[76:79], v13 offset:27648
    v_mul_f32 v99, v99, v19
    v_mul_f32 v100, v100, v20
    v_mul_f32 v101, v101, v21
    v_mfma_f32_32x32x16_bf16 v[32:47], v[84:87], a[84:87], v[32:47]
    ds_read_b128 v[80:83], v13 offset:28672
    s_waitcnt lgkmcnt(5)
    v_mul_f32 v102, v102, v22
    v_mul_f32 v103, v103, v23
    v_exp_f32 v96, v96
    v_mfma_f32_32x32x16_bf16 v[32:47], v[88:91], a[88:91], v[32:47]
    ds_read_b128 v[84:87], v13 offset:29696
    v_mul_f32 v16, v16, v24
    v_exp_f32 v97, v97
    v_mfma_f32_32x32x16_bf16 v[32:47], v[92:95], a[92:95], v[32:47]
    ds_read_b128 v[88:91], v13 offset:30720
    s_waitcnt lgkmcnt(5)
    v_mul_f32 v17, v17, v25
    v_exp_f32 v98, v98
    v_mul_f32 v18, v18, v26
    v_mfma_f32_32x32x16_bf16 v[32:47], v[64:67], a[96:99], v[32:47]
    ds_read_b128 v[92:95], v13 offset:31744
    v_exp_f32 v99, v99
    v_mul_f32 v19, v19, v27
    v_exp_f32 v100, v100
    v_mfma_f32_32x32x16_bf16 v[32:47], v[68:71], a[100:103], v[32:47]
    s_waitcnt vmcnt(2)
    s_barrier
    ds_read_b128 v[64:67], v2 offset:0
    s_waitcnt lgkmcnt(5)
    v_mul_f32 v20, v20, v28
    v_exp_f32 v101, v101
    v_mfma_f32_32x32x16_bf16 v[32:47], v[72:75], a[104:107], v[32:47]
    ds_read_b128 v[68:71], v2 offset:1024
    v_mul_f32 v21, v21, v29
    v_exp_f32 v102, v102
    v_mul_f32 v22, v22, v30
    v_mfma_f32_32x32x16_bf16 v[32:47], v[76:79], a[108:111], v[32:47]
    ds_read_b128 v[72:75], v2 offset:2048
    s_waitcnt lgkmcnt(5)
    v_exp_f32 v103, v103
    v_mul_f32 v23, v23, v31
    v_fma_f32 v96, v96, v122, v122
    v_mfma_f32_32x32x16_bf16 v[32:47], v[80:83], a[112:115], v[32:47]
    ds_read_b128 v[76:79], v2 offset:3072
    v_fma_f32 v97, v97, v122, v122
    v_fma_f32 v98, v98, v122, v122
    v_mfma_f32_32x32x16_bf16 v[32:47], v[84:87], a[116:119], v[32:47]
    ds_read_b128 v[80:83], v2 offset:4096
    s_waitcnt lgkmcnt(5)
    v_fma_f32 v99, v99, v122, v122
    v_fma_f32 v100, v100, v122, v122
    v_fma_f32 v101, v101, v122, v122
    v_mfma_f32_32x32x16_bf16 v[32:47], v[88:91], a[120:123], v[32:47]
    ds_read_b128 v[84:87], v2 offset:5120
    v_fma_f32 v102, v102, v122, v122
    v_fma_f32 v103, v103, v122, v122
    v_rcp_f32 v96, v96
    v_mfma_f32_32x32x16_bf16 v[32:47], v[92:95], a[124:127], v[32:47]
    ds_read_b128 v[88:91], v2 offset:6144
    s_waitcnt lgkmcnt(5)
    v_rcp_f32 v97, v97
    v_mul_f32 v16, v16, v96
    v_mfma_f32_32x32x16_bf16 v[32:47], v[108:111], v[116:119], v[32:47]
    v_mfma_f32_32x32x16_bf16 v[48:63], v[64:67], a[0:3], 0
    ds_read_b128 v[92:95], v2 offset:7168
    v_rcp_f32 v98, v98
    v_mul_f32 v17, v17, v97
    v_rcp_f32 v99, v99
    v_mul_f32 v18, v18, v98
    v_mfma_f32_32x32x16_bf16 v[48:63], v[68:71], a[4:7], v[48:63]
    ds_read_b128 v[64:67], v2 offset:8192
    s_waitcnt lgkmcnt(5)
    s_add_u32 s38, s24, 3899392
    buffer_load_dwordx4 a[0:3], v2, s[4:7], s38 offen offset:0
    v_rcp_f32 v100, v100
    v_mul_f32 v19, v19, v99
    v_mfma_f32_32x32x16_bf16 v[48:63], v[72:75], a[8:11], v[48:63]
    ds_read_b128 v[68:71], v2 offset:9216
    v_rcp_f32 v101, v101
    v_mul_f32 v20, v20, v100
    buffer_load_dwordx4 a[4:7], v2, s[4:7], s38 offen offset:1024
    v_rcp_f32 v102, v102
    v_mfma_f32_32x32x16_bf16 v[48:63], v[76:79], a[12:15], v[48:63]
    ds_read_b128 v[72:75], v2 offset:10240
    s_waitcnt lgkmcnt(5)
    v_mul_f32 v21, v21, v101
    v_rcp_f32 v103, v103
    v_mul_f32 v22, v22, v102
    v_mfma_f32_32x32x16_bf16 v[48:63], v[80:83], a[16:19], v[48:63]
    ds_read_b128 v[76:79], v2 offset:11264
    buffer_load_dwordx4 a[8:11], v2, s[4:7], s38 offen offset:2048
    v_cvt_pk_bf16_f32 v104, v16, v17
    v_mul_f32 v23, v23, v103
    v_cvt_pk_bf16_f32 v105, v18, v19
    v_mfma_f32_32x32x16_bf16 v[48:63], v[84:87], a[20:23], v[48:63]
    ds_read_b128 v[80:83], v2 offset:12288
    s_waitcnt lgkmcnt(5)
    v_cvt_pk_bf16_f32 v106, v20, v21
    buffer_load_dwordx4 a[12:15], v2, s[4:7], s38 offen offset:3072
    v_cvt_pk_bf16_f32 v107, v22, v23
    v_mfma_f32_32x32x16_bf16 v[48:63], v[88:91], a[24:27], v[48:63]
    ds_read_b128 v[84:87], v2 offset:13312
    s_add_u32 s42, s28, 14651392
    buffer_store_dwordx4 v[104:107], v2, s[4:7], s42 offen
    v_mul_f32 v96, v32, v32
    v_mul_f32 v97, v33, v33
    s_add_u32 s38, s24, 3903488
    buffer_load_dwordx4 a[16:19], v2, s[4:7], s38 offen offset:0
    v_mfma_f32_32x32x16_bf16 v[48:63], v[92:95], a[28:31], v[48:63]
    ds_read_b128 v[88:91], v2 offset:14336
    s_waitcnt lgkmcnt(5)
    v_mul_f32 v98, v34, v34
    v_mul_f32 v99, v35, v35
    v_mul_f32 v100, v36, v36
    v_mfma_f32_32x32x16_bf16 v[48:63], v[64:67], a[32:35], v[48:63]
    ds_read_b128 v[92:95], v2 offset:15360
    v_mul_f32 v101, v37, v37
    buffer_load_dwordx4 a[20:23], v2, s[4:7], s38 offen offset:1024
    v_mul_f32 v102, v38, v38
    v_mfma_f32_32x32x16_bf16 v[48:63], v[68:71], a[36:39], v[48:63]
    ds_read_b128 v[64:67], v2 offset:16384
    s_waitcnt lgkmcnt(5)
    v_mul_f32 v103, v39, v39
    v_fma_f32 v96, v96, v121, v120
    v_fma_f32 v97, v97, v121, v120
    buffer_load_dwordx4 a[24:27], v2, s[4:7], s38 offen offset:2048
    v_mfma_f32_32x32x16_bf16 v[48:63], v[72:75], a[40:43], v[48:63]
    ds_read_b128 v[68:71], v2 offset:17408
    v_fma_f32 v98, v98, v121, v120
    v_fma_f32 v99, v99, v121, v120
    v_fma_f32 v100, v100, v121, v120
    v_mfma_f32_32x32x16_bf16 v[48:63], v[76:79], a[44:47], v[48:63]
    ds_read_b128 v[72:75], v2 offset:18432
    s_waitcnt lgkmcnt(5)
    v_fma_f32 v101, v101, v121, v120
    buffer_load_dwordx4 a[28:31], v2, s[4:7], s38 offen offset:3072
    v_fma_f32 v102, v102, v121, v120
    v_fma_f32 v103, v103, v121, v120
    v_mfma_f32_32x32x16_bf16 v[48:63], v[80:83], a[48:51], v[48:63]
    ds_read_b128 v[76:79], v2 offset:19456
    v_mul_f32 v96, v96, v32
    v_mul_f32 v97, v97, v33
    s_add_u32 s38, s24, 3907584
    buffer_load_dwordx4 a[32:35], v2, s[4:7], s38 offen offset:0
    v_mfma_f32_32x32x16_bf16 v[48:63], v[84:87], a[52:55], v[48:63]
    ds_read_b128 v[80:83], v2 offset:20480
    s_waitcnt lgkmcnt(5)
    v_mul_f32 v98, v98, v34
    v_mul_f32 v99, v99, v35
    v_mul_f32 v100, v100, v36
    v_mul_f32 v101, v101, v37
    v_mfma_f32_32x32x16_bf16 v[48:63], v[88:91], a[56:59], v[48:63]
    ds_read_b128 v[84:87], v2 offset:21504
    buffer_load_dwordx4 a[36:39], v2, s[4:7], s38 offen offset:1024
    v_mul_f32 v102, v102, v38
    v_mul_f32 v103, v103, v39
    v_mfma_f32_32x32x16_bf16 v[48:63], v[92:95], a[60:63], v[48:63]
    ds_read_b128 v[88:91], v2 offset:22528
    s_waitcnt lgkmcnt(5)
    v_exp_f32 v96, v96
    v_mul_f32 v32, v32, v40
    buffer_load_dwordx4 a[40:43], v2, s[4:7], s38 offen offset:2048
    v_mfma_f32_32x32x16_bf16 v[48:63], v[64:67], a[64:67], v[48:63]
    ds_read_b128 v[92:95], v2 offset:23552
    v_exp_f32 v97, v97
    v_mul_f32 v33, v33, v41
    v_exp_f32 v98, v98
    v_mul_f32 v34, v34, v42
    v_mfma_f32_32x32x16_bf16 v[48:63], v[68:71], a[68:71], v[48:63]
    ds_read_b128 v[64:67], v2 offset:24576
    s_waitcnt lgkmcnt(5)
    buffer_load_dwordx4 a[44:47], v2, s[4:7], s38 offen offset:3072
    v_exp_f32 v99, v99
    v_mul_f32 v35, v35, v43
    v_mfma_f32_32x32x16_bf16 v[48:63], v[72:75], a[72:75], v[48:63]
    ds_read_b128 v[68:71], v2 offset:25600
    v_exp_f32 v100, v100
    v_mul_f32 v36, v36, v44
    s_add_u32 s38, s24, 3911680
    buffer_load_dwordx4 a[48:51], v2, s[4:7], s38 offen offset:0
    v_exp_f32 v101, v101
    v_mfma_f32_32x32x16_bf16 v[48:63], v[76:79], a[76:79], v[48:63]
    ds_read_b128 v[72:75], v2 offset:26624
    s_waitcnt lgkmcnt(5)
    v_mul_f32 v37, v37, v45
    v_exp_f32 v102, v102
    s_waitcnt vmcnt(9)
    s_add_u32 s41, s21, 36401152
    v_mov_b32 v15, 1
    buffer_store_dword v15, v8, s[4:7], s41 offen
    v_mfma_f32_32x32x16_bf16 v[48:63], v[80:83], a[80:83], v[48:63]
    ds_read_b128 v[76:79], v2 offset:27648
    v_mul_f32 v38, v38, v46
    buffer_load_dwordx4 a[52:55], v2, s[4:7], s38 offen offset:1024
    v_exp_f32 v103, v103
    v_mul_f32 v39, v39, v47
    v_mfma_f32_32x32x16_bf16 v[48:63], v[84:87], a[84:87], v[48:63]
    ds_read_b128 v[80:83], v2 offset:28672
    s_waitcnt lgkmcnt(5)
    v_fma_f32 v96, v96, v122, v122
    v_fma_f32 v97, v97, v122, v122
    buffer_load_dwordx4 a[56:59], v2, s[4:7], s38 offen offset:2048
    v_mfma_f32_32x32x16_bf16 v[48:63], v[88:91], a[88:91], v[48:63]
    ds_read_b128 v[84:87], v2 offset:29696
    v_fma_f32 v98, v98, v122, v122
    v_fma_f32 v99, v99, v122, v122
    v_fma_f32 v100, v100, v122, v122
    v_fma_f32 v101, v101, v122, v122
    v_mfma_f32_32x32x16_bf16 v[48:63], v[92:95], a[92:95], v[48:63]
    ds_read_b128 v[88:91], v2 offset:30720
    s_waitcnt lgkmcnt(5)
    buffer_load_dwordx4 a[60:63], v2, s[4:7], s38 offen offset:3072
    v_fma_f32 v102, v102, v122, v122
    v_fma_f32 v103, v103, v122, v122
    v_mfma_f32_32x32x16_bf16 v[48:63], v[64:67], a[96:99], v[48:63]
    ds_read_b128 v[92:95], v2 offset:31744
    v_rcp_f32 v96, v96
    v_rcp_f32 v97, v97
    s_add_u32 s38, s24, 3915776
    buffer_load_dwordx4 a[64:67], v2, s[4:7], s38 offen offset:0
    v_mfma_f32_32x32x16_bf16 v[48:63], v[68:71], a[100:103], v[48:63]
    s_waitcnt lgkmcnt(4)
    v_mul_f32 v32, v32, v96
    v_rcp_f32 v98, v98
    v_mul_f32 v33, v33, v97
    v_rcp_f32 v99, v99
    v_mfma_f32_32x32x16_bf16 v[48:63], v[72:75], a[104:107], v[48:63]
    buffer_load_dwordx4 a[68:71], v2, s[4:7], s38 offen offset:1024
    v_mul_f32 v34, v34, v98
    v_rcp_f32 v100, v100
    v_mfma_f32_32x32x16_bf16 v[48:63], v[76:79], a[108:111], v[48:63]
    s_waitcnt lgkmcnt(2)
    v_mul_f32 v35, v35, v99
    v_rcp_f32 v101, v101
    buffer_load_dwordx4 a[72:75], v2, s[4:7], s38 offen offset:2048
    v_mul_f32 v36, v36, v100
    v_mfma_f32_32x32x16_bf16 v[48:63], v[80:83], a[112:115], v[48:63]
    v_rcp_f32 v102, v102
    v_mul_f32 v37, v37, v101
    v_rcp_f32 v103, v103
    v_mfma_f32_32x32x16_bf16 v[48:63], v[84:87], a[116:119], v[48:63]
    s_waitcnt lgkmcnt(0)
    buffer_load_dwordx4 a[76:79], v2, s[4:7], s38 offen offset:3072
    v_mul_f32 v38, v38, v102
    v_cvt_pk_bf16_f32 v104, v32, v33
    v_mul_f32 v39, v39, v103
    v_mfma_f32_32x32x16_bf16 v[48:63], v[88:91], a[120:123], v[48:63]
    v_cvt_pk_bf16_f32 v105, v34, v35
    s_add_u32 s38, s24, 3919872
    buffer_load_dwordx4 a[80:83], v2, s[4:7], s38 offen offset:0
    v_cvt_pk_bf16_f32 v106, v36, v37
    v_mfma_f32_32x32x16_bf16 v[48:63], v[92:95], a[124:127], v[48:63]
    v_cvt_pk_bf16_f32 v107, v38, v39
    s_add_u32 s42, s28, 14667776
    buffer_store_dwordx4 v[104:107], v2, s[4:7], s42 offen
    buffer_load_dwordx4 a[84:87], v2, s[4:7], s38 offen offset:1024
    v_mfma_f32_32x32x16_bf16 v[48:63], v[112:115], v[116:119], v[48:63]
    s_add_u32 s41, s19, 36401152
    buffer_load_dword v123, v3, s[4:7], s41 offen sc1
    s_nop 9
    v_mul_f32 v96, v48, v48
    v_mul_f32 v97, v49, v49
    v_mul_f32 v98, v50, v50
    v_mul_f32 v99, v51, v51
    v_mul_f32 v100, v52, v52
    v_mul_f32 v101, v53, v53
    v_mul_f32 v102, v54, v54
    v_mul_f32 v103, v55, v55
    v_fma_f32 v96, v96, v121, v120
    v_fma_f32 v97, v97, v121, v120
    v_fma_f32 v98, v98, v121, v120
    v_fma_f32 v99, v99, v121, v120
    v_fma_f32 v100, v100, v121, v120
    v_fma_f32 v101, v101, v121, v120
    v_fma_f32 v102, v102, v121, v120
    v_fma_f32 v103, v103, v121, v120
    v_mul_f32 v96, v96, v48
    v_mul_f32 v97, v97, v49
    v_mul_f32 v98, v98, v50
    v_mul_f32 v99, v99, v51
    v_mul_f32 v100, v100, v52
    v_mul_f32 v101, v101, v53
    v_mul_f32 v102, v102, v54
    v_mul_f32 v103, v103, v55
    v_exp_f32 v96, v96
    v_mul_f32 v48, v48, v56
    v_exp_f32 v97, v97
    v_mul_f32 v49, v49, v57
    v_exp_f32 v98, v98
    v_mul_f32 v50, v50, v58
    v_exp_f32 v99, v99
    v_mul_f32 v51, v51, v59
    v_exp_f32 v100, v100
    v_mul_f32 v52, v52, v60
    v_exp_f32 v101, v101
    v_mul_f32 v53, v53, v61
    v_exp_f32 v102, v102
    v_mul_f32 v54, v54, v62
    v_exp_f32 v103, v103
    v_mul_f32 v55, v55, v63
    v_fma_f32 v96, v96, v122, v122
    v_fma_f32 v97, v97, v122, v122
    v_fma_f32 v98, v98, v122, v122
    v_fma_f32 v99, v99, v122, v122
    v_fma_f32 v100, v100, v122, v122
    v_fma_f32 v101, v101, v122, v122
    v_fma_f32 v102, v102, v122, v122
    v_fma_f32 v103, v103, v122, v122
    v_rcp_f32 v96, v96
    v_rcp_f32 v97, v97
    v_mul_f32 v48, v48, v96
    v_rcp_f32 v98, v98
    v_mul_f32 v49, v49, v97
    v_rcp_f32 v99, v99
    v_mul_f32 v50, v50, v98
    v_rcp_f32 v100, v100
    v_mul_f32 v51, v51, v99
    v_rcp_f32 v101, v101
    v_mul_f32 v52, v52, v100
    v_rcp_f32 v102, v102
    v_mul_f32 v53, v53, v101
    v_rcp_f32 v103, v103
    v_mul_f32 v54, v54, v102
    v_cvt_pk_bf16_f32 v104, v48, v49
    v_mul_f32 v55, v55, v103
    v_cvt_pk_bf16_f32 v105, v50, v51
    v_cvt_pk_bf16_f32 v106, v52, v53
    v_cvt_pk_bf16_f32 v107, v54, v55
    s_add_u32 s42, s28, 14684160
    s_cmp_ge_u32 s15, 6
    s_cselect_b32 s42, 2147418112, s42
    buffer_store_dwordx4 v[104:107], v2, s[4:7], s42 offen
    s_waitcnt vmcnt(1)
    v_cmp_gt_u32 vcc, 1, v123
    s_cbranch_vccnz L_main_kernel_aslow_28
L_main_kernel_aback_29:
    s_add_u32 m0, s27, 32768
    s_add_u32 s43, s29, 14602240
    buffer_load_dwordx4 v2, s[4:7], s43 offen offset:0 sc1 lds
    buffer_load_dwordx4 v2, s[4:7], s43 offen offset:1024 sc1 lds
    buffer_load_dwordx4 v2, s[4:7], s43 offen offset:2048 sc1 lds
    buffer_load_dwordx4 v2, s[4:7], s43 offen offset:3072 sc1 lds
    s_waitcnt vmcnt(4)
    s_add_u32 s41, s21, 36401152
    v_mov_b32 v15, 2
    buffer_store_dword v15, v8, s[4:7], s41 offen
    v_add_u32 v13, 32768, v2
    v_add_u32 v14, 98304, v2
    s_add_u32 m0, s27, 49152
    s_add_u32 s43, s29, 14618624
    buffer_load_dwordx4 v2, s[4:7], s43 offen offset:0 sc1 lds
    buffer_load_dwordx4 v2, s[4:7], s43 offen offset:1024 sc1 lds
    buffer_load_dwordx4 v2, s[4:7], s43 offen offset:2048 sc1 lds
    buffer_load_dwordx4 v2, s[4:7], s43 offen offset:3072 sc1 lds
    s_waitcnt vmcnt(5)
    s_barrier
    ds_read_b128 v[32:35], v13 offset:0
    ds_read_b128 v[36:39], v13 offset:1024
    ds_read_b128 v[40:43], v13 offset:2048
    ds_read_b128 v[44:47], v13 offset:3072
    ds_read_b128 v[48:51], v13 offset:4096
    ds_read_b128 v[52:55], v13 offset:5120
    ds_read_b128 v[56:59], v13 offset:6144
    s_waitcnt lgkmcnt(5)
    v_mfma_f32_32x32x16_bf16 v[16:31], a[0:3], v[32:35], 0
    ds_read_b128 v[60:63], v13 offset:7168
    s_add_u32 m0, s27, 65536
    s_add_u32 s43, s29, 14635008
    buffer_load_dwordx4 v2, s[4:7], s43 offen offset:0 sc1 lds
    v_mfma_f32_32x32x16_bf16 v[16:31], a[4:7], v[36:39], v[16:31]
    ds_read_b128 v[32:35], v13 offset:8192
    s_waitcnt lgkmcnt(5)
    buffer_load_dwordx4 v2, s[4:7], s43 offen offset:1024 sc1 lds
    v_mfma_f32_32x32x16_bf16 v[16:31], a[8:11], v[40:43], v[16:31]
    ds_read_b128 v[36:39], v13 offset:9216
    v_mfma_f32_32x32x16_bf16 v[16:31], a[12:15], v[44:47], v[16:31]
    ds_read_b128 v[40:43], v13 offset:10240
    s_waitcnt lgkmcnt(5)
    buffer_load_dwordx4 v2, s[4:7], s43 offen offset:2048 sc1 lds
    v_mfma_f32_32x32x16_bf16 v[16:31], a[16:19], v[48:51], v[16:31]
    ds_read_b128 v[44:47], v13 offset:11264
    buffer_load_dwordx4 v2, s[4:7], s43 offen offset:3072 sc1 lds
    v_mfma_f32_32x32x16_bf16 v[16:31], a[20:23], v[52:55], v[16:31]
    ds_read_b128 v[48:51], v13 offset:12288
    s_waitcnt lgkmcnt(5)
    v_mfma_f32_32x32x16_bf16 v[16:31], a[24:27], v[56:59], v[16:31]
    ds_read_b128 v[52:55], v13 offset:13312
    s_add_u32 m0, s27, 81920
    s_add_u32 s43, s29, 14651392
    buffer_load_dwordx4 v2, s[4:7], s43 offen offset:0 sc1 lds
    v_mfma_f32_32x32x16_bf16 v[16:31], a[28:31], v[60:63], v[16:31]
    ds_read_b128 v[56:59], v13 offset:14336
    s_waitcnt lgkmcnt(5)
    buffer_load_dwordx4 v2, s[4:7], s43 offen offset:1024 sc1 lds
    v_mfma_f32_32x32x16_bf16 v[16:31], a[32:35], v[32:35], v[16:31]
    ds_read_b128 v[60:63], v13 offset:15360
    v_mfma_f32_32x32x16_bf16 v[16:31], a[36:39], v[36:39], v[16:31]
    s_waitcnt vmcnt(6)
    s_barrier
    ds_read_b128 v[32:35], v13 offset:16384
    s_waitcnt lgkmcnt(5)
    buffer_load_dwordx4 v2, s[4:7], s43 offen offset:2048 sc1 lds
    v_mfma_f32_32x32x16_bf16 v[16:31], a[40:43], v[40:43], v[16:31]
    ds_read_b128 v[36:39], v13 offset:17408
    buffer_load_dwordx4 v2, s[4:7], s43 offen offset:3072 sc1 lds
    v_mfma_f32_32x32x16_bf16 v[16:31], a[44:47], v[44:47], v[16:31]
    ds_read_b128 v[40:43], v13 offset:18432
    s_waitcnt lgkmcnt(5)
    v_mfma_f32_32x32x16_bf16 v[16:31], a[48:51], v[48:51], v[16:31]
    ds_read_b128 v[44:47], v13 offset:19456
    s_add_u32 s42, s16, 5402624
    buffer_load_dwordx4 v[64:67], v2, s[4:7], s42 offen sc1
    buffer_load_dwordx4 v[68:71], v2, s[4:7], s42 offen offset:1024 sc1
    v_mfma_f32_32x32x16_bf16 v[16:31], a[52:55], v[52:55], v[16:31]
    ds_read_b128 v[48:51], v13 offset:20480
    s_waitcnt lgkmcnt(5)
    v_mfma_f32_32x32x16_bf16 v[16:31], a[56:59], v[56:59], v[16:31]
    ds_read_b128 v[52:55], v13 offset:21504
    v_mfma_f32_32x32x16_bf16 v[16:31], a[60:63], v[60:63], v[16:31]
    ds_read_b128 v[56:59], v13 offset:22528
    s_waitcnt lgkmcnt(5)
    v_mfma_f32_32x32x16_bf16 v[16:31], a[64:67], v[32:35], v[16:31]
    ds_read_b128 v[60:63], v13 offset:23552
    v_mfma_f32_32x32x16_bf16 v[16:31], a[68:71], v[36:39], v[16:31]
    ds_read_b128 v[32:35], v13 offset:24576
    s_waitcnt lgkmcnt(5)
    v_mfma_f32_32x32x16_bf16 v[16:31], a[72:75], v[40:43], v[16:31]
    ds_read_b128 v[36:39], v13 offset:25600
    v_mfma_f32_32x32x16_bf16 v[16:31], a[76:79], v[44:47], v[16:31]
    ds_read_b128 v[40:43], v13 offset:26624
    s_waitcnt lgkmcnt(5)
    v_mfma_f32_32x32x16_bf16 v[16:31], a[80:83], v[48:51], v[16:31]
    ds_read_b128 v[44:47], v13 offset:27648
    v_mfma_f32_32x32x16_bf16 v[16:31], a[84:87], v[52:55], v[16:31]
    ds_read_b128 v[48:51], v13 offset:28672
    s_waitcnt lgkmcnt(5)
    v_mfma_f32_32x32x16_bf16 v[16:31], a[128:131], v[56:59], v[16:31]
    ds_read_b128 v[52:55], v13 offset:29696
    v_mfma_f32_32x32x16_bf16 v[16:31], a[132:135], v[60:63], v[16:31]
    ds_read_b128 v[56:59], v13 offset:30720
    s_waitcnt lgkmcnt(5)
    v_mfma_f32_32x32x16_bf16 v[16:31], a[136:139], v[32:35], v[16:31]
    ds_read_b128 v[60:63], v13 offset:31744
    s_add_u32 s41, s19, 36401152
    buffer_load_dword v79, v3, s[4:7], s41 offen sc1
    v_mfma_f32_32x32x16_bf16 v[16:31], a[140:143], v[36:39], v[16:31]
    s_waitcnt vmcnt(3)
    s_barrier
    ds_read_b128 v[32:35], v13 offset:32768
    s_waitcnt lgkmcnt(5)
    v_mfma_f32_32x32x16_bf16 v[16:31], a[144:147], v[40:43], v[16:31]
    ds_read_b128 v[36:39], v13 offset:33792
    v_mfma_f32_32x32x16_bf16 v[16:31], a[148:151], v[44:47], v[16:31]
    ds_read_b128 v[40:43], v13 offset:34816
    s_waitcnt lgkmcnt(5)
    v_mfma_f32_32x32x16_bf16 v[16:31], a[152:155], v[48:51], v[16:31]
    ds_read_b128 v[44:47], v13 offset:35840
    v_mfma_f32_32x32x16_bf16 v[16:31], a[156:159], v[52:55], v[16:31]
    ds_read_b128 v[48:51], v13 offset:36864
    s_waitcnt lgkmcnt(5)
    v_mfma_f32_32x32x16_bf16 v[16:31], a[160:163], v[56:59], v[16:31]
    ds_read_b128 v[52:55], v13 offset:37888
    v_mfma_f32_32x32x16_bf16 v[16:31], a[164:167], v[60:63], v[16:31]
    ds_read_b128 v[56:59], v13 offset:38912
    s_waitcnt lgkmcnt(5)
    v_mfma_f32_32x32x16_bf16 v[16:31], a[168:171], v[32:35], v[16:31]
    ds_read_b128 v[60:63], v13 offset:39936
    v_mfma_f32_32x32x16_bf16 v[16:31], a[172:175], v[36:39], v[16:31]
    ds_read_b128 v[32:35], v13 offset:40960
    s_waitcnt lgkmcnt(5)
    v_mfma_f32_32x32x16_bf16 v[16:31], a[176:179], v[40:43], v[16:31]
    ds_read_b128 v[36:39], v13 offset:41984
    s_waitcnt vmcnt(0)
    v_cmp_gt_u32 vcc, 2, v79
    s_cbranch_vccnz L_main_kernel_aslow_30
L_main_kernel_aback_31:
    v_mfma_f32_32x32x16_bf16 v[16:31], a[180:183], v[44:47], v[16:31]
    ds_read_b128 v[40:43], v13 offset:43008
    s_waitcnt lgkmcnt(5)
    s_add_u32 m0, s27, 98304
    s_add_u32 s43, s29, 14667776
    buffer_load_dwordx4 v2, s[4:7], s43 offen offset:0 sc1 lds
    v_mfma_f32_32x32x16_bf16 v[16:31], a[184:187], v[48:51], v[16:31]
    ds_read_b128 v[44:47], v13 offset:44032
    buffer_load_dwordx4 v2, s[4:7], s43 offen offset:1024 sc1 lds
    v_mfma_f32_32x32x16_bf16 v[16:31], a[188:191], v[52:55], v[16:31]
    ds_read_b128 v[48:51], v13 offset:45056
    s_waitcnt lgkmcnt(5)
    v_mfma_f32_32x32x16_bf16 v[16:31], a[192:195], v[56:59], v[16:31]
    ds_read_b128 v[52:55], v13 offset:46080
    buffer_load_dwordx4 v2, s[4:7], s43 offen offset:2048 sc1 lds
    v_mfma_f32_32x32x16_bf16 v[16:31], a[196:199], v[60:63], v[16:31]
    ds_read_b128 v[56:59], v13 offset:47104
    s_waitcnt lgkmcnt(5)
    buffer_load_dwordx4 v2, s[4:7], s43 offen offset:3072 sc1 lds
    v_mfma_f32_32x32x16_bf16 v[16:31], a[200:203], v[32:35], v[16:31]
    ds_read_b128 v[60:63], v13 offset:48128
    s_add_u32 m0, s27, 114688
    s_add_u32 s43, s29, 14684160
    s_cmp_ge_u32 s3, 2
    s_cselect_b32 s43, 2147418112, s43
    buffer_load_dwordx4 v2, s[4:7], s43 offen offset:0 sc1 lds
    v_mfma_f32_32x32x16_bf16 v[16:31], a[204:207], v[36:39], v[16:31]
    ds_read_b128 v[32:35], v13 offset:49152
    s_waitcnt lgkmcnt(5)
    v_mfma_f32_32x32x16_bf16 v[16:31], a[208:211], v[40:43], v[16:31]
    ds_read_b128 v[36:39], v13 offset:50176
    buffer_load_dwordx4 v2, s[4:7], s43 offen offset:1024 sc1 lds
    v_mfma_f32_32x32x16_bf16 v[16:31], a[212:215], v[44:47], v[16:31]
    ds_read_b128 v[40:43], v13 offset:51200
    s_waitcnt lgkmcnt(5)
    buffer_load_dwordx4 v2, s[4:7], s43 offen offset:2048 sc1 lds
    v_mfma_f32_32x32x16_bf16 v[16:31], a[216:219], v[48:51], v[16:31]
    ds_read_b128 v[44:47], v13 offset:52224
    buffer_load_dwordx4 v2, s[4:7], s43 offen offset:3072 sc1 lds
    v_mfma_f32_32x32x16_bf16 v[16:31], a[220:223], v[52:55], v[16:31]
    ds_read_b128 v[48:51], v13 offset:53248
    s_waitcnt lgkmcnt(5)
    v_mfma_f32_32x32x16_bf16 v[16:31], a[224:227], v[56:59], v[16:31]
    ds_read_b128 v[52:55], v13 offset:54272
    v_mfma_f32_32x32x16_bf16 v[16:31], a[228:231], v[60:63], v[16:31]
    ds_read_b128 v[56:59], v13 offset:55296
    s_waitcnt lgkmcnt(5)
    v_mfma_f32_32x32x16_bf16 v[16:31], a[232:235], v[32:35], v[16:31]
    ds_read_b128 v[60:63], v13 offset:56320
    v_lshlrev_b32 v112, 16, v64
    v_mfma_f32_32x32x16_bf16 v[16:31], a[236:239], v[36:39], v[16:31]
    ds_read_b128 v[32:35], v13 offset:57344
    s_waitcnt lgkmcnt(5)
    v_and_b32 v113, 0xffff0000, v64
    v_mfma_f32_32x32x16_bf16 v[16:31], a[240:243], v[40:43], v[16:31]
    ds_read_b128 v[36:39], v13 offset:58368
    v_lshlrev_b32 v114, 16, v65
    v_mfma_f32_32x32x16_bf16 v[16:31], a[244:247], v[44:47], v[16:31]
    ds_read_b128 v[40:43], v13 offset:59392
    s_waitcnt lgkmcnt(5)
    v_and_b32 v115, 0xffff0000, v65
    v_mfma_f32_32x32x16_bf16 v[16:31], a[248:251], v[48:51], v[16:31]
    ds_read_b128 v[44:47], v13 offset:60416
    v_lshlrev_b32 v116, 16, v66
    v_and_b32 v117, 0xffff0000, v66
    v_mfma_f32_32x32x16_bf16 v[16:31], a[252:255], v[52:55], v[16:31]
    ds_read_b128 v[48:51], v13 offset:61440
    s_waitcnt lgkmcnt(5)
    v_lshlrev_b32 v118, 16, v67
    v_mfma_f32_32x32x16_bf16 v[16:31], v[128:131], v[56:59], v[16:31]
    ds_read_b128 v[52:55], v13 offset:62464
    v_and_b32 v119, 0xffff0000, v67
    v_mfma_f32_32x32x16_bf16 v[16:31], v[132:135], v[60:63], v[16:31]
    ds_read_b128 v[56:59], v13 offset:63488
    s_waitcnt lgkmcnt(5)
    v_lshlrev_b32 v120, 16, v68
    v_mfma_f32_32x32x16_bf16 v[16:31], v[136:139], v[32:35], v[16:31]
    ds_read_b128 v[60:63], v13 offset:64512
    v_and_b32 v121, 0xffff0000, v68
    v_mfma_f32_32x32x16_bf16 v[16:31], v[140:143], v[36:39], v[16:31]
    s_waitcnt vmcnt(0)
    s_barrier
    ds_read_b128 v[32:35], v14 offset:0
    s_waitcnt lgkmcnt(5)
    v_lshlrev_b32 v122, 16, v69
    v_and_b32 v123, 0xffff0000, v69
    v_mfma_f32_32x32x16_bf16 v[16:31], v[144:147], v[40:43], v[16:31]
    ds_read_b128 v[36:39], v14 offset:1024
    v_lshlrev_b32 v124, 16, v70
    v_mfma_f32_32x32x16_bf16 v[16:31], v[148:151], v[44:47], v[16:31]
    ds_read_b128 v[40:43], v14 offset:2048
    s_waitcnt lgkmcnt(5)
    v_and_b32 v125, 0xffff0000, v70
    v_mfma_f32_32x32x16_bf16 v[16:31], v[152:155], v[48:51], v[16:31]
    ds_read_b128 v[44:47], v14 offset:3072
    v_lshlrev_b32 v126, 16, v71
    v_mfma_f32_32x32x16_bf16 v[16:31], v[156:159], v[52:55], v[16:31]
    ds_read_b128 v[48:51], v14 offset:4096
    s_waitcnt lgkmcnt(5)
    v_and_b32 v127, 0xffff0000, v71
    v_mfma_f32_32x32x16_bf16 v[16:31], v[160:163], v[56:59], v[16:31]
    ds_read_b128 v[52:55], v14 offset:5120
    v_mfma_f32_32x32x16_bf16 v[16:31], v[164:167], v[60:63], v[16:31]
    ds_read_b128 v[56:59], v14 offset:6144
    s_waitcnt lgkmcnt(5)
    v_mfma_f32_32x32x16_bf16 v[16:31], v[168:171], v[32:35], v[16:31]
    ds_read_b128 v[60:63], v14 offset:7168
    v_mfma_f32_32x32x16_bf16 v[16:31], v[172:175], v[36:39], v[16:31]
    ds_read_b128 v[32:35], v14 offset:8192
    s_waitcnt lgkmcnt(5)
    v_mfma_f32_32x32x16_bf16 v[16:31], v[176:179], v[40:43], v[16:31]
    ds_read_b128 v[36:39], v14 offset:9216
    v_mfma_f32_32x32x16_bf16 v[16:31], v[180:183], v[44:47], v[16:31]
    ds_read_b128 v[40:43], v14 offset:10240
    s_waitcnt lgkmcnt(5)
    v_mfma_f32_32x32x16_bf16 v[16:31], v[184:187], v[48:51], v[16:31]
    ds_read_b128 v[44:47], v14 offset:11264
    v_mfma_f32_32x32x16_bf16 v[16:31], v[188:191], v[52:55], v[16:31]
    ds_read_b128 v[48:51], v14 offset:12288
    s_waitcnt lgkmcnt(5)
    v_mfma_f32_32x32x16_bf16 v[16:31], v[192:195], v[56:59], v[16:31]
    ds_read_b128 v[52:55], v14 offset:13312
    v_mfma_f32_32x32x16_bf16 v[16:31], v[196:199], v[60:63], v[16:31]
    ds_read_b128 v[56:59], v14 offset:14336
    s_waitcnt lgkmcnt(5)
    v_mfma_f32_32x32x16_bf16 v[16:31], v[200:203], v[32:35], v[16:31]
    ds_read_b128 v[60:63], v14 offset:15360
    v_mfma_f32_32x32x16_bf16 v[16:31], v[204:207], v[36:39], v[16:31]
    ds_read_b128 v[32:35], v14 offset:16384
    s_waitcnt lgkmcnt(5)
    v_mfma_f32_32x32x16_bf16 v[16:31], v[208:211], v[40:43], v[16:31]
    ds_read_b128 v[36:39], v14 offset:17408
    v_mfma_f32_32x32x16_bf16 v[16:31], v[212:215], v[44:47], v[16:31]
    ds_read_b128 v[40:43], v14 offset:18432
    s_waitcnt lgkmcnt(5)
    v_mfma_f32_32x32x16_bf16 v[16:31], v[216:219], v[48:51], v[16:31]
    ds_read_b128 v[44:47], v14 offset:19456
    v_mfma_f32_32x32x16_bf16 v[16:31], v[220:223], v[52:55], v[16:31]
    ds_read_b128 v[48:51], v14 offset:20480
    s_waitcnt lgkmcnt(5)
    v_mfma_f32_32x32x16_bf16 v[16:31], v[224:227], v[56:59], v[16:31]
    ds_read_b128 v[52:55], v14 offset:21504
    v_mfma_f32_32x32x16_bf16 v[16:31], v[228:231], v[60:63], v[16:31]
    s_waitcnt lgkmcnt(4)
    v_mfma_f32_32x32x16_bf16 v[16:31], v[232:235], v[32:35], v[16:31]
    v_mfma_f32_32x32x16_bf16 v[16:31], v[236:239], v[36:39], v[16:31]
    s_waitcnt lgkmcnt(2)
    v_mfma_f32_32x32x16_bf16 v[16:31], v[240:243], v[40:43], v[16:31]
    v_mfma_f32_32x32x16_bf16 v[16:31], v[244:247], v[44:47], v[16:31]
    s_waitcnt lgkmcnt(0)
    v_mfma_f32_32x32x16_bf16 v[16:31], v[248:251], v[48:51], v[16:31]
    v_mfma_f32_32x32x16_bf16 v[16:31], v[252:255], v[52:55], v[16:31]
    v_and_b32 v12, 31, v1
    v_lshlrev_b32 v12, 10, v12
    v_lshrrev_b32 v13, 5, v1
    v_lshl_add_u32 v12, v13, 4, v12
    s_lshl_b32 s42, s14, 6
    s_add_u32 s42, s42, s17
    s_nop 5
    v_add_f32 v16, v16, v112
    v_add_f32 v17, v17, v113
    v_add_f32 v18, v18, v114
    v_add_f32 v19, v19, v115
    v_add_f32 v20, v20, v116
    v_add_f32 v21, v21, v117
    v_add_f32 v22, v22, v118
    v_add_f32 v23, v23, v119
    v_add_f32 v24, v24, v120
    v_add_f32 v25, v25, v121
    v_add_f32 v26, v26, v122
    v_add_f32 v27, v27, v123
    v_add_f32 v28, v28, v124
    v_add_f32 v29, v29, v125
    v_add_f32 v30, v30, v126
    v_add_f32 v31, v31, v127
    v_cvt_pk_bf16_f32 v48, v16, v17
    v_cvt_pk_bf16_f32 v49, v18, v19
    v_cvt_pk_bf16_f32 v50, v20, v21
    v_cvt_pk_bf16_f32 v51, v22, v23
    buffer_store_dwordx4 v[48:51], v12, s[8:11], s42 offen offset:0
    v_cvt_pk_bf16_f32 v52, v24, v25
    v_cvt_pk_bf16_f32 v53, v26, v27
    v_cvt_pk_bf16_f32 v54, v28, v29
    v_cvt_pk_bf16_f32 v55, v30, v31
    buffer_store_dwordx4 v[52:55], v12, s[8:11], s42 offen offset:32
L_main_kernel_end_1:
    s_endpgm
L_main_kernel_afb_5:
    v_add_u32 v113, 0, v2
    v_and_b32 v14, 15, v1
    v_lshlrev_b32 v14, 4, v14
    v_lshrrev_b32 v13, 5, v1
    v_lshl_add_u32 v14, v13, 8, v14
    v_add_u32 v114, 1024, v14
    v_add_u32 v115, 1536, v14
    v_and_b32 v14, 27, v1
    v_cmp_eq_u32 vcc, 16, v14
    v_mov_b32 v14, 2064
    v_mov_b32 v13, 2048
    v_cndmask_b32 v14, v14, v13, vcc
    v_and_b32 v13, 16, v1
    v_cmp_ne_u32 vcc, 0, v13
    s_nop 1
    v_cndmask_b32 v114, v114, v14, vcc
    v_cndmask_b32 v115, v115, v14, vcc
    v_mov_b32 v12, 0xff800000
    v_mov_b32 v13, 0xff800000
    s_mov_b32 s42, 0
    s_mov_b32 s43, 14315520
L_main_kernel_p1_32:
    buffer_load_dwordx4 v[56:59], v113, s[4:7], s43 offen sc1
    s_waitcnt vmcnt(0)
    v_mfma_f32_32x32x16_bf16 v[80:95], v[56:59], v[16:19], 0
    v_mfma_f32_32x32x16_bf16 v[96:111], v[56:59], v[20:23], 0
    s_nop 15
    v_max3_f32 v12, v80, v81, v12
    v_max3_f32 v12, v82, v83, v12
    v_max3_f32 v12, v84, v85, v12
    v_max3_f32 v12, v86, v87, v12
    v_max3_f32 v12, v88, v89, v12
    v_max3_f32 v12, v90, v91, v12
    v_max3_f32 v12, v92, v93, v12
    v_max3_f32 v12, v94, v95, v12
    v_max3_f32 v13, v96, v97, v13
    v_max3_f32 v13, v98, v99, v13
    v_max3_f32 v13, v100, v101, v13
    v_max3_f32 v13, v102, v103, v13
    v_max3_f32 v13, v104, v105, v13
    v_max3_f32 v13, v106, v107, v13
    v_max3_f32 v13, v108, v109, v13
    v_max3_f32 v13, v110, v111, v13
    s_add_u32 s42, s42, 1
    s_add_u32 s43, s43, 2080
    s_and_b32 s41, s42, 7
    s_cmp_eq_u32 s41, 0
    s_cselect_b32 s41, 768, 0
    s_add_u32 s43, s43, s41
    s_cmp_lt_u32 s42, 64
    s_cbranch_scc1 L_main_kernel_p1_32
    v_mov_b32 v14, v12
    s_nop 1
    v_permlane32_swap_b32 v12, v14
    s_nop 1
    v_max_f32 v12, v12, v14
    v_mov_b32 v14, v13
    s_nop 1
    v_permlane32_swap_b32 v13, v14
    s_nop 1
    v_max_f32 v13, v13, v14
    v_mov_b32 v24, 0
    v_mov_b32 v25, 0
    v_mov_b32 v26, 0
    v_mov_b32 v27, 0
    v_mov_b32 v28, 0
    v_mov_b32 v29, 0
    v_mov_b32 v30, 0
    v_mov_b32 v31, 0
    v_mov_b32 v32, 0
    v_mov_b32 v33, 0
    v_mov_b32 v34, 0
    v_mov_b32 v35, 0
    v_mov_b32 v36, 0
    v_mov_b32 v37, 0
    v_mov_b32 v38, 0
    v_mov_b32 v39, 0
    v_mov_b32 v40, 0
    v_mov_b32 v41, 0
    v_mov_b32 v42, 0
    v_mov_b32 v43, 0
    v_mov_b32 v44, 0
    v_mov_b32 v45, 0
    v_mov_b32 v46, 0
    v_mov_b32 v47, 0
    v_mov_b32 v48, 0
    v_mov_b32 v49, 0
    v_mov_b32 v50, 0
    v_mov_b32 v51, 0
    v_mov_b32 v52, 0
    v_mov_b32 v53, 0
    v_mov_b32 v54, 0
    v_mov_b32 v55, 0
    s_mov_b32 s42, 0
    s_mov_b32 s43, 14315520
L_main_kernel_p2_33:
    buffer_load_dwordx4 v[56:59], v113, s[4:7], s43 offen sc1
    buffer_load_dwordx4 v[64:67], v114, s[4:7], s43 offen sc1
    buffer_load_dwordx4 v[68:71], v115, s[4:7], s43 offen sc1
    s_waitcnt vmcnt(0)
    v_mfma_f32_32x32x16_bf16 v[80:95], v[56:59], v[16:19], 0
    v_mfma_f32_32x32x16_bf16 v[96:111], v[56:59], v[20:23], 0
    s_nop 15
    v_sub_f32 v80, v80, v12
    v_sub_f32 v81, v81, v12
    v_sub_f32 v82, v82, v12
    v_sub_f32 v83, v83, v12
    v_sub_f32 v84, v84, v12
    v_sub_f32 v85, v85, v12
    v_sub_f32 v86, v86, v12
    v_sub_f32 v87, v87, v12
    v_sub_f32 v88, v88, v12
    v_sub_f32 v89, v89, v12
    v_sub_f32 v90, v90, v12
    v_sub_f32 v91, v91, v12
    v_sub_f32 v92, v92, v12
    v_sub_f32 v93, v93, v12
    v_sub_f32 v94, v94, v12
    v_sub_f32 v95, v95, v12
    v_exp_f32 v80, v80
    v_exp_f32 v81, v81
    v_exp_f32 v82, v82
    v_exp_f32 v83, v83
    v_exp_f32 v84, v84
    v_exp_f32 v85, v85
    v_exp_f32 v86, v86
    v_exp_f32 v87, v87
    v_exp_f32 v88, v88
    v_exp_f32 v89, v89
    v_exp_f32 v90, v90
    v_exp_f32 v91, v91
    v_exp_f32 v92, v92
    v_exp_f32 v93, v93
    v_exp_f32 v94, v94
    v_exp_f32 v95, v95
    v_sub_f32 v96, v96, v13
    v_sub_f32 v97, v97, v13
    v_sub_f32 v98, v98, v13
    v_sub_f32 v99, v99, v13
    v_sub_f32 v100, v100, v13
    v_sub_f32 v101, v101, v13
    v_sub_f32 v102, v102, v13
    v_sub_f32 v103, v103, v13
    v_sub_f32 v104, v104, v13
    v_sub_f32 v105, v105, v13
    v_sub_f32 v106, v106, v13
    v_sub_f32 v107, v107, v13
    v_sub_f32 v108, v108, v13
    v_sub_f32 v109, v109, v13
    v_sub_f32 v110, v110, v13
    v_sub_f32 v111, v111, v13
    v_exp_f32 v96, v96
    v_exp_f32 v97, v97
    v_exp_f32 v98, v98
    v_exp_f32 v99, v99
    v_exp_f32 v100, v100
    v_exp_f32 v101, v101
    v_exp_f32 v102, v102
    v_exp_f32 v103, v103
    v_exp_f32 v104, v104
    v_exp_f32 v105, v105
    v_exp_f32 v106, v106
    v_exp_f32 v107, v107
    v_exp_f32 v108, v108
    v_exp_f32 v109, v109
    v_exp_f32 v110, v110
    v_exp_f32 v111, v111
    s_nop 1
    v_smfmac_f32_32x32x32_bf16 v[24:39], v[64:67], v[80:87], v112
    v_smfmac_f32_32x32x32_bf16 v[24:39], v[68:71], v[88:95], v112
    v_smfmac_f32_32x32x32_bf16 v[40:55], v[64:67], v[96:103], v112
    v_smfmac_f32_32x32x32_bf16 v[40:55], v[68:71], v[104:111], v112
    s_nop 15
    s_add_u32 s42, s42, 1
    s_add_u32 s43, s43, 2080
    s_and_b32 s41, s42, 7
    s_cmp_eq_u32 s41, 0
    s_cselect_b32 s41, 768, 0
    s_add_u32 s43, s43, s41
    s_cmp_lt_u32 s42, 64
    s_cbranch_scc1 L_main_kernel_p2_33
    s_branch L_main_kernel_afin_4
L_main_kernel_aslow_10:
    s_add_u32 s41, s19, 35729408
    s_mov_b32 s40, 0
L_main_kernel_poll_34:
    buffer_load_dword v15, v3, s[4:7], s41 offen sc1
    s_add_u32 s40, s40, 1
    s_waitcnt vmcnt(0)
    v_cmp_gt_u32 vcc, 1, v15
    s_cbranch_vccz L_main_kernel_polld_35
    s_cmp_lt_u32 s40, 262144
    s_cbranch_scc1 L_main_kernel_poll_34
L_main_kernel_polld_35:
    s_branch L_main_kernel_aback_11
L_main_kernel_aslow_12:
    s_add_u32 s41, s19, 35729408
    s_mov_b32 s40, 0
L_main_kernel_poll_36:
    buffer_load_dword v15, v3, s[4:7], s41 offen sc1
    s_add_u32 s40, s40, 1
    s_waitcnt vmcnt(0)
    v_cmp_gt_u32 vcc, 2, v15
    s_cbranch_vccz L_main_kernel_polld_37
    s_cmp_lt_u32 s40, 262144
    s_cbranch_scc1 L_main_kernel_poll_36
L_main_kernel_polld_37:
    s_branch L_main_kernel_aback_13
L_main_kernel_aslow_20:
    s_mov_b32 s41, 36532224
    s_mov_b32 s40, 0
L_main_kernel_poll_38:
    buffer_load_dword v15, v120, s[4:7], s41 offen sc1
    s_add_u32 s40, s40, 1
    s_waitcnt vmcnt(0)
    v_cmp_gt_u32 vcc, 32, v15
    s_cbranch_vccz L_main_kernel_polld_39
    s_cmp_lt_u32 s40, 262144
    s_cbranch_scc1 L_main_kernel_poll_38
L_main_kernel_polld_39:
    s_branch L_main_kernel_aback_21
L_main_kernel_afb_23:
    v_add_u32 v113, 0, v2
    v_and_b32 v14, 15, v1
    v_lshlrev_b32 v14, 4, v14
    v_lshrrev_b32 v13, 5, v1
    v_lshl_add_u32 v14, v13, 8, v14
    v_add_u32 v114, 1024, v14
    v_add_u32 v115, 1536, v14
    v_and_b32 v14, 27, v1
    v_cmp_eq_u32 vcc, 16, v14
    v_mov_b32 v14, 2064
    v_mov_b32 v13, 2048
    v_cndmask_b32 v14, v14, v13, vcc
    v_and_b32 v13, 16, v1
    v_cmp_ne_u32 vcc, 0, v13
    s_nop 1
    v_cndmask_b32 v114, v114, v14, vcc
    v_cndmask_b32 v115, v115, v14, vcc
    v_mov_b32 v12, 0xff800000
    v_mov_b32 v13, 0xff800000
    s_mov_b32 s42, 0
    s_mov_b32 s43, 29216768
L_main_kernel_p1_40:
    buffer_load_dwordx4 v[56:59], v113, s[4:7], s43 offen sc1
    s_waitcnt vmcnt(0)
    v_mfma_f32_32x32x16_bf16 v[80:95], v[56:59], v[16:19], 0
    v_mfma_f32_32x32x16_bf16 v[96:111], v[56:59], v[20:23], 0
    s_nop 15
    v_max3_f32 v12, v80, v81, v12
    v_max3_f32 v12, v82, v83, v12
    v_max3_f32 v12, v84, v85, v12
    v_max3_f32 v12, v86, v87, v12
    v_max3_f32 v12, v88, v89, v12
    v_max3_f32 v12, v90, v91, v12
    v_max3_f32 v12, v92, v93, v12
    v_max3_f32 v12, v94, v95, v12
    v_max3_f32 v13, v96, v97, v13
    v_max3_f32 v13, v98, v99, v13
    v_max3_f32 v13, v100, v101, v13
    v_max3_f32 v13, v102, v103, v13
    v_max3_f32 v13, v104, v105, v13
    v_max3_f32 v13, v106, v107, v13
    v_max3_f32 v13, v108, v109, v13
    v_max3_f32 v13, v110, v111, v13
    s_add_u32 s42, s42, 1
    s_add_u32 s43, s43, 2080
    s_and_b32 s41, s42, 7
    s_cmp_eq_u32 s41, 0
    s_cselect_b32 s41, 768, 0
    s_add_u32 s43, s43, s41
    s_cmp_lt_u32 s42, 64
    s_cbranch_scc1 L_main_kernel_p1_40
    v_mov_b32 v14, v12
    s_nop 1
    v_permlane32_swap_b32 v12, v14
    s_nop 1
    v_max_f32 v12, v12, v14
    v_mov_b32 v14, v13
    s_nop 1
    v_permlane32_swap_b32 v13, v14
    s_nop 1
    v_max_f32 v13, v13, v14
    v_mov_b32 v24, 0
    v_mov_b32 v25, 0
    v_mov_b32 v26, 0
    v_mov_b32 v27, 0
    v_mov_b32 v28, 0
    v_mov_b32 v29, 0
    v_mov_b32 v30, 0
    v_mov_b32 v31, 0
    v_mov_b32 v32, 0
    v_mov_b32 v33, 0
    v_mov_b32 v34, 0
    v_mov_b32 v35, 0
    v_mov_b32 v36, 0
    v_mov_b32 v37, 0
    v_mov_b32 v38, 0
    v_mov_b32 v39, 0
    v_mov_b32 v40, 0
    v_mov_b32 v41, 0
    v_mov_b32 v42, 0
    v_mov_b32 v43, 0
    v_mov_b32 v44, 0
    v_mov_b32 v45, 0
    v_mov_b32 v46, 0
    v_mov_b32 v47, 0
    v_mov_b32 v48, 0
    v_mov_b32 v49, 0
    v_mov_b32 v50, 0
    v_mov_b32 v51, 0
    v_mov_b32 v52, 0
    v_mov_b32 v53, 0
    v_mov_b32 v54, 0
    v_mov_b32 v55, 0
    s_mov_b32 s42, 0
    s_mov_b32 s43, 29216768
L_main_kernel_p2_41:
    buffer_load_dwordx4 v[56:59], v113, s[4:7], s43 offen sc1
    buffer_load_dwordx4 v[64:67], v114, s[4:7], s43 offen sc1
    buffer_load_dwordx4 v[68:71], v115, s[4:7], s43 offen sc1
    s_waitcnt vmcnt(0)
    v_mfma_f32_32x32x16_bf16 v[80:95], v[56:59], v[16:19], 0
    v_mfma_f32_32x32x16_bf16 v[96:111], v[56:59], v[20:23], 0
    s_nop 15
    v_sub_f32 v80, v80, v12
    v_sub_f32 v81, v81, v12
    v_sub_f32 v82, v82, v12
    v_sub_f32 v83, v83, v12
    v_sub_f32 v84, v84, v12
    v_sub_f32 v85, v85, v12
    v_sub_f32 v86, v86, v12
    v_sub_f32 v87, v87, v12
    v_sub_f32 v88, v88, v12
    v_sub_f32 v89, v89, v12
    v_sub_f32 v90, v90, v12
    v_sub_f32 v91, v91, v12
    v_sub_f32 v92, v92, v12
    v_sub_f32 v93, v93, v12
    v_sub_f32 v94, v94, v12
    v_sub_f32 v95, v95, v12
    v_exp_f32 v80, v80
    v_exp_f32 v81, v81
    v_exp_f32 v82, v82
    v_exp_f32 v83, v83
    v_exp_f32 v84, v84
    v_exp_f32 v85, v85
    v_exp_f32 v86, v86
    v_exp_f32 v87, v87
    v_exp_f32 v88, v88
    v_exp_f32 v89, v89
    v_exp_f32 v90, v90
    v_exp_f32 v91, v91
    v_exp_f32 v92, v92
    v_exp_f32 v93, v93
    v_exp_f32 v94, v94
    v_exp_f32 v95, v95
    v_sub_f32 v96, v96, v13
    v_sub_f32 v97, v97, v13
    v_sub_f32 v98, v98, v13
    v_sub_f32 v99, v99, v13
    v_sub_f32 v100, v100, v13
    v_sub_f32 v101, v101, v13
    v_sub_f32 v102, v102, v13
    v_sub_f32 v103, v103, v13
    v_sub_f32 v104, v104, v13
    v_sub_f32 v105, v105, v13
    v_sub_f32 v106, v106, v13
    v_sub_f32 v107, v107, v13
    v_sub_f32 v108, v108, v13
    v_sub_f32 v109, v109, v13
    v_sub_f32 v110, v110, v13
    v_sub_f32 v111, v111, v13
    v_exp_f32 v96, v96
    v_exp_f32 v97, v97
    v_exp_f32 v98, v98
    v_exp_f32 v99, v99
    v_exp_f32 v100, v100
    v_exp_f32 v101, v101
    v_exp_f32 v102, v102
    v_exp_f32 v103, v103
    v_exp_f32 v104, v104
    v_exp_f32 v105, v105
    v_exp_f32 v106, v106
    v_exp_f32 v107, v107
    v_exp_f32 v108, v108
    v_exp_f32 v109, v109
    v_exp_f32 v110, v110
    v_exp_f32 v111, v111
    s_nop 1
    v_smfmac_f32_32x32x32_bf16 v[24:39], v[64:67], v[80:87], v112
    v_smfmac_f32_32x32x32_bf16 v[24:39], v[68:71], v[88:95], v112
    v_smfmac_f32_32x32x32_bf16 v[40:55], v[64:67], v[96:103], v112
    v_smfmac_f32_32x32x32_bf16 v[40:55], v[68:71], v[104:111], v112
    s_nop 15
    s_add_u32 s42, s42, 1
    s_add_u32 s43, s43, 2080
    s_and_b32 s41, s42, 7
    s_cmp_eq_u32 s41, 0
    s_cselect_b32 s41, 768, 0
    s_add_u32 s43, s43, s41
    s_cmp_lt_u32 s42, 64
    s_cbranch_scc1 L_main_kernel_p2_41
    s_branch L_main_kernel_afin_22
L_main_kernel_aslow_28:
    s_add_u32 s41, s19, 36401152
    s_mov_b32 s40, 0
L_main_kernel_poll_42:
    buffer_load_dword v15, v3, s[4:7], s41 offen sc1
    s_add_u32 s40, s40, 1
    s_waitcnt vmcnt(0)
    v_cmp_gt_u32 vcc, 1, v15
    s_cbranch_vccz L_main_kernel_polld_43
    s_cmp_lt_u32 s40, 262144
    s_cbranch_scc1 L_main_kernel_poll_42
L_main_kernel_polld_43:
    s_branch L_main_kernel_aback_29
L_main_kernel_aslow_30:
    s_add_u32 s41, s19, 36401152
    s_mov_b32 s40, 0
L_main_kernel_poll_44:
    buffer_load_dword v15, v3, s[4:7], s41 offen sc1
    s_add_u32 s40, s40, 1
    s_waitcnt vmcnt(0)
    v_cmp_gt_u32 vcc, 2, v15
    s_cbranch_vccz L_main_kernel_polld_45
    s_cmp_lt_u32 s40, 262144
    s_cbranch_scc1 L_main_kernel_poll_44
L_main_kernel_polld_45:
    s_branch L_main_kernel_aback_31
L_main_end:
.section .rodata,"a"
.p2align 6
.amdhsa_kernel main_kernel
  .amdhsa_next_free_vgpr 512
  .amdhsa_next_free_sgpr 102
  .amdhsa_accum_offset 256
  .amdhsa_group_segment_fixed_size 0
  .amdhsa_kernarg_size 96
  .amdhsa_user_sgpr_count 2
  .amdhsa_user_sgpr_kernarg_segment_ptr 1
  .amdhsa_system_sgpr_workgroup_id_x 1
.end_amdhsa_kernel
```
